```python
import torch

def _softmax(x, axis=-1):
    return torch.softmax(x, dim=axis)
def _gelu(x):
    return torch.nn.functional.gelu(x, approximate="tanh")
def _silu(x):
    return torch.nn.functional.silu(x)
def _sigmoid(x):
    return torch.sigmoid(x)
def _layernorm(x, axis=-1, eps=1e-5):
    m = x.mean(dim=axis, keepdim=True)
    v = x.var(dim=axis, keepdim=True, unbiased=False)
    return (x - m) / torch.sqrt(v + eps)
def _scatter_add(tgt, idx, src, axis=0):
    return tgt.clone().index_add_(axis, idx, src)
def _segment_sum(src, seg, n):
    out = torch.zeros((n,) + src.shape[1:], dtype=src.dtype)
    return out.index_add_(0, seg, src)
def _pad(x, pw):
    flat = tuple(v for pair in reversed(pw) for v in pair)
    return torch.nn.functional.pad(x, flat)

kernel_name = 'sequential_preLN__ssm_conv_s4d__mixer_token_mlp__prompt'

def setup_inputs():

    _w = (lambda a: (lambda t: t.to(torch.bfloat16) if t.is_floating_point() else t)(torch.as_tensor(a)))
    def _A_setup():
        Bsz, L, D, N = 1, 2048, 640, 192
        return {
            "u": _w((lambda *s: torch.randn(*s, dtype=torch.bfloat16) * 0.05)(Bsz, L, D)),
            "log_A_real": _w((lambda *s: torch.randn(*s, dtype=torch.bfloat16) * 6.4)(D, N) * 0.5),
            "A_imag": _w((lambda *s: torch.randn(*s, dtype=torch.bfloat16) * 0.05)(D, N) * 3.14),
            "C_real": _w((lambda *s: torch.randn(*s, dtype=torch.bfloat16) * 0.05)(D, N) / N ** 0.5),
            "C_imag": _w((lambda *s: torch.randn(*s, dtype=torch.bfloat16) * 0.05)(D, N) / N ** 0.5),
            "log_dt": _w((lambda *s: torch.randn(*s, dtype=torch.bfloat16) * 0.05)(D) * 0.5 - 4.0),
            "D_skip": _w((lambda *s: torch.randn(*s, dtype=torch.bfloat16) * 0.05)(D)),
        }
    _A_in = _A_setup()

    def _B_setup():
        B, S, D, F = 1, 2048, 640, 1536
        return {
            "x": _w((lambda *s: torch.randn(*s, dtype=torch.bfloat16) * 0.05)(B, S, D)),
            "w1": _w((lambda *s: torch.randn(*s, dtype=torch.bfloat16) * 0.4)(S, F) * (S ** -0.5)),
            "b1": _w((lambda *s: torch.randn(*s, dtype=torch.bfloat16) * 12.8)(F) * 0.02),
            "w2": _w((lambda *s: torch.randn(*s, dtype=torch.bfloat16) * 0.2)(F, S) * (F ** -0.5)),
            "b2": _w((lambda *s: torch.randn(*s, dtype=torch.bfloat16) * 3.2)(S) * 0.02),
        }
    _B_in = _B_setup()

    return {
        "A_u": _A_in["u"],
        "A_log_A_real": _A_in["log_A_real"],
        "A_A_imag": _A_in["A_imag"],
        "A_C_real": _A_in["C_real"],
        "A_C_imag": _A_in["C_imag"],
        "A_log_dt": _A_in["log_dt"],
        "A_D_skip": _A_in["D_skip"],
        "B_x": _B_in["x"],
        "B_w1": _B_in["w1"],
        "B_b1": _B_in["b1"],
        "B_w2": _B_in["w2"],
        "B_b2": _B_in["b2"],
    }

def reference(A_u, A_log_A_real, A_A_imag, A_C_real, A_C_imag, A_log_dt, A_D_skip, B_x, B_w1, B_b1, B_w2, B_b2):
    def _A_ref(u, log_A_real, A_imag, C_real, C_imag, log_dt, D_skip):
        L = u.shape[1]
        dt = torch.exp(log_dt)
        A = -torch.exp(log_A_real) + 1j * A_imag
        C = (C_real + 1j * C_imag) * dt[:, None]
        pos = (lambda x, dt: x.to(dt))(torch.arange(L), log_dt.dtype)
        P = torch.exp((A * dt[:, None])[:, :, None] * pos[None, None, :])
        K = 2.0 * torch.einsum("dn,dnl->dl", C, P).real
        L2 = 2 * L
        u_t = (lambda x, *d: x.permute(*d))(u, 0, 2, 1)
        Kf = (lambda x, *a, **k: torch.fft.rfft(x.float(), *a, **k))(K, L2)
        Uf = (lambda x, *a, **k: torch.fft.rfft(x.float(), *a, **k))(u_t, L2)
        y = (lambda x, *a, **k: torch.fft.irfft(x, *a, **k).to(torch.bfloat16))(Uf * Kf[None, :, :], L2)[:, :, :L]
        y = (lambda x, *d: x.permute(*d))(y, 0, 2, 1)
        return y + u * D_skip[None, None, :]

    def _B_ref(x, w1, b1, w2, b2):
        B, S, D = x.shape
        h = _layernorm(x, axis=-1)
        u = torch.einsum("bsd,sf->bdf", h, w1) + b1
        u = _gelu(u)
        y = torch.einsum("bdf,fs->bds", u, w2) + b2
        return (lambda x, *d: x.permute(*d))(y, 0, 2, 1)

    x = A_u
    h = x + _A_ref(_layernorm(x, axis=-1), A_log_A_real, A_A_imag, A_C_real, A_C_imag, A_log_dt, A_D_skip)
    h2 = h + _B_ref(_layernorm(h, axis=-1), B_w1, B_b1, B_w2, B_b2)
    return h2
```

```asm
; @launch kernel=prep_kernel grid=(2304,1,1) block=(256,1,1) lds=38912
; @launch kernel=conv_kernel grid=(640,1,1) block=(256,1,1) lds=48640
; @launch kernel=ln2_kernel grid=(128,1,1) block=(256,1,1) lds=20480
; @launch kernel=gemm1_kernel grid=(240,1,1) block=(256,1,1) lds=65536
; @launch kernel=gemm2_kernel grid=(320,1,1) block=(256,1,1) lds=65536
.amdgcn_target "amdgcn-amd-amdhsa--gfx950"
.text
.globl prep_kernel
.p2align 8
.type prep_kernel,@function
prep_kernel:
    s_cmp_ge_u32 s2, 2304
    s_cbranch_scc1 L_end_4
    s_cmp_lt_u32 s2, 640
    s_cbranch_scc1 L_kgen_1
    s_cmp_lt_u32 s2, 768
    s_cbranch_scc1 L_ln1_2
    s_branch L_tr_3
L_end_4:
    s_endpgm
L_kgen_1:
    s_load_dwordx2 s[4:5], s[0:1], 8
    s_load_dwordx2 s[6:7], s[0:1], 16
    s_load_dwordx2 s[8:9], s[0:1], 24
    s_load_dwordx2 s[10:11], s[0:1], 32
    s_load_dwordx2 s[12:13], s[0:1], 40
    s_load_dwordx2 s[14:15], s[0:1], 112
    s_waitcnt lgkmcnt(0)
    s_mov_b32 s16, s4
    s_mov_b32 s17, s5
    s_mov_b32 s18, 0x3c000
    s_mov_b32 s19, 0x00020000
    s_mov_b32 s20, s6
    s_mov_b32 s21, s7
    s_mov_b32 s22, 0x3c000
    s_mov_b32 s23, 0x00020000
    s_mov_b32 s24, s8
    s_mov_b32 s25, s9
    s_mov_b32 s26, 0x3c000
    s_mov_b32 s27, 0x00020000
    s_mov_b32 s28, s10
    s_mov_b32 s29, s11
    s_mov_b32 s30, 0x3c000
    s_mov_b32 s31, 0x00020000
    s_mov_b32 s32, s12
    s_mov_b32 s33, s13
    s_mov_b32 s34, 0x500
    s_mov_b32 s35, 0x00020000
    s_add_u32 s36, s14, 0x280000
    s_addc_u32 s37, s15, 0
    s_mov_b32 s38, 0x195000
    s_mov_b32 s39, 0x00020000
    s_mul_i32 s40, s2, 384
    s_lshl_b32 s41, s2, 1
    v_lshlrev_b32 v1, 1, v0
    v_and_b32 v2, 63, v0
    v_lshrrev_b32 v3, 6, v0
    s_nop 0
    v_readfirstlane_b32 s42, v3
    v_mov_b32 v4, 0
    v_mov_b32 v5, 3072
    ds_write_b32 v5, v4
    v_mov_b32 v6, 0
    buffer_load_ushort v10, v1, s[16:19], s40 offen
    buffer_load_ushort v11, v1, s[20:23], s40 offen
    buffer_load_ushort v12, v1, s[24:27], s40 offen
    buffer_load_ushort v13, v1, s[28:31], s40 offen
    buffer_load_ushort v14, v6, s[32:35], s41 offen
    s_waitcnt vmcnt(0) lgkmcnt(0)
    s_barrier
    v_lshlrev_b32 v10, 16, v10
    v_lshlrev_b32 v11, 16, v11
    v_lshlrev_b32 v12, 16, v12
    v_lshlrev_b32 v13, 16, v13
    v_lshlrev_b32 v14, 16, v14
    v_mul_f32 v10, 0x3fb8aa3b, v10
    v_mul_f32 v14, 0x3fb8aa3b, v14
    v_exp_f32 v10, v10
    v_exp_f32 v14, v14
    s_nop 0
    v_cvt_pk_bf16_f32 v10, v10, v10
    v_lshlrev_b32 v10, 16, v10
    v_cvt_pk_bf16_f32 v14, v14, v14
    v_lshlrev_b32 v14, 16, v14
    v_mul_f32 v16, v10, v14
    v_sub_f32 v16, 0, v16
    v_mul_f32 v17, v11, v14
    v_mul_f32 v18, v12, v14
    v_mul_f32 v19, v13, v14
    v_cmp_gt_u32 vcc, 192, v0
    s_and_saveexec_b64 s[44:45], vcc
    v_lshlrev_b32 v7, 4, v0
    ds_write_b128 v7, v[16:19]
    v_and_b32 v20, 0x7fffffff, v18
    v_and_b32 v21, 0x7fffffff, v19
    v_max_u32 v20, v20, v21
    ds_max_u32 v5, v20
    s_mov_b64 exec, s[44:45]
    s_waitcnt lgkmcnt(0)
    s_barrier
    ds_read_b32 v21, v5
    s_waitcnt lgkmcnt(0)
    v_lshrrev_b32 v21, 23, v21
    v_sub_u32 v22, 254, v21
    v_lshlrev_b32 v22, 23, v22
    v_add_u32 v23, 1, v21
    v_lshlrev_b32 v23, 23, v23
    v_mov_b32 v24, 0
    v_mov_b32 v25, 0
    v_mov_b32 v26, 0
    v_mov_b32 v27, 0
    v_lshlrev_b32 v8, 2, v2
    s_mov_b32 s46, 0
L_kg_loop_5:
    s_lshl_b32 s47, s46, 10
    v_lshlrev_b32 v9, 4, v2
    v_add_u32 v9, s47, v9
    ds_read_b128 v[30:33], v9
    s_waitcnt lgkmcnt(0)
    v_mul_f32 v30, 0x3fb8aa3b, v30
    v_mul_f32 v31, 0x3e22f983, v31
    v_mul_f32 v32, v32, v22
    v_mul_f32 v33, v33, v22
    s_cmp_eq_u32 s42, 1
    s_cbranch_scc1 L_kg_w_7
    s_cmp_eq_u32 s42, 2
    s_cbranch_scc1 L_kg_w_8
    s_cmp_eq_u32 s42, 3
    s_cbranch_scc1 L_kg_w_9
L_kg_w_6:
    v_mul_f32 v34, 0x41000000, v30
    v_mul_f32 v35, 0x41000000, v31
    v_exp_f32 v34, v34
    v_fract_f32 v35, v35
    v_cos_f32 v36, v35
    v_sin_f32 v37, v35
    s_nop 0
    v_mul_f32 v40, v34, v36
    v_mul_f32 v41, v34, v37
    v_mov_b32 v42, 1.0
    v_mov_b32 v43, 0
    v_cvt_pkrtz_f16_f32 v34, v42, v43
    v_cvt_f32_f16 v35, v34
    v_cvt_f32_f16_sdwa v36, v34 dst_sel:DWORD dst_unused:UNUSED_PAD src0_sel:WORD_1
    v_sub_f32 v35, v42, v35
    v_sub_f32 v36, v43, v36
    v_cvt_pkrtz_f16_f32 v37, v35, v36
    ds_write_b32 v8, v34 offset:30208
    ds_write_b32 v8, v37 offset:34560
    v_mul_f32 v34, v43, v41
    v_mul_f32 v35, v43, v40
    v_fma_f32 v36, v42, v40, -v34
    v_fma_f32 v43, v42, v41, v35
    v_mov_b32 v42, v36
    v_cvt_pkrtz_f16_f32 v34, v42, v43
    v_cvt_f32_f16 v35, v34
    v_cvt_f32_f16_sdwa v36, v34 dst_sel:DWORD dst_unused:UNUSED_PAD src0_sel:WORD_1
    v_sub_f32 v35, v42, v35
    v_sub_f32 v36, v43, v36
    v_cvt_pkrtz_f16_f32 v37, v35, v36
    ds_write_b32 v8, v34 offset:30480
    ds_write_b32 v8, v37 offset:34832
    v_mul_f32 v34, v43, v41
    v_mul_f32 v35, v43, v40
    v_fma_f32 v36, v42, v40, -v34
    v_fma_f32 v43, v42, v41, v35
    v_mov_b32 v42, v36
    v_cvt_pkrtz_f16_f32 v34, v42, v43
    v_cvt_f32_f16 v35, v34
    v_cvt_f32_f16_sdwa v36, v34 dst_sel:DWORD dst_unused:UNUSED_PAD src0_sel:WORD_1
    v_sub_f32 v35, v42, v35
    v_sub_f32 v36, v43, v36
    v_cvt_pkrtz_f16_f32 v37, v35, v36
    ds_write_b32 v8, v34 offset:30752
    ds_write_b32 v8, v37 offset:35104
    v_mul_f32 v34, v43, v41
    v_mul_f32 v35, v43, v40
    v_fma_f32 v36, v42, v40, -v34
    v_fma_f32 v43, v42, v41, v35
    v_mov_b32 v42, v36
    v_cvt_pkrtz_f16_f32 v34, v42, v43
    v_cvt_f32_f16 v35, v34
    v_cvt_f32_f16_sdwa v36, v34 dst_sel:DWORD dst_unused:UNUSED_PAD src0_sel:WORD_1
    v_sub_f32 v35, v42, v35
    v_sub_f32 v36, v43, v36
    v_cvt_pkrtz_f16_f32 v37, v35, v36
    ds_write_b32 v8, v34 offset:31024
    ds_write_b32 v8, v37 offset:35376
    v_mul_f32 v34, v43, v41
    v_mul_f32 v35, v43, v40
    v_fma_f32 v36, v42, v40, -v34
    v_fma_f32 v43, v42, v41, v35
    v_mov_b32 v42, v36
    v_cvt_pkrtz_f16_f32 v34, v42, v43
    v_cvt_f32_f16 v35, v34
    v_cvt_f32_f16_sdwa v36, v34 dst_sel:DWORD dst_unused:UNUSED_PAD src0_sel:WORD_1
    v_sub_f32 v35, v42, v35
    v_sub_f32 v36, v43, v36
    v_cvt_pkrtz_f16_f32 v37, v35, v36
    ds_write_b32 v8, v34 offset:31296
    ds_write_b32 v8, v37 offset:35648
    v_mul_f32 v34, v43, v41
    v_mul_f32 v35, v43, v40
    v_fma_f32 v36, v42, v40, -v34
    v_fma_f32 v43, v42, v41, v35
    v_mov_b32 v42, v36
    v_cvt_pkrtz_f16_f32 v34, v42, v43
    v_cvt_f32_f16 v35, v34
    v_cvt_f32_f16_sdwa v36, v34 dst_sel:DWORD dst_unused:UNUSED_PAD src0_sel:WORD_1
    v_sub_f32 v35, v42, v35
    v_sub_f32 v36, v43, v36
    v_cvt_pkrtz_f16_f32 v37, v35, v36
    ds_write_b32 v8, v34 offset:31568
    ds_write_b32 v8, v37 offset:35920
    v_mul_f32 v34, v43, v41
    v_mul_f32 v35, v43, v40
    v_fma_f32 v36, v42, v40, -v34
    v_fma_f32 v43, v42, v41, v35
    v_mov_b32 v42, v36
    v_cvt_pkrtz_f16_f32 v34, v42, v43
    v_cvt_f32_f16 v35, v34
    v_cvt_f32_f16_sdwa v36, v34 dst_sel:DWORD dst_unused:UNUSED_PAD src0_sel:WORD_1
    v_sub_f32 v35, v42, v35
    v_sub_f32 v36, v43, v36
    v_cvt_pkrtz_f16_f32 v37, v35, v36
    ds_write_b32 v8, v34 offset:31840
    ds_write_b32 v8, v37 offset:36192
    v_mul_f32 v34, v43, v41
    v_mul_f32 v35, v43, v40
    v_fma_f32 v36, v42, v40, -v34
    v_fma_f32 v43, v42, v41, v35
    v_mov_b32 v42, v36
    v_cvt_pkrtz_f16_f32 v34, v42, v43
    v_cvt_f32_f16 v35, v34
    v_cvt_f32_f16_sdwa v36, v34 dst_sel:DWORD dst_unused:UNUSED_PAD src0_sel:WORD_1
    v_sub_f32 v35, v42, v35
    v_sub_f32 v36, v43, v36
    v_cvt_pkrtz_f16_f32 v37, v35, v36
    ds_write_b32 v8, v34 offset:32112
    ds_write_b32 v8, v37 offset:36464
    v_mul_f32 v34, v43, v41
    v_mul_f32 v35, v43, v40
    v_fma_f32 v36, v42, v40, -v34
    v_fma_f32 v43, v42, v41, v35
    v_mov_b32 v42, v36
    v_cvt_pkrtz_f16_f32 v34, v42, v43
    v_cvt_f32_f16 v35, v34
    v_cvt_f32_f16_sdwa v36, v34 dst_sel:DWORD dst_unused:UNUSED_PAD src0_sel:WORD_1
    v_sub_f32 v35, v42, v35
    v_sub_f32 v36, v43, v36
    v_cvt_pkrtz_f16_f32 v37, v35, v36
    ds_write_b32 v8, v34 offset:32384
    ds_write_b32 v8, v37 offset:36736
    v_mul_f32 v34, v43, v41
    v_mul_f32 v35, v43, v40
    v_fma_f32 v36, v42, v40, -v34
    v_fma_f32 v43, v42, v41, v35
    v_mov_b32 v42, v36
    v_cvt_pkrtz_f16_f32 v34, v42, v43
    v_cvt_f32_f16 v35, v34
    v_cvt_f32_f16_sdwa v36, v34 dst_sel:DWORD dst_unused:UNUSED_PAD src0_sel:WORD_1
    v_sub_f32 v35, v42, v35
    v_sub_f32 v36, v43, v36
    v_cvt_pkrtz_f16_f32 v37, v35, v36
    ds_write_b32 v8, v34 offset:32656
    ds_write_b32 v8, v37 offset:37008
    v_mul_f32 v34, v43, v41
    v_mul_f32 v35, v43, v40
    v_fma_f32 v36, v42, v40, -v34
    v_fma_f32 v43, v42, v41, v35
    v_mov_b32 v42, v36
    v_cvt_pkrtz_f16_f32 v34, v42, v43
    v_cvt_f32_f16 v35, v34
    v_cvt_f32_f16_sdwa v36, v34 dst_sel:DWORD dst_unused:UNUSED_PAD src0_sel:WORD_1
    v_sub_f32 v35, v42, v35
    v_sub_f32 v36, v43, v36
    v_cvt_pkrtz_f16_f32 v37, v35, v36
    ds_write_b32 v8, v34 offset:32928
    ds_write_b32 v8, v37 offset:37280
    v_mul_f32 v34, v43, v41
    v_mul_f32 v35, v43, v40
    v_fma_f32 v36, v42, v40, -v34
    v_fma_f32 v43, v42, v41, v35
    v_mov_b32 v42, v36
    v_cvt_pkrtz_f16_f32 v34, v42, v43
    v_cvt_f32_f16 v35, v34
    v_cvt_f32_f16_sdwa v36, v34 dst_sel:DWORD dst_unused:UNUSED_PAD src0_sel:WORD_1
    v_sub_f32 v35, v42, v35
    v_sub_f32 v36, v43, v36
    v_cvt_pkrtz_f16_f32 v37, v35, v36
    ds_write_b32 v8, v34 offset:33200
    ds_write_b32 v8, v37 offset:37552
    v_mul_f32 v34, v43, v41
    v_mul_f32 v35, v43, v40
    v_fma_f32 v36, v42, v40, -v34
    v_fma_f32 v43, v42, v41, v35
    v_mov_b32 v42, v36
    v_cvt_pkrtz_f16_f32 v34, v42, v43
    v_cvt_f32_f16 v35, v34
    v_cvt_f32_f16_sdwa v36, v34 dst_sel:DWORD dst_unused:UNUSED_PAD src0_sel:WORD_1
    v_sub_f32 v35, v42, v35
    v_sub_f32 v36, v43, v36
    v_cvt_pkrtz_f16_f32 v37, v35, v36
    ds_write_b32 v8, v34 offset:33472
    ds_write_b32 v8, v37 offset:37824
    v_mul_f32 v34, v43, v41
    v_mul_f32 v35, v43, v40
    v_fma_f32 v36, v42, v40, -v34
    v_fma_f32 v43, v42, v41, v35
    v_mov_b32 v42, v36
    v_cvt_pkrtz_f16_f32 v34, v42, v43
    v_cvt_f32_f16 v35, v34
    v_cvt_f32_f16_sdwa v36, v34 dst_sel:DWORD dst_unused:UNUSED_PAD src0_sel:WORD_1
    v_sub_f32 v35, v42, v35
    v_sub_f32 v36, v43, v36
    v_cvt_pkrtz_f16_f32 v37, v35, v36
    ds_write_b32 v8, v34 offset:33744
    ds_write_b32 v8, v37 offset:38096
    v_mul_f32 v34, v43, v41
    v_mul_f32 v35, v43, v40
    v_fma_f32 v36, v42, v40, -v34
    v_fma_f32 v43, v42, v41, v35
    v_mov_b32 v42, v36
    v_cvt_pkrtz_f16_f32 v34, v42, v43
    v_cvt_f32_f16 v35, v34
    v_cvt_f32_f16_sdwa v36, v34 dst_sel:DWORD dst_unused:UNUSED_PAD src0_sel:WORD_1
    v_sub_f32 v35, v42, v35
    v_sub_f32 v36, v43, v36
    v_cvt_pkrtz_f16_f32 v37, v35, v36
    ds_write_b32 v8, v34 offset:34016
    ds_write_b32 v8, v37 offset:38368
    v_mul_f32 v34, v43, v41
    v_mul_f32 v35, v43, v40
    v_fma_f32 v36, v42, v40, -v34
    v_fma_f32 v43, v42, v41, v35
    v_mov_b32 v42, v36
    v_cvt_pkrtz_f16_f32 v34, v42, v43
    v_cvt_f32_f16 v35, v34
    v_cvt_f32_f16_sdwa v36, v34 dst_sel:DWORD dst_unused:UNUSED_PAD src0_sel:WORD_1
    v_sub_f32 v35, v42, v35
    v_sub_f32 v36, v43, v36
    v_cvt_pkrtz_f16_f32 v37, v35, v36
    ds_write_b32 v8, v34 offset:34288
    ds_write_b32 v8, v37 offset:38640
    s_branch L_kg_gen_done_10
L_kg_w_7:
    v_mul_f32 v34, 0x3f800000, v30
    v_mul_f32 v35, 0x3f800000, v31
    v_exp_f32 v34, v34
    v_fract_f32 v35, v35
    v_cos_f32 v36, v35
    v_sin_f32 v37, v35
    s_nop 0
    v_mul_f32 v40, v34, v36
    v_mul_f32 v41, v34, v37
    v_mul_f32 v34, 0x43000000, v30
    v_mul_f32 v35, 0x43000000, v31
    v_exp_f32 v34, v34
    v_fract_f32 v35, v35
    v_cos_f32 v36, v35
    v_sin_f32 v37, v35
    s_nop 0
    v_mul_f32 v38, v34, v36
    v_mul_f32 v39, v34, v37
    v_mov_b32 v44, v32
    v_mov_b32 v45, v33
    v_mul_f32 v34, v45, v41
    v_mul_f32 v35, v45, v40
    v_fma_f32 v46, v44, v40, -v34
    v_fma_f32 v47, v44, v41, v35
    v_mul_f32 v34, v47, v41
    v_mul_f32 v35, v47, v40
    v_fma_f32 v48, v46, v40, -v34
    v_fma_f32 v49, v46, v41, v35
    v_mul_f32 v34, v49, v41
    v_mul_f32 v35, v49, v40
    v_fma_f32 v50, v48, v40, -v34
    v_fma_f32 v51, v48, v41, v35
    v_mul_f32 v34, v51, v41
    v_mul_f32 v35, v51, v40
    v_fma_f32 v52, v50, v40, -v34
    v_fma_f32 v53, v50, v41, v35
    v_mul_f32 v34, v53, v41
    v_mul_f32 v35, v53, v40
    v_fma_f32 v54, v52, v40, -v34
    v_fma_f32 v55, v52, v41, v35
    v_mul_f32 v34, v55, v41
    v_mul_f32 v35, v55, v40
    v_fma_f32 v56, v54, v40, -v34
    v_fma_f32 v57, v54, v41, v35
    v_mul_f32 v34, v57, v41
    v_mul_f32 v35, v57, v40
    v_fma_f32 v58, v56, v40, -v34
    v_fma_f32 v59, v56, v41, v35
    v_cvt_pkrtz_f16_f32 v34, v44, -v45
    v_cvt_f32_f16 v35, v34
    v_cvt_f32_f16_sdwa v36, v34 dst_sel:DWORD dst_unused:UNUSED_PAD src0_sel:WORD_1
    v_sub_f32 v35, v44, v35
    v_add_f32 v36, v45, v36
    v_sub_f32 v36, 0, v36
    v_cvt_pkrtz_f16_f32 v37, v35, v36
    ds_write_b32 v8, v34 offset:4096
    ds_write_b32 v8, v37 offset:17152
    v_cvt_pkrtz_f16_f32 v34, v46, -v47
    v_cvt_f32_f16 v35, v34
    v_cvt_f32_f16_sdwa v36, v34 dst_sel:DWORD dst_unused:UNUSED_PAD src0_sel:WORD_1
    v_sub_f32 v35, v46, v35
    v_add_f32 v36, v47, v36
    v_sub_f32 v36, 0, v36
    v_cvt_pkrtz_f16_f32 v37, v35, v36
    ds_write_b32 v8, v34 offset:4368
    ds_write_b32 v8, v37 offset:17424
    v_cvt_pkrtz_f16_f32 v34, v48, -v49
    v_cvt_f32_f16 v35, v34
    v_cvt_f32_f16_sdwa v36, v34 dst_sel:DWORD dst_unused:UNUSED_PAD src0_sel:WORD_1
    v_sub_f32 v35, v48, v35
    v_add_f32 v36, v49, v36
    v_sub_f32 v36, 0, v36
    v_cvt_pkrtz_f16_f32 v37, v35, v36
    ds_write_b32 v8, v34 offset:4640
    ds_write_b32 v8, v37 offset:17696
    v_cvt_pkrtz_f16_f32 v34, v50, -v51
    v_cvt_f32_f16 v35, v34
    v_cvt_f32_f16_sdwa v36, v34 dst_sel:DWORD dst_unused:UNUSED_PAD src0_sel:WORD_1
    v_sub_f32 v35, v50, v35
    v_add_f32 v36, v51, v36
    v_sub_f32 v36, 0, v36
    v_cvt_pkrtz_f16_f32 v37, v35, v36
    ds_write_b32 v8, v34 offset:4912
    ds_write_b32 v8, v37 offset:17968
    v_cvt_pkrtz_f16_f32 v34, v52, -v53
    v_cvt_f32_f16 v35, v34
    v_cvt_f32_f16_sdwa v36, v34 dst_sel:DWORD dst_unused:UNUSED_PAD src0_sel:WORD_1
    v_sub_f32 v35, v52, v35
    v_add_f32 v36, v53, v36
    v_sub_f32 v36, 0, v36
    v_cvt_pkrtz_f16_f32 v37, v35, v36
    ds_write_b32 v8, v34 offset:5184
    ds_write_b32 v8, v37 offset:18240
    v_cvt_pkrtz_f16_f32 v34, v54, -v55
    v_cvt_f32_f16 v35, v34
    v_cvt_f32_f16_sdwa v36, v34 dst_sel:DWORD dst_unused:UNUSED_PAD src0_sel:WORD_1
    v_sub_f32 v35, v54, v35
    v_add_f32 v36, v55, v36
    v_sub_f32 v36, 0, v36
    v_cvt_pkrtz_f16_f32 v37, v35, v36
    ds_write_b32 v8, v34 offset:5456
    ds_write_b32 v8, v37 offset:18512
    v_cvt_pkrtz_f16_f32 v34, v56, -v57
    v_cvt_f32_f16 v35, v34
    v_cvt_f32_f16_sdwa v36, v34 dst_sel:DWORD dst_unused:UNUSED_PAD src0_sel:WORD_1
    v_sub_f32 v35, v56, v35
    v_add_f32 v36, v57, v36
    v_sub_f32 v36, 0, v36
    v_cvt_pkrtz_f16_f32 v37, v35, v36
    ds_write_b32 v8, v34 offset:5728
    ds_write_b32 v8, v37 offset:18784
    v_cvt_pkrtz_f16_f32 v34, v58, -v59
    v_cvt_f32_f16 v35, v34
    v_cvt_f32_f16_sdwa v36, v34 dst_sel:DWORD dst_unused:UNUSED_PAD src0_sel:WORD_1
    v_sub_f32 v35, v58, v35
    v_add_f32 v36, v59, v36
    v_sub_f32 v36, 0, v36
    v_cvt_pkrtz_f16_f32 v37, v35, v36
    ds_write_b32 v8, v34 offset:6000
    ds_write_b32 v8, v37 offset:19056
    v_mul_f32 v34, v45, v39
    v_mul_f32 v35, v45, v38
    v_fma_f32 v36, v44, v38, -v34
    v_fma_f32 v45, v44, v39, v35
    v_mov_b32 v44, v36
    v_cvt_pkrtz_f16_f32 v34, v44, -v45
    v_cvt_f32_f16 v35, v34
    v_cvt_f32_f16_sdwa v36, v34 dst_sel:DWORD dst_unused:UNUSED_PAD src0_sel:WORD_1
    v_sub_f32 v35, v44, v35
    v_add_f32 v36, v45, v36
    v_sub_f32 v36, 0, v36
    v_cvt_pkrtz_f16_f32 v37, v35, v36
    ds_write_b32 v8, v34 offset:6272
    ds_write_b32 v8, v37 offset:19328
    v_mul_f32 v34, v47, v39
    v_mul_f32 v35, v47, v38
    v_fma_f32 v36, v46, v38, -v34
    v_fma_f32 v47, v46, v39, v35
    v_mov_b32 v46, v36
    v_cvt_pkrtz_f16_f32 v34, v46, -v47
    v_cvt_f32_f16 v35, v34
    v_cvt_f32_f16_sdwa v36, v34 dst_sel:DWORD dst_unused:UNUSED_PAD src0_sel:WORD_1
    v_sub_f32 v35, v46, v35
    v_add_f32 v36, v47, v36
    v_sub_f32 v36, 0, v36
    v_cvt_pkrtz_f16_f32 v37, v35, v36
    ds_write_b32 v8, v34 offset:6544
    ds_write_b32 v8, v37 offset:19600
    v_mul_f32 v34, v49, v39
    v_mul_f32 v35, v49, v38
    v_fma_f32 v36, v48, v38, -v34
    v_fma_f32 v49, v48, v39, v35
    v_mov_b32 v48, v36
    v_cvt_pkrtz_f16_f32 v34, v48, -v49
    v_cvt_f32_f16 v35, v34
    v_cvt_f32_f16_sdwa v36, v34 dst_sel:DWORD dst_unused:UNUSED_PAD src0_sel:WORD_1
    v_sub_f32 v35, v48, v35
    v_add_f32 v36, v49, v36
    v_sub_f32 v36, 0, v36
    v_cvt_pkrtz_f16_f32 v37, v35, v36
    ds_write_b32 v8, v34 offset:6816
    ds_write_b32 v8, v37 offset:19872
    v_mul_f32 v34, v51, v39
    v_mul_f32 v35, v51, v38
    v_fma_f32 v36, v50, v38, -v34
    v_fma_f32 v51, v50, v39, v35
    v_mov_b32 v50, v36
    v_cvt_pkrtz_f16_f32 v34, v50, -v51
    v_cvt_f32_f16 v35, v34
    v_cvt_f32_f16_sdwa v36, v34 dst_sel:DWORD dst_unused:UNUSED_PAD src0_sel:WORD_1
    v_sub_f32 v35, v50, v35
    v_add_f32 v36, v51, v36
    v_sub_f32 v36, 0, v36
    v_cvt_pkrtz_f16_f32 v37, v35, v36
    ds_write_b32 v8, v34 offset:7088
    ds_write_b32 v8, v37 offset:20144
    v_mul_f32 v34, v53, v39
    v_mul_f32 v35, v53, v38
    v_fma_f32 v36, v52, v38, -v34
    v_fma_f32 v53, v52, v39, v35
    v_mov_b32 v52, v36
    v_cvt_pkrtz_f16_f32 v34, v52, -v53
    v_cvt_f32_f16 v35, v34
    v_cvt_f32_f16_sdwa v36, v34 dst_sel:DWORD dst_unused:UNUSED_PAD src0_sel:WORD_1
    v_sub_f32 v35, v52, v35
    v_add_f32 v36, v53, v36
    v_sub_f32 v36, 0, v36
    v_cvt_pkrtz_f16_f32 v37, v35, v36
    ds_write_b32 v8, v34 offset:7360
    ds_write_b32 v8, v37 offset:20416
    v_mul_f32 v34, v55, v39
    v_mul_f32 v35, v55, v38
    v_fma_f32 v36, v54, v38, -v34
    v_fma_f32 v55, v54, v39, v35
    v_mov_b32 v54, v36
    v_cvt_pkrtz_f16_f32 v34, v54, -v55
    v_cvt_f32_f16 v35, v34
    v_cvt_f32_f16_sdwa v36, v34 dst_sel:DWORD dst_unused:UNUSED_PAD src0_sel:WORD_1
    v_sub_f32 v35, v54, v35
    v_add_f32 v36, v55, v36
    v_sub_f32 v36, 0, v36
    v_cvt_pkrtz_f16_f32 v37, v35, v36
    ds_write_b32 v8, v34 offset:7632
    ds_write_b32 v8, v37 offset:20688
    v_mul_f32 v34, v57, v39
    v_mul_f32 v35, v57, v38
    v_fma_f32 v36, v56, v38, -v34
    v_fma_f32 v57, v56, v39, v35
    v_mov_b32 v56, v36
    v_cvt_pkrtz_f16_f32 v34, v56, -v57
    v_cvt_f32_f16 v35, v34
    v_cvt_f32_f16_sdwa v36, v34 dst_sel:DWORD dst_unused:UNUSED_PAD src0_sel:WORD_1
    v_sub_f32 v35, v56, v35
    v_add_f32 v36, v57, v36
    v_sub_f32 v36, 0, v36
    v_cvt_pkrtz_f16_f32 v37, v35, v36
    ds_write_b32 v8, v34 offset:7904
    ds_write_b32 v8, v37 offset:20960
    v_mul_f32 v34, v59, v39
    v_mul_f32 v35, v59, v38
    v_fma_f32 v36, v58, v38, -v34
    v_fma_f32 v59, v58, v39, v35
    v_mov_b32 v58, v36
    v_cvt_pkrtz_f16_f32 v34, v58, -v59
    v_cvt_f32_f16 v35, v34
    v_cvt_f32_f16_sdwa v36, v34 dst_sel:DWORD dst_unused:UNUSED_PAD src0_sel:WORD_1
    v_sub_f32 v35, v58, v35
    v_add_f32 v36, v59, v36
    v_sub_f32 v36, 0, v36
    v_cvt_pkrtz_f16_f32 v37, v35, v36
    ds_write_b32 v8, v34 offset:8176
    ds_write_b32 v8, v37 offset:21232
    s_branch L_kg_gen_done_10
L_kg_w_8:
    v_mul_f32 v34, 0x43000000, v30
    v_mul_f32 v35, 0x43000000, v31
    v_exp_f32 v34, v34
    v_fract_f32 v35, v35
    v_cos_f32 v36, v35
    v_sin_f32 v37, v35
    s_nop 0
    v_mul_f32 v38, v34, v36
    v_mul_f32 v39, v34, v37
    v_mul_f32 v34, 0x40000000, v30
    v_mul_f32 v35, 0x40000000, v31
    v_exp_f32 v34, v34
    v_fract_f32 v35, v35
    v_cos_f32 v36, v35
    v_sin_f32 v37, v35
    s_nop 0
    v_mul_f32 v40, v34, v36
    v_mul_f32 v41, v34, v37
    v_mul_f32 v34, 0x43800000, v30
    v_mul_f32 v35, 0x43800000, v31
    v_exp_f32 v34, v34
    v_fract_f32 v35, v35
    v_cos_f32 v36, v35
    v_sin_f32 v37, v35
    s_nop 0
    v_mul_f32 v42, v34, v36
    v_mul_f32 v43, v34, v37
    v_mul_f32 v34, v43, v33
    v_mul_f32 v35, v43, v32
    v_fma_f32 v36, v42, v32, -v34
    v_fma_f32 v43, v42, v33, v35
    v_mov_b32 v42, v36
    v_mov_b32 v44, v42
    v_mov_b32 v45, v43
    v_mul_f32 v34, v45, v41
    v_mul_f32 v35, v45, v40
    v_fma_f32 v46, v44, v40, -v34
    v_fma_f32 v47, v44, v41, v35
    v_mul_f32 v34, v47, v41
    v_mul_f32 v35, v47, v40
    v_fma_f32 v48, v46, v40, -v34
    v_fma_f32 v49, v46, v41, v35
    v_mul_f32 v34, v49, v41
    v_mul_f32 v35, v49, v40
    v_fma_f32 v50, v48, v40, -v34
    v_fma_f32 v51, v48, v41, v35
    v_cvt_pkrtz_f16_f32 v34, v44, -v45
    v_cvt_f32_f16 v35, v34
    v_cvt_f32_f16_sdwa v36, v34 dst_sel:DWORD dst_unused:UNUSED_PAD src0_sel:WORD_1
    v_sub_f32 v35, v44, v35
    v_add_f32 v36, v45, v36
    v_sub_f32 v36, 0, v36
    v_cvt_pkrtz_f16_f32 v37, v35, v36
    ds_write_b32 v8, v34 offset:8448
    ds_write_b32 v8, v37 offset:21504
    v_cvt_pkrtz_f16_f32 v34, v46, -v47
    v_cvt_f32_f16 v35, v34
    v_cvt_f32_f16_sdwa v36, v34 dst_sel:DWORD dst_unused:UNUSED_PAD src0_sel:WORD_1
    v_sub_f32 v35, v46, v35
    v_add_f32 v36, v47, v36
    v_sub_f32 v36, 0, v36
    v_cvt_pkrtz_f16_f32 v37, v35, v36
    ds_write_b32 v8, v34 offset:8720
    ds_write_b32 v8, v37 offset:21776
    v_cvt_pkrtz_f16_f32 v34, v48, -v49
    v_cvt_f32_f16 v35, v34
    v_cvt_f32_f16_sdwa v36, v34 dst_sel:DWORD dst_unused:UNUSED_PAD src0_sel:WORD_1
    v_sub_f32 v35, v48, v35
    v_add_f32 v36, v49, v36
    v_sub_f32 v36, 0, v36
    v_cvt_pkrtz_f16_f32 v37, v35, v36
    ds_write_b32 v8, v34 offset:8992
    ds_write_b32 v8, v37 offset:22048
    v_cvt_pkrtz_f16_f32 v34, v50, -v51
    v_cvt_f32_f16 v35, v34
    v_cvt_f32_f16_sdwa v36, v34 dst_sel:DWORD dst_unused:UNUSED_PAD src0_sel:WORD_1
    v_sub_f32 v35, v50, v35
    v_add_f32 v36, v51, v36
    v_sub_f32 v36, 0, v36
    v_cvt_pkrtz_f16_f32 v37, v35, v36
    ds_write_b32 v8, v34 offset:9264
    ds_write_b32 v8, v37 offset:22320
    v_mul_f32 v34, v45, v39
    v_mul_f32 v35, v45, v38
    v_fma_f32 v36, v44, v38, -v34
    v_fma_f32 v45, v44, v39, v35
    v_mov_b32 v44, v36
    v_cvt_pkrtz_f16_f32 v34, v44, -v45
    v_cvt_f32_f16 v35, v34
    v_cvt_f32_f16_sdwa v36, v34 dst_sel:DWORD dst_unused:UNUSED_PAD src0_sel:WORD_1
    v_sub_f32 v35, v44, v35
    v_add_f32 v36, v45, v36
    v_sub_f32 v36, 0, v36
    v_cvt_pkrtz_f16_f32 v37, v35, v36
    ds_write_b32 v8, v34 offset:9536
    ds_write_b32 v8, v37 offset:22592
    v_mul_f32 v34, v47, v39
    v_mul_f32 v35, v47, v38
    v_fma_f32 v36, v46, v38, -v34
    v_fma_f32 v47, v46, v39, v35
    v_mov_b32 v46, v36
    v_cvt_pkrtz_f16_f32 v34, v46, -v47
    v_cvt_f32_f16 v35, v34
    v_cvt_f32_f16_sdwa v36, v34 dst_sel:DWORD dst_unused:UNUSED_PAD src0_sel:WORD_1
    v_sub_f32 v35, v46, v35
    v_add_f32 v36, v47, v36
    v_sub_f32 v36, 0, v36
    v_cvt_pkrtz_f16_f32 v37, v35, v36
    ds_write_b32 v8, v34 offset:9808
    ds_write_b32 v8, v37 offset:22864
    v_mul_f32 v34, v49, v39
    v_mul_f32 v35, v49, v38
    v_fma_f32 v36, v48, v38, -v34
    v_fma_f32 v49, v48, v39, v35
    v_mov_b32 v48, v36
    v_cvt_pkrtz_f16_f32 v34, v48, -v49
    v_cvt_f32_f16 v35, v34
    v_cvt_f32_f16_sdwa v36, v34 dst_sel:DWORD dst_unused:UNUSED_PAD src0_sel:WORD_1
    v_sub_f32 v35, v48, v35
    v_add_f32 v36, v49, v36
    v_sub_f32 v36, 0, v36
    v_cvt_pkrtz_f16_f32 v37, v35, v36
    ds_write_b32 v8, v34 offset:10080
    ds_write_b32 v8, v37 offset:23136
    v_mul_f32 v34, v51, v39
    v_mul_f32 v35, v51, v38
    v_fma_f32 v36, v50, v38, -v34
    v_fma_f32 v51, v50, v39, v35
    v_mov_b32 v50, v36
    v_cvt_pkrtz_f16_f32 v34, v50, -v51
    v_cvt_f32_f16 v35, v34
    v_cvt_f32_f16_sdwa v36, v34 dst_sel:DWORD dst_unused:UNUSED_PAD src0_sel:WORD_1
    v_sub_f32 v35, v50, v35
    v_add_f32 v36, v51, v36
    v_sub_f32 v36, 0, v36
    v_cvt_pkrtz_f16_f32 v37, v35, v36
    ds_write_b32 v8, v34 offset:10352
    ds_write_b32 v8, v37 offset:23408
    v_mul_f32 v34, 0x44000000, v30
    v_mul_f32 v35, 0x44000000, v31
    v_exp_f32 v34, v34
    v_fract_f32 v35, v35
    v_cos_f32 v36, v35
    v_sin_f32 v37, v35
    s_nop 0
    v_mul_f32 v42, v34, v36
    v_mul_f32 v43, v34, v37
    v_mul_f32 v34, v43, v33
    v_mul_f32 v35, v43, v32
    v_fma_f32 v36, v42, v32, -v34
    v_fma_f32 v43, v42, v33, v35
    v_mov_b32 v42, v36
    v_mul_f32 v34, 0x40800000, v30
    v_mul_f32 v35, 0x40800000, v31
    v_exp_f32 v34, v34
    v_fract_f32 v35, v35
    v_cos_f32 v36, v35
    v_sin_f32 v37, v35
    s_nop 0
    v_mul_f32 v40, v34, v36
    v_mul_f32 v41, v34, v37
    v_mul_f32 v34, v43, v41
    v_mul_f32 v35, v43, v40
    v_fma_f32 v44, v42, v40, -v34
    v_fma_f32 v45, v42, v41, v35
    v_cvt_pkrtz_f16_f32 v34, v42, -v43
    v_cvt_f32_f16 v35, v34
    v_cvt_f32_f16_sdwa v36, v34 dst_sel:DWORD dst_unused:UNUSED_PAD src0_sel:WORD_1
    v_sub_f32 v35, v42, v35
    v_add_f32 v36, v43, v36
    v_sub_f32 v36, 0, v36
    v_cvt_pkrtz_f16_f32 v37, v35, v36
    ds_write_b32 v8, v34 offset:10624
    ds_write_b32 v8, v37 offset:23680
    v_cvt_pkrtz_f16_f32 v34, v44, -v45
    v_cvt_f32_f16 v35, v34
    v_cvt_f32_f16_sdwa v36, v34 dst_sel:DWORD dst_unused:UNUSED_PAD src0_sel:WORD_1
    v_sub_f32 v35, v44, v35
    v_add_f32 v36, v45, v36
    v_sub_f32 v36, 0, v36
    v_cvt_pkrtz_f16_f32 v37, v35, v36
    ds_write_b32 v8, v34 offset:10896
    ds_write_b32 v8, v37 offset:23952
    v_mul_f32 v34, v43, v39
    v_mul_f32 v35, v43, v38
    v_fma_f32 v36, v42, v38, -v34
    v_fma_f32 v43, v42, v39, v35
    v_mov_b32 v42, v36
    v_mul_f32 v34, v45, v39
    v_mul_f32 v35, v45, v38
    v_fma_f32 v36, v44, v38, -v34
    v_fma_f32 v45, v44, v39, v35
    v_mov_b32 v44, v36
    v_cvt_pkrtz_f16_f32 v34, v42, -v43
    v_cvt_f32_f16 v35, v34
    v_cvt_f32_f16_sdwa v36, v34 dst_sel:DWORD dst_unused:UNUSED_PAD src0_sel:WORD_1
    v_sub_f32 v35, v42, v35
    v_add_f32 v36, v43, v36
    v_sub_f32 v36, 0, v36
    v_cvt_pkrtz_f16_f32 v37, v35, v36
    ds_write_b32 v8, v34 offset:11168
    ds_write_b32 v8, v37 offset:24224
    v_cvt_pkrtz_f16_f32 v34, v44, -v45
    v_cvt_f32_f16 v35, v34
    v_cvt_f32_f16_sdwa v36, v34 dst_sel:DWORD dst_unused:UNUSED_PAD src0_sel:WORD_1
    v_sub_f32 v35, v44, v35
    v_add_f32 v36, v45, v36
    v_sub_f32 v36, 0, v36
    v_cvt_pkrtz_f16_f32 v37, v35, v36
    ds_write_b32 v8, v34 offset:11440
    ds_write_b32 v8, v37 offset:24496
    v_mul_f32 v34, v43, v39
    v_mul_f32 v35, v43, v38
    v_fma_f32 v36, v42, v38, -v34
    v_fma_f32 v43, v42, v39, v35
    v_mov_b32 v42, v36
    v_mul_f32 v34, v45, v39
    v_mul_f32 v35, v45, v38
    v_fma_f32 v36, v44, v38, -v34
    v_fma_f32 v45, v44, v39, v35
    v_mov_b32 v44, v36
    v_cvt_pkrtz_f16_f32 v34, v42, -v43
    v_cvt_f32_f16 v35, v34
    v_cvt_f32_f16_sdwa v36, v34 dst_sel:DWORD dst_unused:UNUSED_PAD src0_sel:WORD_1
    v_sub_f32 v35, v42, v35
    v_add_f32 v36, v43, v36
    v_sub_f32 v36, 0, v36
    v_cvt_pkrtz_f16_f32 v37, v35, v36
    ds_write_b32 v8, v34 offset:11712
    ds_write_b32 v8, v37 offset:24768
    v_cvt_pkrtz_f16_f32 v34, v44, -v45
    v_cvt_f32_f16 v35, v34
    v_cvt_f32_f16_sdwa v36, v34 dst_sel:DWORD dst_unused:UNUSED_PAD src0_sel:WORD_1
    v_sub_f32 v35, v44, v35
    v_add_f32 v36, v45, v36
    v_sub_f32 v36, 0, v36
    v_cvt_pkrtz_f16_f32 v37, v35, v36
    ds_write_b32 v8, v34 offset:11984
    ds_write_b32 v8, v37 offset:25040
    v_mul_f32 v34, v43, v39
    v_mul_f32 v35, v43, v38
    v_fma_f32 v36, v42, v38, -v34
    v_fma_f32 v43, v42, v39, v35
    v_mov_b32 v42, v36
    v_mul_f32 v34, v45, v39
    v_mul_f32 v35, v45, v38
    v_fma_f32 v36, v44, v38, -v34
    v_fma_f32 v45, v44, v39, v35
    v_mov_b32 v44, v36
    v_cvt_pkrtz_f16_f32 v34, v42, -v43
    v_cvt_f32_f16 v35, v34
    v_cvt_f32_f16_sdwa v36, v34 dst_sel:DWORD dst_unused:UNUSED_PAD src0_sel:WORD_1
    v_sub_f32 v35, v42, v35
    v_add_f32 v36, v43, v36
    v_sub_f32 v36, 0, v36
    v_cvt_pkrtz_f16_f32 v37, v35, v36
    ds_write_b32 v8, v34 offset:12256
    ds_write_b32 v8, v37 offset:25312
    v_cvt_pkrtz_f16_f32 v34, v44, -v45
    v_cvt_f32_f16 v35, v34
    v_cvt_f32_f16_sdwa v36, v34 dst_sel:DWORD dst_unused:UNUSED_PAD src0_sel:WORD_1
    v_sub_f32 v35, v44, v35
    v_add_f32 v36, v45, v36
    v_sub_f32 v36, 0, v36
    v_cvt_pkrtz_f16_f32 v37, v35, v36
    ds_write_b32 v8, v34 offset:12528
    ds_write_b32 v8, v37 offset:25584
    s_branch L_kg_gen_done_10
L_kg_w_9:
    v_mul_f32 v34, 0x43000000, v30
    v_mul_f32 v35, 0x43000000, v31
    v_exp_f32 v34, v34
    v_fract_f32 v35, v35
    v_cos_f32 v36, v35
    v_sin_f32 v37, v35
    s_nop 0
    v_mul_f32 v38, v34, v36
    v_mul_f32 v39, v34, v37
    v_mul_f32 v34, 0x44800000, v30
    v_mul_f32 v35, 0x44800000, v31
    v_exp_f32 v34, v34
    v_fract_f32 v35, v35
    v_cos_f32 v36, v35
    v_sin_f32 v37, v35
    s_nop 0
    v_mul_f32 v42, v34, v36
    v_mul_f32 v43, v34, v37
    v_mul_f32 v34, v43, v33
    v_mul_f32 v35, v43, v32
    v_fma_f32 v36, v42, v32, -v34
    v_fma_f32 v43, v42, v33, v35
    v_mov_b32 v42, v36
    v_cvt_pkrtz_f16_f32 v34, v42, -v43
    v_cvt_f32_f16 v35, v34
    v_cvt_f32_f16_sdwa v36, v34 dst_sel:DWORD dst_unused:UNUSED_PAD src0_sel:WORD_1
    v_sub_f32 v35, v42, v35
    v_add_f32 v36, v43, v36
    v_sub_f32 v36, 0, v36
    v_cvt_pkrtz_f16_f32 v37, v35, v36
    ds_write_b32 v8, v34 offset:12800
    ds_write_b32 v8, v37 offset:25856
    v_mul_f32 v34, v43, v39
    v_mul_f32 v35, v43, v38
    v_fma_f32 v36, v42, v38, -v34
    v_fma_f32 v43, v42, v39, v35
    v_mov_b32 v42, v36
    v_cvt_pkrtz_f16_f32 v34, v42, -v43
    v_cvt_f32_f16 v35, v34
    v_cvt_f32_f16_sdwa v36, v34 dst_sel:DWORD dst_unused:UNUSED_PAD src0_sel:WORD_1
    v_sub_f32 v35, v42, v35
    v_add_f32 v36, v43, v36
    v_sub_f32 v36, 0, v36
    v_cvt_pkrtz_f16_f32 v37, v35, v36
    ds_write_b32 v8, v34 offset:13072
    ds_write_b32 v8, v37 offset:26128
    v_mul_f32 v34, v43, v39
    v_mul_f32 v35, v43, v38
    v_fma_f32 v36, v42, v38, -v34
    v_fma_f32 v43, v42, v39, v35
    v_mov_b32 v42, v36
    v_cvt_pkrtz_f16_f32 v34, v42, -v43
    v_cvt_f32_f16 v35, v34
    v_cvt_f32_f16_sdwa v36, v34 dst_sel:DWORD dst_unused:UNUSED_PAD src0_sel:WORD_1
    v_sub_f32 v35, v42, v35
    v_add_f32 v36, v43, v36
    v_sub_f32 v36, 0, v36
    v_cvt_pkrtz_f16_f32 v37, v35, v36
    ds_write_b32 v8, v34 offset:13344
    ds_write_b32 v8, v37 offset:26400
    v_mul_f32 v34, v43, v39
    v_mul_f32 v35, v43, v38
    v_fma_f32 v36, v42, v38, -v34
    v_fma_f32 v43, v42, v39, v35
    v_mov_b32 v42, v36
    v_cvt_pkrtz_f16_f32 v34, v42, -v43
    v_cvt_f32_f16 v35, v34
    v_cvt_f32_f16_sdwa v36, v34 dst_sel:DWORD dst_unused:UNUSED_PAD src0_sel:WORD_1
    v_sub_f32 v35, v42, v35
    v_add_f32 v36, v43, v36
    v_sub_f32 v36, 0, v36
    v_cvt_pkrtz_f16_f32 v37, v35, v36
    ds_write_b32 v8, v34 offset:13616
    ds_write_b32 v8, v37 offset:26672
    v_mul_f32 v34, v43, v39
    v_mul_f32 v35, v43, v38
    v_fma_f32 v36, v42, v38, -v34
    v_fma_f32 v43, v42, v39, v35
    v_mov_b32 v42, v36
    v_cvt_pkrtz_f16_f32 v34, v42, -v43
    v_cvt_f32_f16 v35, v34
    v_cvt_f32_f16_sdwa v36, v34 dst_sel:DWORD dst_unused:UNUSED_PAD src0_sel:WORD_1
    v_sub_f32 v35, v42, v35
    v_add_f32 v36, v43, v36
    v_sub_f32 v36, 0, v36
    v_cvt_pkrtz_f16_f32 v37, v35, v36
    ds_write_b32 v8, v34 offset:13888
    ds_write_b32 v8, v37 offset:26944
    v_mul_f32 v34, v43, v39
    v_mul_f32 v35, v43, v38
    v_fma_f32 v36, v42, v38, -v34
    v_fma_f32 v43, v42, v39, v35
    v_mov_b32 v42, v36
    v_cvt_pkrtz_f16_f32 v34, v42, -v43
    v_cvt_f32_f16 v35, v34
    v_cvt_f32_f16_sdwa v36, v34 dst_sel:DWORD dst_unused:UNUSED_PAD src0_sel:WORD_1
    v_sub_f32 v35, v42, v35
    v_add_f32 v36, v43, v36
    v_sub_f32 v36, 0, v36
    v_cvt_pkrtz_f16_f32 v37, v35, v36
    ds_write_b32 v8, v34 offset:14160
    ds_write_b32 v8, v37 offset:27216
    v_mul_f32 v34, v43, v39
    v_mul_f32 v35, v43, v38
    v_fma_f32 v36, v42, v38, -v34
    v_fma_f32 v43, v42, v39, v35
    v_mov_b32 v42, v36
    v_cvt_pkrtz_f16_f32 v34, v42, -v43
    v_cvt_f32_f16 v35, v34
    v_cvt_f32_f16_sdwa v36, v34 dst_sel:DWORD dst_unused:UNUSED_PAD src0_sel:WORD_1
    v_sub_f32 v35, v42, v35
    v_add_f32 v36, v43, v36
    v_sub_f32 v36, 0, v36
    v_cvt_pkrtz_f16_f32 v37, v35, v36
    ds_write_b32 v8, v34 offset:14432
    ds_write_b32 v8, v37 offset:27488
    v_mul_f32 v34, v43, v39
    v_mul_f32 v35, v43, v38
    v_fma_f32 v36, v42, v38, -v34
    v_fma_f32 v43, v42, v39, v35
    v_mov_b32 v42, v36
    v_cvt_pkrtz_f16_f32 v34, v42, -v43
    v_cvt_f32_f16 v35, v34
    v_cvt_f32_f16_sdwa v36, v34 dst_sel:DWORD dst_unused:UNUSED_PAD src0_sel:WORD_1
    v_sub_f32 v35, v42, v35
    v_add_f32 v36, v43, v36
    v_sub_f32 v36, 0, v36
    v_cvt_pkrtz_f16_f32 v37, v35, v36
    ds_write_b32 v8, v34 offset:14704
    ds_write_b32 v8, v37 offset:27760
    v_mul_f32 v34, 0x45000000, v30
    v_mul_f32 v35, 0x45000000, v31
    v_exp_f32 v34, v34
    v_fract_f32 v35, v35
    v_cos_f32 v36, v35
    v_sin_f32 v37, v35
    s_nop 0
    v_mul_f32 v42, v34, v36
    v_mul_f32 v43, v34, v37
    v_mul_f32 v34, v43, v33
    v_mul_f32 v35, v43, v32
    v_fma_f32 v36, v42, v32, -v34
    v_fma_f32 v43, v42, v33, v35
    v_mov_b32 v42, v36
    v_cvt_pkrtz_f16_f32 v34, v42, -v43
    v_cvt_f32_f16 v35, v34
    v_cvt_f32_f16_sdwa v36, v34 dst_sel:DWORD dst_unused:UNUSED_PAD src0_sel:WORD_1
    v_sub_f32 v35, v42, v35
    v_add_f32 v36, v43, v36
    v_sub_f32 v36, 0, v36
    v_cvt_pkrtz_f16_f32 v37, v35, v36
    ds_write_b32 v8, v34 offset:14976
    ds_write_b32 v8, v37 offset:28032
    v_mov_b32 v40, 0
    ds_write_b32 v8, v40 offset:15248
    ds_write_b32 v8, v40 offset:28304
    ds_write_b32 v8, v40 offset:15520
    ds_write_b32 v8, v40 offset:28576
    ds_write_b32 v8, v40 offset:15792
    ds_write_b32 v8, v40 offset:28848
    ds_write_b32 v8, v40 offset:16064
    ds_write_b32 v8, v40 offset:29120
    ds_write_b32 v8, v40 offset:16336
    ds_write_b32 v8, v40 offset:29392
    ds_write_b32 v8, v40 offset:16608
    ds_write_b32 v8, v40 offset:29664
    ds_write_b32 v8, v40 offset:16880
    ds_write_b32 v8, v40 offset:29936
L_kg_gen_done_10:
    s_waitcnt lgkmcnt(0)
    s_barrier
    s_cmp_eq_u32 s42, 3
    s_cbranch_scc1 L_kg_skip_11
    v_and_b32 v60, 15, v2
    v_lshrrev_b32 v61, 4, v2
    v_mul_u32_u24 v62, 272, v60
    v_lshl_add_u32 v62, v61, 4, v62
    s_mul_i32 s48, s42, 4352
    v_add_u32 v63, s48, v62
    ds_read_b128 v[64:67], v63 offset:4096
    ds_read_b128 v[68:71], v63 offset:17152
    ds_read_b128 v[72:75], v62 offset:30208
    ds_read_b128 v[76:79], v62 offset:34560
    s_waitcnt lgkmcnt(0)
    v_mfma_f32_16x16x32_f16 v[24:27], v[64:67], v[72:75], v[24:27]
    v_mfma_f32_16x16x32_f16 v[24:27], v[64:67], v[76:79], v[24:27]
    v_mfma_f32_16x16x32_f16 v[24:27], v[68:71], v[72:75], v[24:27]
    ds_read_b128 v[64:67], v63 offset:4160
    ds_read_b128 v[68:71], v63 offset:17216
    ds_read_b128 v[72:75], v62 offset:30272
    ds_read_b128 v[76:79], v62 offset:34624
    s_waitcnt lgkmcnt(0)
    v_mfma_f32_16x16x32_f16 v[24:27], v[64:67], v[72:75], v[24:27]
    v_mfma_f32_16x16x32_f16 v[24:27], v[64:67], v[76:79], v[24:27]
    v_mfma_f32_16x16x32_f16 v[24:27], v[68:71], v[72:75], v[24:27]
    ds_read_b128 v[64:67], v63 offset:4224
    ds_read_b128 v[68:71], v63 offset:17280
    ds_read_b128 v[72:75], v62 offset:30336
    ds_read_b128 v[76:79], v62 offset:34688
    s_waitcnt lgkmcnt(0)
    v_mfma_f32_16x16x32_f16 v[24:27], v[64:67], v[72:75], v[24:27]
    v_mfma_f32_16x16x32_f16 v[24:27], v[64:67], v[76:79], v[24:27]
    v_mfma_f32_16x16x32_f16 v[24:27], v[68:71], v[72:75], v[24:27]
    ds_read_b128 v[64:67], v63 offset:4288
    ds_read_b128 v[68:71], v63 offset:17344
    ds_read_b128 v[72:75], v62 offset:30400
    ds_read_b128 v[76:79], v62 offset:34752
    s_waitcnt lgkmcnt(0)
    v_mfma_f32_16x16x32_f16 v[24:27], v[64:67], v[72:75], v[24:27]
    v_mfma_f32_16x16x32_f16 v[24:27], v[64:67], v[76:79], v[24:27]
    v_mfma_f32_16x16x32_f16 v[24:27], v[68:71], v[72:75], v[24:27]
L_kg_skip_11:
    s_barrier
    s_add_u32 s46, s46, 1
    s_cmp_lt_u32 s46, 3
    s_cbranch_scc1 L_kg_loop_5
    s_cmp_eq_u32 s42, 3
    s_cbranch_scc1 L_kg_out_end_12
    s_nop 7
    s_nop 7
    s_mul_i32 s49, s2, 2592
    s_cmp_eq_u32 s42, 1
    s_cbranch_scc1 L_kg_t1_13
    s_cmp_eq_u32 s42, 2
    s_cbranch_scc1 L_kg_t2_14
    v_and_b32 v64, 1, v61
    v_lshlrev_b32 v64, 2, v64
    v_lshl_add_u32 v64, v60, 3, v64
    v_lshrrev_b32 v65, 1, v61
    v_lshl_add_u32 v64, v65, 7, v64
    v_add_u32 v70, 0, v64
    v_add_u32 v71, 1, v64
    v_add_u32 v72, 2, v64
    v_add_u32 v73, 3, v64
    s_branch L_kg_st_15
L_kg_t1_13:
    v_lshlrev_b32 v64, 2, v60
    v_lshl_add_u32 v64, v61, 6, v64
    v_add_u32 v64, 256, v64
    v_lshlrev_b32 v65, 1, v60
    v_subrev_u32 v66, 2, v61
    v_lshl_add_u32 v65, v66, 6, v65
    v_add_u32 v65, 384, v65
    v_cmp_gt_u32 vcc, 2, v61
    v_add_u32 v70, 0, v64
    v_add_u32 v74, 0, v65
    v_add_u32 v71, 1, v64
    v_add_u32 v75, 1, v65
    v_add_u32 v72, 2, v64
    v_add_u32 v76, 32, v65
    v_add_u32 v73, 3, v64
    v_add_u32 v77, 33, v65
    s_nop 1
    v_cndmask_b32 v70, v74, v70, vcc
    v_cndmask_b32 v71, v75, v71, vcc
    v_cndmask_b32 v72, v76, v72, vcc
    v_cndmask_b32 v73, v77, v73, vcc
    s_branch L_kg_st_15
L_kg_t2_14:
    v_lshlrev_b32 v64, 6, v61
    v_add_u32 v64, v64, v60
    v_add_u32 v64, 512, v64
    v_mov_b32 v65, 644
    v_cmp_gt_u32 vcc, 2, v61
    v_add_u32 v74, 0, v64
    v_add_u32 v75, 16, v64
    v_add_u32 v76, 32, v64
    v_add_u32 v77, 48, v64
    s_nop 1
    v_cndmask_b32 v70, v65, v74, vcc
    v_cndmask_b32 v71, v65, v75, vcc
    v_cndmask_b32 v72, v65, v76, vcc
    v_cndmask_b32 v73, v65, v77, vcc
    v_cmp_eq_u32 vcc, 32, v2
    v_mov_b32 v66, 640
    s_nop 1
    v_cndmask_b32 v70, v70, v66, vcc
L_kg_st_15:
    v_lshlrev_b32 v70, 2, v70
    v_mul_f32 v24, v24, v23
    v_lshlrev_b32 v71, 2, v71
    v_mul_f32 v25, v25, v23
    v_lshlrev_b32 v72, 2, v72
    v_mul_f32 v26, v26, v23
    v_lshlrev_b32 v73, 2, v73
    v_mul_f32 v27, v27, v23
    buffer_store_dword v24, v70, s[36:39], s49 offen
    buffer_store_dword v25, v71, s[36:39], s49 offen
    buffer_store_dword v26, v72, s[36:39], s49 offen
    buffer_store_dword v27, v73, s[36:39], s49 offen
L_kg_out_end_12:
    s_endpgm
L_ln1_2:
    s_load_dwordx2 s[4:5], s[0:1], 0
    s_load_dwordx2 s[6:7], s[0:1], 112
    s_waitcnt lgkmcnt(0)
    s_mov_b32 s8, s4
    s_mov_b32 s9, s5
    s_mov_b32 s10, 0x280000
    s_mov_b32 s11, 0x00020000
    s_mov_b32 s12, s6
    s_mov_b32 s13, s7
    s_mov_b32 s14, 0x280000
    s_mov_b32 s15, 0x00020000
    s_sub_u32 s16, s2, 640
    s_mul_i32 s17, s16, 20480
    v_and_b32 v1, 63, v0
    v_lshrrev_b32 v2, 6, v0
    v_mul_u32_u24 v3, 5120, v2
    v_lshl_add_u32 v3, v1, 2, v3
    s_add_u32 s20, s17, 0
    s_add_u32 s21, s17, 1280
    s_add_u32 s22, s17, 2560
    s_add_u32 s23, s17, 3840
    buffer_load_dword v10, v3, s[8:11], s20 offen offset:0
    buffer_load_dword v11, v3, s[8:11], s20 offen offset:256
    buffer_load_dword v12, v3, s[8:11], s20 offen offset:512
    buffer_load_dword v13, v3, s[8:11], s20 offen offset:768
    buffer_load_dword v14, v3, s[8:11], s20 offen offset:1024
    buffer_load_dword v15, v3, s[8:11], s21 offen offset:0
    buffer_load_dword v16, v3, s[8:11], s21 offen offset:256
    buffer_load_dword v17, v3, s[8:11], s21 offen offset:512
    buffer_load_dword v18, v3, s[8:11], s21 offen offset:768
    buffer_load_dword v19, v3, s[8:11], s21 offen offset:1024
    buffer_load_dword v20, v3, s[8:11], s22 offen offset:0
    buffer_load_dword v21, v3, s[8:11], s22 offen offset:256
    buffer_load_dword v22, v3, s[8:11], s22 offen offset:512
    buffer_load_dword v23, v3, s[8:11], s22 offen offset:768
    buffer_load_dword v24, v3, s[8:11], s22 offen offset:1024
    buffer_load_dword v25, v3, s[8:11], s23 offen offset:0
    buffer_load_dword v26, v3, s[8:11], s23 offen offset:256
    buffer_load_dword v27, v3, s[8:11], s23 offen offset:512
    buffer_load_dword v28, v3, s[8:11], s23 offen offset:768
    buffer_load_dword v29, v3, s[8:11], s23 offen offset:1024
    s_waitcnt vmcnt(0)
    v_lshlrev_b32 v30, 16, v10
    v_and_b32 v31, 0xffff0000, v10
    v_lshlrev_b32 v32, 16, v11
    v_and_b32 v33, 0xffff0000, v11
    v_lshlrev_b32 v34, 16, v12
    v_and_b32 v35, 0xffff0000, v12
    v_lshlrev_b32 v36, 16, v13
    v_and_b32 v37, 0xffff0000, v13
    v_lshlrev_b32 v38, 16, v14
    v_and_b32 v39, 0xffff0000, v14
    v_lshlrev_b32 v40, 16, v15
    v_and_b32 v41, 0xffff0000, v15
    v_lshlrev_b32 v42, 16, v16
    v_and_b32 v43, 0xffff0000, v16
    v_lshlrev_b32 v44, 16, v17
    v_and_b32 v45, 0xffff0000, v17
    v_lshlrev_b32 v46, 16, v18
    v_and_b32 v47, 0xffff0000, v18
    v_lshlrev_b32 v48, 16, v19
    v_and_b32 v49, 0xffff0000, v19
    v_lshlrev_b32 v50, 16, v20
    v_and_b32 v51, 0xffff0000, v20
    v_lshlrev_b32 v52, 16, v21
    v_and_b32 v53, 0xffff0000, v21
    v_lshlrev_b32 v54, 16, v22
    v_and_b32 v55, 0xffff0000, v22
    v_lshlrev_b32 v56, 16, v23
    v_and_b32 v57, 0xffff0000, v23
    v_lshlrev_b32 v58, 16, v24
    v_and_b32 v59, 0xffff0000, v24
    v_lshlrev_b32 v60, 16, v25
    v_and_b32 v61, 0xffff0000, v25
    v_lshlrev_b32 v62, 16, v26
    v_and_b32 v63, 0xffff0000, v26
    v_lshlrev_b32 v64, 16, v27
    v_and_b32 v65, 0xffff0000, v27
    v_lshlrev_b32 v66, 16, v28
    v_and_b32 v67, 0xffff0000, v28
    v_lshlrev_b32 v68, 16, v29
    v_and_b32 v69, 0xffff0000, v29
    v_mov_b32 v9, 0x3acccccd
    v_add_f32 v70, v30, v31
    v_add_f32 v71, v40, v41
    v_add_f32 v72, v50, v51
    v_add_f32 v73, v60, v61
    v_add_f32 v70, v70, v32
    v_add_f32 v71, v71, v42
    v_add_f32 v72, v72, v52
    v_add_f32 v73, v73, v62
    v_add_f32 v70, v70, v33
    v_add_f32 v71, v71, v43
    v_add_f32 v72, v72, v53
    v_add_f32 v73, v73, v63
    v_add_f32 v70, v70, v34
    v_add_f32 v71, v71, v44
    v_add_f32 v72, v72, v54
    v_add_f32 v73, v73, v64
    v_add_f32 v70, v70, v35
    v_add_f32 v71, v71, v45
    v_add_f32 v72, v72, v55
    v_add_f32 v73, v73, v65
    v_add_f32 v70, v70, v36
    v_add_f32 v71, v71, v46
    v_add_f32 v72, v72, v56
    v_add_f32 v73, v73, v66
    v_add_f32 v70, v70, v37
    v_add_f32 v71, v71, v47
    v_add_f32 v72, v72, v57
    v_add_f32 v73, v73, v67
    v_add_f32 v70, v70, v38
    v_add_f32 v71, v71, v48
    v_add_f32 v72, v72, v58
    v_add_f32 v73, v73, v68
    v_add_f32 v70, v70, v39
    v_add_f32 v71, v71, v49
    v_add_f32 v72, v72, v59
    v_add_f32 v73, v73, v69
    s_nop 1
    v_add_f32_dpp v70, v70, v70 row_shr:1 row_mask:0xf bank_mask:0xf
    v_add_f32_dpp v71, v71, v71 row_shr:1 row_mask:0xf bank_mask:0xf
    v_add_f32_dpp v72, v72, v72 row_shr:1 row_mask:0xf bank_mask:0xf
    v_add_f32_dpp v73, v73, v73 row_shr:1 row_mask:0xf bank_mask:0xf
    v_add_f32_dpp v70, v70, v70 row_shr:2 row_mask:0xf bank_mask:0xf
    v_add_f32_dpp v71, v71, v71 row_shr:2 row_mask:0xf bank_mask:0xf
    v_add_f32_dpp v72, v72, v72 row_shr:2 row_mask:0xf bank_mask:0xf
    v_add_f32_dpp v73, v73, v73 row_shr:2 row_mask:0xf bank_mask:0xf
    v_add_f32_dpp v70, v70, v70 row_shr:4 row_mask:0xf bank_mask:0xf
    v_add_f32_dpp v71, v71, v71 row_shr:4 row_mask:0xf bank_mask:0xf
    v_add_f32_dpp v72, v72, v72 row_shr:4 row_mask:0xf bank_mask:0xf
    v_add_f32_dpp v73, v73, v73 row_shr:4 row_mask:0xf bank_mask:0xf
    v_add_f32_dpp v70, v70, v70 row_shr:8 row_mask:0xf bank_mask:0xf
    v_add_f32_dpp v71, v71, v71 row_shr:8 row_mask:0xf bank_mask:0xf
    v_add_f32_dpp v72, v72, v72 row_shr:8 row_mask:0xf bank_mask:0xf
    v_add_f32_dpp v73, v73, v73 row_shr:8 row_mask:0xf bank_mask:0xf
    v_add_f32_dpp v70, v70, v70 row_bcast:15 row_mask:0xa bank_mask:0xf
    v_add_f32_dpp v71, v71, v71 row_bcast:15 row_mask:0xa bank_mask:0xf
    v_add_f32_dpp v72, v72, v72 row_bcast:15 row_mask:0xa bank_mask:0xf
    v_add_f32_dpp v73, v73, v73 row_bcast:15 row_mask:0xa bank_mask:0xf
    v_add_f32_dpp v70, v70, v70 row_bcast:31 row_mask:0xc bank_mask:0xf
    v_add_f32_dpp v71, v71, v71 row_bcast:31 row_mask:0xc bank_mask:0xf
    v_add_f32_dpp v72, v72, v72 row_bcast:31 row_mask:0xc bank_mask:0xf
    v_add_f32_dpp v73, v73, v73 row_bcast:31 row_mask:0xc bank_mask:0xf
    s_nop 1
    v_readlane_b32 s24, v70, 63
    v_readlane_b32 s25, v71, 63
    v_readlane_b32 s26, v72, 63
    v_readlane_b32 s27, v73, 63
    s_nop 1
    v_mul_f32 v74, s24, v9
    v_mul_f32 v75, s25, v9
    v_mul_f32 v76, s26, v9
    v_mul_f32 v77, s27, v9
    v_mov_b32 v70, 0
    v_mov_b32 v71, 0
    v_mov_b32 v72, 0
    v_mov_b32 v73, 0
    v_sub_f32 v78, v30, v74
    v_sub_f32 v79, v40, v75
    v_sub_f32 v80, v50, v76
    v_sub_f32 v81, v60, v77
    v_fmac_f32 v70, v78, v78
    v_fmac_f32 v71, v79, v79
    v_fmac_f32 v72, v80, v80
    v_fmac_f32 v73, v81, v81
    v_sub_f32 v78, v31, v74
    v_sub_f32 v79, v41, v75
    v_sub_f32 v80, v51, v76
    v_sub_f32 v81, v61, v77
    v_fmac_f32 v70, v78, v78
    v_fmac_f32 v71, v79, v79
    v_fmac_f32 v72, v80, v80
    v_fmac_f32 v73, v81, v81
    v_sub_f32 v78, v32, v74
    v_sub_f32 v79, v42, v75
    v_sub_f32 v80, v52, v76
    v_sub_f32 v81, v62, v77
    v_fmac_f32 v70, v78, v78
    v_fmac_f32 v71, v79, v79
    v_fmac_f32 v72, v80, v80
    v_fmac_f32 v73, v81, v81
    v_sub_f32 v78, v33, v74
    v_sub_f32 v79, v43, v75
    v_sub_f32 v80, v53, v76
    v_sub_f32 v81, v63, v77
    v_fmac_f32 v70, v78, v78
    v_fmac_f32 v71, v79, v79
    v_fmac_f32 v72, v80, v80
    v_fmac_f32 v73, v81, v81
    v_sub_f32 v78, v34, v74
    v_sub_f32 v79, v44, v75
    v_sub_f32 v80, v54, v76
    v_sub_f32 v81, v64, v77
    v_fmac_f32 v70, v78, v78
    v_fmac_f32 v71, v79, v79
    v_fmac_f32 v72, v80, v80
    v_fmac_f32 v73, v81, v81
    v_sub_f32 v78, v35, v74
    v_sub_f32 v79, v45, v75
    v_sub_f32 v80, v55, v76
    v_sub_f32 v81, v65, v77
    v_fmac_f32 v70, v78, v78
    v_fmac_f32 v71, v79, v79
    v_fmac_f32 v72, v80, v80
    v_fmac_f32 v73, v81, v81
    v_sub_f32 v78, v36, v74
    v_sub_f32 v79, v46, v75
    v_sub_f32 v80, v56, v76
    v_sub_f32 v81, v66, v77
    v_fmac_f32 v70, v78, v78
    v_fmac_f32 v71, v79, v79
    v_fmac_f32 v72, v80, v80
    v_fmac_f32 v73, v81, v81
    v_sub_f32 v78, v37, v74
    v_sub_f32 v79, v47, v75
    v_sub_f32 v80, v57, v76
    v_sub_f32 v81, v67, v77
    v_fmac_f32 v70, v78, v78
    v_fmac_f32 v71, v79, v79
    v_fmac_f32 v72, v80, v80
    v_fmac_f32 v73, v81, v81
    v_sub_f32 v78, v38, v74
    v_sub_f32 v79, v48, v75
    v_sub_f32 v80, v58, v76
    v_sub_f32 v81, v68, v77
    v_fmac_f32 v70, v78, v78
    v_fmac_f32 v71, v79, v79
    v_fmac_f32 v72, v80, v80
    v_fmac_f32 v73, v81, v81
    v_sub_f32 v78, v39, v74
    v_sub_f32 v79, v49, v75
    v_sub_f32 v80, v59, v76
    v_sub_f32 v81, v69, v77
    v_fmac_f32 v70, v78, v78
    v_fmac_f32 v71, v79, v79
    v_fmac_f32 v72, v80, v80
    v_fmac_f32 v73, v81, v81
    s_nop 1
    v_add_f32_dpp v70, v70, v70 row_shr:1 row_mask:0xf bank_mask:0xf
    v_add_f32_dpp v71, v71, v71 row_shr:1 row_mask:0xf bank_mask:0xf
    v_add_f32_dpp v72, v72, v72 row_shr:1 row_mask:0xf bank_mask:0xf
    v_add_f32_dpp v73, v73, v73 row_shr:1 row_mask:0xf bank_mask:0xf
    v_add_f32_dpp v70, v70, v70 row_shr:2 row_mask:0xf bank_mask:0xf
    v_add_f32_dpp v71, v71, v71 row_shr:2 row_mask:0xf bank_mask:0xf
    v_add_f32_dpp v72, v72, v72 row_shr:2 row_mask:0xf bank_mask:0xf
    v_add_f32_dpp v73, v73, v73 row_shr:2 row_mask:0xf bank_mask:0xf
    v_add_f32_dpp v70, v70, v70 row_shr:4 row_mask:0xf bank_mask:0xf
    v_add_f32_dpp v71, v71, v71 row_shr:4 row_mask:0xf bank_mask:0xf
    v_add_f32_dpp v72, v72, v72 row_shr:4 row_mask:0xf bank_mask:0xf
    v_add_f32_dpp v73, v73, v73 row_shr:4 row_mask:0xf bank_mask:0xf
    v_add_f32_dpp v70, v70, v70 row_shr:8 row_mask:0xf bank_mask:0xf
    v_add_f32_dpp v71, v71, v71 row_shr:8 row_mask:0xf bank_mask:0xf
    v_add_f32_dpp v72, v72, v72 row_shr:8 row_mask:0xf bank_mask:0xf
    v_add_f32_dpp v73, v73, v73 row_shr:8 row_mask:0xf bank_mask:0xf
    v_add_f32_dpp v70, v70, v70 row_bcast:15 row_mask:0xa bank_mask:0xf
    v_add_f32_dpp v71, v71, v71 row_bcast:15 row_mask:0xa bank_mask:0xf
    v_add_f32_dpp v72, v72, v72 row_bcast:15 row_mask:0xa bank_mask:0xf
    v_add_f32_dpp v73, v73, v73 row_bcast:15 row_mask:0xa bank_mask:0xf
    v_add_f32_dpp v70, v70, v70 row_bcast:31 row_mask:0xc bank_mask:0xf
    v_add_f32_dpp v71, v71, v71 row_bcast:31 row_mask:0xc bank_mask:0xf
    v_add_f32_dpp v72, v72, v72 row_bcast:31 row_mask:0xc bank_mask:0xf
    v_add_f32_dpp v73, v73, v73 row_bcast:31 row_mask:0xc bank_mask:0xf
    s_nop 1
    v_readlane_b32 s24, v70, 63
    v_readlane_b32 s25, v71, 63
    v_readlane_b32 s26, v72, 63
    v_readlane_b32 s27, v73, 63
    s_nop 1
    v_mul_f32 v82, s24, v9
    v_mul_f32 v83, s25, v9
    v_mul_f32 v84, s26, v9
    v_mul_f32 v85, s27, v9
    v_mov_b32 v8, 0x3727c5ac
    v_cvt_pk_bf16_f32 v74, v74, v74
    v_lshlrev_b32 v74, 16, v74
    v_cvt_pk_bf16_f32 v75, v75, v75
    v_lshlrev_b32 v75, 16, v75
    v_cvt_pk_bf16_f32 v76, v76, v76
    v_lshlrev_b32 v76, 16, v76
    v_cvt_pk_bf16_f32 v77, v77, v77
    v_lshlrev_b32 v77, 16, v77
    v_cvt_pk_bf16_f32 v82, v82, v82
    v_lshlrev_b32 v82, 16, v82
    v_cvt_pk_bf16_f32 v83, v83, v83
    v_lshlrev_b32 v83, 16, v83
    v_cvt_pk_bf16_f32 v84, v84, v84
    v_lshlrev_b32 v84, 16, v84
    v_cvt_pk_bf16_f32 v85, v85, v85
    v_lshlrev_b32 v85, 16, v85
    v_add_f32 v82, v82, v8
    v_add_f32 v83, v83, v8
    v_add_f32 v84, v84, v8
    v_add_f32 v85, v85, v8
    v_cvt_pk_bf16_f32 v82, v82, v82
    v_lshlrev_b32 v82, 16, v82
    v_cvt_pk_bf16_f32 v83, v83, v83
    v_lshlrev_b32 v83, 16, v83
    v_cvt_pk_bf16_f32 v84, v84, v84
    v_lshlrev_b32 v84, 16, v84
    v_cvt_pk_bf16_f32 v85, v85, v85
    v_lshlrev_b32 v85, 16, v85
    v_sqrt_f32 v82, v82
    v_sqrt_f32 v83, v83
    v_sqrt_f32 v84, v84
    v_sqrt_f32 v85, v85
    s_nop 0
    v_cvt_pk_bf16_f32 v82, v82, v82
    v_lshlrev_b32 v82, 16, v82
    v_cvt_pk_bf16_f32 v83, v83, v83
    v_lshlrev_b32 v83, 16, v83
    v_cvt_pk_bf16_f32 v84, v84, v84
    v_lshlrev_b32 v84, 16, v84
    v_cvt_pk_bf16_f32 v85, v85, v85
    v_lshlrev_b32 v85, 16, v85
    v_rcp_f32 v86, v82
    v_rcp_f32 v87, v83
    v_rcp_f32 v88, v84
    v_rcp_f32 v89, v85
    s_nop 0
    v_sub_f32 v30, v30, v74
    v_sub_f32 v40, v40, v75
    v_sub_f32 v50, v50, v76
    v_sub_f32 v60, v60, v77
    v_cvt_pk_bf16_f32 v30, v30, v30
    v_lshlrev_b32 v30, 16, v30
    v_cvt_pk_bf16_f32 v40, v40, v40
    v_lshlrev_b32 v40, 16, v40
    v_cvt_pk_bf16_f32 v50, v50, v50
    v_lshlrev_b32 v50, 16, v50
    v_cvt_pk_bf16_f32 v60, v60, v60
    v_lshlrev_b32 v60, 16, v60
    v_mul_f32 v78, v30, v86
    v_mul_f32 v79, v40, v87
    v_mul_f32 v80, v50, v88
    v_mul_f32 v81, v60, v89
    v_fma_f32 v30, -v78, v82, v30
    v_fma_f32 v40, -v79, v83, v40
    v_fma_f32 v50, -v80, v84, v50
    v_fma_f32 v60, -v81, v85, v60
    v_fma_f32 v30, v30, v86, v78
    v_fma_f32 v40, v40, v87, v79
    v_fma_f32 v50, v50, v88, v80
    v_fma_f32 v60, v60, v89, v81
    v_sub_f32 v31, v31, v74
    v_sub_f32 v41, v41, v75
    v_sub_f32 v51, v51, v76
    v_sub_f32 v61, v61, v77
    v_cvt_pk_bf16_f32 v31, v31, v31
    v_lshlrev_b32 v31, 16, v31
    v_cvt_pk_bf16_f32 v41, v41, v41
    v_lshlrev_b32 v41, 16, v41
    v_cvt_pk_bf16_f32 v51, v51, v51
    v_lshlrev_b32 v51, 16, v51
    v_cvt_pk_bf16_f32 v61, v61, v61
    v_lshlrev_b32 v61, 16, v61
    v_mul_f32 v78, v31, v86
    v_mul_f32 v79, v41, v87
    v_mul_f32 v80, v51, v88
    v_mul_f32 v81, v61, v89
    v_fma_f32 v31, -v78, v82, v31
    v_fma_f32 v41, -v79, v83, v41
    v_fma_f32 v51, -v80, v84, v51
    v_fma_f32 v61, -v81, v85, v61
    v_fma_f32 v31, v31, v86, v78
    v_fma_f32 v41, v41, v87, v79
    v_fma_f32 v51, v51, v88, v80
    v_fma_f32 v61, v61, v89, v81
    v_sub_f32 v32, v32, v74
    v_sub_f32 v42, v42, v75
    v_sub_f32 v52, v52, v76
    v_sub_f32 v62, v62, v77
    v_cvt_pk_bf16_f32 v32, v32, v32
    v_lshlrev_b32 v32, 16, v32
    v_cvt_pk_bf16_f32 v42, v42, v42
    v_lshlrev_b32 v42, 16, v42
    v_cvt_pk_bf16_f32 v52, v52, v52
    v_lshlrev_b32 v52, 16, v52
    v_cvt_pk_bf16_f32 v62, v62, v62
    v_lshlrev_b32 v62, 16, v62
    v_mul_f32 v78, v32, v86
    v_mul_f32 v79, v42, v87
    v_mul_f32 v80, v52, v88
    v_mul_f32 v81, v62, v89
    v_fma_f32 v32, -v78, v82, v32
    v_fma_f32 v42, -v79, v83, v42
    v_fma_f32 v52, -v80, v84, v52
    v_fma_f32 v62, -v81, v85, v62
    v_fma_f32 v32, v32, v86, v78
    v_fma_f32 v42, v42, v87, v79
    v_fma_f32 v52, v52, v88, v80
    v_fma_f32 v62, v62, v89, v81
    v_sub_f32 v33, v33, v74
    v_sub_f32 v43, v43, v75
    v_sub_f32 v53, v53, v76
    v_sub_f32 v63, v63, v77
    v_cvt_pk_bf16_f32 v33, v33, v33
    v_lshlrev_b32 v33, 16, v33
    v_cvt_pk_bf16_f32 v43, v43, v43
    v_lshlrev_b32 v43, 16, v43
    v_cvt_pk_bf16_f32 v53, v53, v53
    v_lshlrev_b32 v53, 16, v53
    v_cvt_pk_bf16_f32 v63, v63, v63
    v_lshlrev_b32 v63, 16, v63
    v_mul_f32 v78, v33, v86
    v_mul_f32 v79, v43, v87
    v_mul_f32 v80, v53, v88
    v_mul_f32 v81, v63, v89
    v_fma_f32 v33, -v78, v82, v33
    v_fma_f32 v43, -v79, v83, v43
    v_fma_f32 v53, -v80, v84, v53
    v_fma_f32 v63, -v81, v85, v63
    v_fma_f32 v33, v33, v86, v78
    v_fma_f32 v43, v43, v87, v79
    v_fma_f32 v53, v53, v88, v80
    v_fma_f32 v63, v63, v89, v81
    v_sub_f32 v34, v34, v74
    v_sub_f32 v44, v44, v75
    v_sub_f32 v54, v54, v76
    v_sub_f32 v64, v64, v77
    v_cvt_pk_bf16_f32 v34, v34, v34
    v_lshlrev_b32 v34, 16, v34
    v_cvt_pk_bf16_f32 v44, v44, v44
    v_lshlrev_b32 v44, 16, v44
    v_cvt_pk_bf16_f32 v54, v54, v54
    v_lshlrev_b32 v54, 16, v54
    v_cvt_pk_bf16_f32 v64, v64, v64
    v_lshlrev_b32 v64, 16, v64
    v_mul_f32 v78, v34, v86
    v_mul_f32 v79, v44, v87
    v_mul_f32 v80, v54, v88
    v_mul_f32 v81, v64, v89
    v_fma_f32 v34, -v78, v82, v34
    v_fma_f32 v44, -v79, v83, v44
    v_fma_f32 v54, -v80, v84, v54
    v_fma_f32 v64, -v81, v85, v64
    v_fma_f32 v34, v34, v86, v78
    v_fma_f32 v44, v44, v87, v79
    v_fma_f32 v54, v54, v88, v80
    v_fma_f32 v64, v64, v89, v81
    v_sub_f32 v35, v35, v74
    v_sub_f32 v45, v45, v75
    v_sub_f32 v55, v55, v76
    v_sub_f32 v65, v65, v77
    v_cvt_pk_bf16_f32 v35, v35, v35
    v_lshlrev_b32 v35, 16, v35
    v_cvt_pk_bf16_f32 v45, v45, v45
    v_lshlrev_b32 v45, 16, v45
    v_cvt_pk_bf16_f32 v55, v55, v55
    v_lshlrev_b32 v55, 16, v55
    v_cvt_pk_bf16_f32 v65, v65, v65
    v_lshlrev_b32 v65, 16, v65
    v_mul_f32 v78, v35, v86
    v_mul_f32 v79, v45, v87
    v_mul_f32 v80, v55, v88
    v_mul_f32 v81, v65, v89
    v_fma_f32 v35, -v78, v82, v35
    v_fma_f32 v45, -v79, v83, v45
    v_fma_f32 v55, -v80, v84, v55
    v_fma_f32 v65, -v81, v85, v65
    v_fma_f32 v35, v35, v86, v78
    v_fma_f32 v45, v45, v87, v79
    v_fma_f32 v55, v55, v88, v80
    v_fma_f32 v65, v65, v89, v81
    v_sub_f32 v36, v36, v74
    v_sub_f32 v46, v46, v75
    v_sub_f32 v56, v56, v76
    v_sub_f32 v66, v66, v77
    v_cvt_pk_bf16_f32 v36, v36, v36
    v_lshlrev_b32 v36, 16, v36
    v_cvt_pk_bf16_f32 v46, v46, v46
    v_lshlrev_b32 v46, 16, v46
    v_cvt_pk_bf16_f32 v56, v56, v56
    v_lshlrev_b32 v56, 16, v56
    v_cvt_pk_bf16_f32 v66, v66, v66
    v_lshlrev_b32 v66, 16, v66
    v_mul_f32 v78, v36, v86
    v_mul_f32 v79, v46, v87
    v_mul_f32 v80, v56, v88
    v_mul_f32 v81, v66, v89
    v_fma_f32 v36, -v78, v82, v36
    v_fma_f32 v46, -v79, v83, v46
    v_fma_f32 v56, -v80, v84, v56
    v_fma_f32 v66, -v81, v85, v66
    v_fma_f32 v36, v36, v86, v78
    v_fma_f32 v46, v46, v87, v79
    v_fma_f32 v56, v56, v88, v80
    v_fma_f32 v66, v66, v89, v81
    v_sub_f32 v37, v37, v74
    v_sub_f32 v47, v47, v75
    v_sub_f32 v57, v57, v76
    v_sub_f32 v67, v67, v77
    v_cvt_pk_bf16_f32 v37, v37, v37
    v_lshlrev_b32 v37, 16, v37
    v_cvt_pk_bf16_f32 v47, v47, v47
    v_lshlrev_b32 v47, 16, v47
    v_cvt_pk_bf16_f32 v57, v57, v57
    v_lshlrev_b32 v57, 16, v57
    v_cvt_pk_bf16_f32 v67, v67, v67
    v_lshlrev_b32 v67, 16, v67
    v_mul_f32 v78, v37, v86
    v_mul_f32 v79, v47, v87
    v_mul_f32 v80, v57, v88
    v_mul_f32 v81, v67, v89
    v_fma_f32 v37, -v78, v82, v37
    v_fma_f32 v47, -v79, v83, v47
    v_fma_f32 v57, -v80, v84, v57
    v_fma_f32 v67, -v81, v85, v67
    v_fma_f32 v37, v37, v86, v78
    v_fma_f32 v47, v47, v87, v79
    v_fma_f32 v57, v57, v88, v80
    v_fma_f32 v67, v67, v89, v81
    v_sub_f32 v38, v38, v74
    v_sub_f32 v48, v48, v75
    v_sub_f32 v58, v58, v76
    v_sub_f32 v68, v68, v77
    v_cvt_pk_bf16_f32 v38, v38, v38
    v_lshlrev_b32 v38, 16, v38
    v_cvt_pk_bf16_f32 v48, v48, v48
    v_lshlrev_b32 v48, 16, v48
    v_cvt_pk_bf16_f32 v58, v58, v58
    v_lshlrev_b32 v58, 16, v58
    v_cvt_pk_bf16_f32 v68, v68, v68
    v_lshlrev_b32 v68, 16, v68
    v_mul_f32 v78, v38, v86
    v_mul_f32 v79, v48, v87
    v_mul_f32 v80, v58, v88
    v_mul_f32 v81, v68, v89
    v_fma_f32 v38, -v78, v82, v38
    v_fma_f32 v48, -v79, v83, v48
    v_fma_f32 v58, -v80, v84, v58
    v_fma_f32 v68, -v81, v85, v68
    v_fma_f32 v38, v38, v86, v78
    v_fma_f32 v48, v48, v87, v79
    v_fma_f32 v58, v58, v88, v80
    v_fma_f32 v68, v68, v89, v81
    v_sub_f32 v39, v39, v74
    v_sub_f32 v49, v49, v75
    v_sub_f32 v59, v59, v76
    v_sub_f32 v69, v69, v77
    v_cvt_pk_bf16_f32 v39, v39, v39
    v_lshlrev_b32 v39, 16, v39
    v_cvt_pk_bf16_f32 v49, v49, v49
    v_lshlrev_b32 v49, 16, v49
    v_cvt_pk_bf16_f32 v59, v59, v59
    v_lshlrev_b32 v59, 16, v59
    v_cvt_pk_bf16_f32 v69, v69, v69
    v_lshlrev_b32 v69, 16, v69
    v_mul_f32 v78, v39, v86
    v_mul_f32 v79, v49, v87
    v_mul_f32 v80, v59, v88
    v_mul_f32 v81, v69, v89
    v_fma_f32 v39, -v78, v82, v39
    v_fma_f32 v49, -v79, v83, v49
    v_fma_f32 v59, -v80, v84, v59
    v_fma_f32 v69, -v81, v85, v69
    v_fma_f32 v39, v39, v86, v78
    v_fma_f32 v49, v49, v87, v79
    v_fma_f32 v59, v59, v88, v80
    v_fma_f32 v69, v69, v89, v81
    v_lshlrev_b32 v4, 6, v1
    v_lshl_add_u32 v4, v2, 3, v4
    v_cvt_pk_bf16_f32 v90, v30, v40
    v_cvt_pk_bf16_f32 v91, v50, v60
    ds_write_b64 v4, v[90:91] offset:0
    v_cvt_pk_bf16_f32 v92, v31, v41
    v_cvt_pk_bf16_f32 v93, v51, v61
    ds_write_b64 v4, v[92:93] offset:32
    v_cvt_pk_bf16_f32 v90, v32, v42
    v_cvt_pk_bf16_f32 v91, v52, v62
    ds_write_b64 v4, v[90:91] offset:4096
    v_cvt_pk_bf16_f32 v92, v33, v43
    v_cvt_pk_bf16_f32 v93, v53, v63
    ds_write_b64 v4, v[92:93] offset:4128
    v_cvt_pk_bf16_f32 v90, v34, v44
    v_cvt_pk_bf16_f32 v91, v54, v64
    ds_write_b64 v4, v[90:91] offset:8192
    v_cvt_pk_bf16_f32 v92, v35, v45
    v_cvt_pk_bf16_f32 v93, v55, v65
    ds_write_b64 v4, v[92:93] offset:8224
    v_cvt_pk_bf16_f32 v90, v36, v46
    v_cvt_pk_bf16_f32 v91, v56, v66
    ds_write_b64 v4, v[90:91] offset:12288
    v_cvt_pk_bf16_f32 v92, v37, v47
    v_cvt_pk_bf16_f32 v93, v57, v67
    ds_write_b64 v4, v[92:93] offset:12320
    v_cvt_pk_bf16_f32 v90, v38, v48
    v_cvt_pk_bf16_f32 v91, v58, v68
    ds_write_b64 v4, v[90:91] offset:16384
    v_cvt_pk_bf16_f32 v92, v39, v49
    v_cvt_pk_bf16_f32 v93, v59, v69
    ds_write_b64 v4, v[92:93] offset:16416
    s_waitcnt lgkmcnt(0)
    s_barrier
    v_lshlrev_b32 v5, 5, v0
    v_lshlrev_b32 v6, 12, v0
    s_lshl_b32 s18, s16, 5
    s_add_u32 s19, s18, 1048576
    s_add_u32 s20, s18, 2097152
    ds_read_b128 v[96:99], v5 offset:0
    ds_read_b128 v[100:103], v5 offset:16
    ds_read_b128 v[104:107], v5 offset:8192
    ds_read_b128 v[108:111], v5 offset:8208
    s_waitcnt lgkmcnt(0)
    buffer_store_dwordx4 v[96:99], v6, s[12:15], s18 offen
    buffer_store_dwordx4 v[100:103], v6, s[12:15], s18 offen offset:16
    buffer_store_dwordx4 v[104:107], v6, s[12:15], s19 offen
    buffer_store_dwordx4 v[108:111], v6, s[12:15], s19 offen offset:16
    v_cmp_gt_u32 vcc, 128, v0
    s_and_saveexec_b64 s[30:31], vcc
    s_cbranch_execz L_ln1_end_16
    ds_read_b128 v[112:115], v5 offset:16384
    ds_read_b128 v[116:119], v5 offset:16400
    s_waitcnt lgkmcnt(0)
    buffer_store_dwordx4 v[112:115], v6, s[12:15], s20 offen
    buffer_store_dwordx4 v[116:119], v6, s[12:15], s20 offen offset:16
L_ln1_end_16:
    s_endpgm
L_tr_3:
    s_load_dwordx2 s[4:5], s[0:1], 64
    s_load_dwordx2 s[6:7], s[0:1], 80
    s_load_dwordx2 s[24:25], s[0:1], 112
    s_waitcnt lgkmcnt(0)
    s_cmp_ge_u32 s2, 1536
    s_cbranch_scc1 L_tr_w2_17
    s_sub_u32 s26, s2, 768
    s_mov_b32 s8, s4
    s_mov_b32 s9, s5
    s_mov_b32 s10, 0x600000
    s_mov_b32 s11, 0x00020000
    s_add_u32 s12, s24, 0xd80000
    s_addc_u32 s13, s25, 0
    s_mov_b32 s14, 0x600000
    s_mov_b32 s15, 0x00020000
    s_mov_b32 s16, 3072
    s_mov_b32 s17, 4096
    s_and_b32 s27, s26, 31
    s_lshr_b32 s28, s26, 5
    s_branch L_tr_go_18
L_tr_w2_17:
    s_sub_u32 s26, s2, 1536
    s_mov_b32 s8, s6
    s_mov_b32 s9, s7
    s_mov_b32 s10, 0x600000
    s_mov_b32 s11, 0x00020000
    s_add_u32 s12, s24, 0x1380000
    s_addc_u32 s13, s25, 0
    s_mov_b32 s14, 0x600000
    s_mov_b32 s15, 0x00020000
    s_mov_b32 s16, 4096
    s_mov_b32 s17, 3072
    s_lshr_b32 s27, s26, 5
    s_and_b32 s28, s26, 31
L_tr_go_18:
    s_lshl_b32 s29, s27, 6
    s_lshl_b32 s30, s28, 6
    s_mul_i32 s18, s29, s16
    s_lshl_b32 s31, s30, 1
    s_add_u32 s18, s18, s31
    s_mul_i32 s19, s30, s17
    s_lshl_b32 s31, s29, 1
    s_add_u32 s19, s19, s31
    v_lshrrev_b32 v1, 2, v0
    v_and_b32 v2, 3, v0
    v_mul_lo_u32 v3, v1, s16
    v_lshl_add_u32 v3, v2, 5, v3
    buffer_load_dwordx4 v[10:13], v3, s[8:11], s18 offen
    buffer_load_dwordx4 v[14:17], v3, s[8:11], s18 offen offset:16
    v_mul_u32_u24 v4, 2304, v2
    v_lshl_add_u32 v4, v1, 1, v4
    s_waitcnt vmcnt(0)
    ds_write_b16 v4, v10 offset:0
    ds_write_b16_d16_hi v4, v10 offset:144
    ds_write_b16 v4, v11 offset:288
    ds_write_b16_d16_hi v4, v11 offset:432
    ds_write_b16 v4, v12 offset:576
    ds_write_b16_d16_hi v4, v12 offset:720
    ds_write_b16 v4, v13 offset:864
    ds_write_b16_d16_hi v4, v13 offset:1008
    ds_write_b16 v4, v14 offset:1152
    ds_write_b16_d16_hi v4, v14 offset:1296
    ds_write_b16 v4, v15 offset:1440
    ds_write_b16_d16_hi v4, v15 offset:1584
    ds_write_b16 v4, v16 offset:1728
    ds_write_b16_d16_hi v4, v16 offset:1872
    ds_write_b16 v4, v17 offset:2016
    ds_write_b16_d16_hi v4, v17 offset:2160
    s_waitcnt lgkmcnt(0)
    s_barrier
    v_mul_u32_u24 v5, 144, v1
    v_lshl_add_u32 v5, v2, 5, v5
    ds_read_b128 v[20:23], v5
    ds_read_b128 v[24:27], v5 offset:16
    v_mul_lo_u32 v6, v1, s17
    v_lshl_add_u32 v6, v2, 5, v6
    s_waitcnt lgkmcnt(0)
    buffer_store_dwordx4 v[20:23], v6, s[12:15], s19 offen
    buffer_store_dwordx4 v[24:27], v6, s[12:15], s19 offen offset:16
    s_endpgm
.text
.globl conv_kernel
.p2align 8
.type conv_kernel,@function
conv_kernel:
    s_cmp_ge_u32 s2, 640
    s_cbranch_scc1 L_end_19
    s_load_dwordx2 s[4:5], s[0:1], 112
    s_load_dwordx2 s[6:7], s[0:1], 48
    s_waitcnt lgkmcnt(0)
    s_lshl_b32 s8, s2, 12
    s_add_u32 s10, s4, s8
    s_addc_u32 s11, s5, 0
    s_mov_b32 s12, s10
    s_mov_b32 s13, s11
    s_mov_b32 s14, 0x1000
    s_mov_b32 s15, 0x00020000
    s_add_u32 s16, s10, 0x420000
    s_addc_u32 s17, s11, 0
    s_mov_b32 s18, 0x1000
    s_mov_b32 s19, 0x00020000
    s_add_u32 s20, s4, 0x280000
    s_addc_u32 s21, s5, 0
    s_mov_b32 s22, 0x195000
    s_mov_b32 s23, 0x00020000
    s_mov_b32 s24, s6
    s_mov_b32 s25, s7
    s_mov_b32 s26, 0x500
    s_mov_b32 s27, 0x00020000
    s_mul_i32 s28, s2, 2592
    s_lshl_b32 s29, s2, 1
    v_and_b32 v1, 63, v0
    v_lshrrev_b32 v2, 6, v0
    s_nop 0
    v_readfirstlane_b32 s30, v2
    v_lshlrev_b32 v3, 3, v0
    v_or_b32 v4, 0xff, v3
    v_ffbh_u32 v4, v4
    v_sub_u32 v4, 24, v4
    v_mov_b32 v5, 1
    v_lshlrev_b32 v5, v4, v5
    v_subrev_u32 v6, 1, v5
    v_lshrrev_b32 v6, 1, v6
    v_min_u32 v7, 1, v4
    v_lshlrev_b32 v8, 7, v4
    v_add_u32 v10, 0, v3
    v_lshrrev_b32 v11, v4, v10
    v_and_b32 v11, v11, v7
    v_add3_u32 v10, v10, v6, v11
    v_lshrrev_b32 v10, v4, v10
    v_add_u32 v10, v10, v8
    v_lshlrev_b32 v12, 2, v10
    v_add_u32 v10, 1, v3
    v_lshrrev_b32 v11, v4, v10
    v_and_b32 v11, v11, v7
    v_add3_u32 v10, v10, v6, v11
    v_lshrrev_b32 v10, v4, v10
    v_add_u32 v10, v10, v8
    v_lshlrev_b32 v13, 2, v10
    v_add_u32 v10, 2, v3
    v_lshrrev_b32 v11, v4, v10
    v_and_b32 v11, v11, v7
    v_add3_u32 v10, v10, v6, v11
    v_lshrrev_b32 v10, v4, v10
    v_add_u32 v10, v10, v8
    v_lshlrev_b32 v14, 2, v10
    v_add_u32 v10, 3, v3
    v_lshrrev_b32 v11, v4, v10
    v_and_b32 v11, v11, v7
    v_add3_u32 v10, v10, v6, v11
    v_lshrrev_b32 v10, v4, v10
    v_add_u32 v10, v10, v8
    v_lshlrev_b32 v15, 2, v10
    v_add_u32 v10, 4, v3
    v_lshrrev_b32 v11, v4, v10
    v_and_b32 v11, v11, v7
    v_add3_u32 v10, v10, v6, v11
    v_lshrrev_b32 v10, v4, v10
    v_add_u32 v10, v10, v8
    v_lshlrev_b32 v16, 2, v10
    v_add_u32 v10, 5, v3
    v_lshrrev_b32 v11, v4, v10
    v_and_b32 v11, v11, v7
    v_add3_u32 v10, v10, v6, v11
    v_lshrrev_b32 v10, v4, v10
    v_add_u32 v10, v10, v8
    v_lshlrev_b32 v17, 2, v10
    v_add_u32 v10, 6, v3
    v_lshrrev_b32 v11, v4, v10
    v_and_b32 v11, v11, v7
    v_add3_u32 v10, v10, v6, v11
    v_lshrrev_b32 v10, v4, v10
    v_add_u32 v10, v10, v8
    v_lshlrev_b32 v18, 2, v10
    v_add_u32 v10, 7, v3
    v_lshrrev_b32 v11, v4, v10
    v_and_b32 v11, v11, v7
    v_add3_u32 v10, v10, v6, v11
    v_lshrrev_b32 v10, v4, v10
    v_add_u32 v10, v10, v8
    v_lshlrev_b32 v19, 2, v10
    buffer_load_dword v20, v12, s[20:23], s28 offen
    buffer_load_dword v21, v13, s[20:23], s28 offen
    buffer_load_dword v22, v14, s[20:23], s28 offen
    buffer_load_dword v23, v15, s[20:23], s28 offen
    buffer_load_dword v24, v16, s[20:23], s28 offen
    buffer_load_dword v25, v17, s[20:23], s28 offen
    buffer_load_dword v26, v18, s[20:23], s28 offen
    buffer_load_dword v27, v19, s[20:23], s28 offen
    v_lshlrev_b32 v28, 4, v0
    v_sub_u32 v28, 4064, v28
    v_add_u32 v29, 16, v28
    buffer_load_dwordx4 v[32:35], v28, s[12:15], 0 offen
    buffer_load_dwordx4 v[36:39], v29, s[12:15], 0 offen
    v_mov_b32 v30, 0
    buffer_load_ushort v31, v30, s[24:27], s29 offen
    v_mov_b32 v40, 0
    v_mov_b32 v41, 0
    v_mov_b32 v42, 0
    v_mov_b32 v43, 0
    v_cmp_gt_u32 vcc, 160, v0
    s_and_saveexec_b64 s[32:33], vcc
    v_lshlrev_b32 v44, 4, v0
    ds_write_b128 v44, v[40:43] offset:33280
    ds_write_b128 v44, v[40:43] offset:40960
    s_mov_b64 exec, s[32:33]
    v_cmp_gt_u32 vcc, 32, v0
    s_and_saveexec_b64 s[32:33], vcc
    v_lshrrev_b32 v44, 2, v0
    v_mul_u32_u24 v44, 4160, v44
    v_and_b32 v45, 3, v0
    v_lshl_add_u32 v44, v45, 4, v44
    ds_write_b128 v44, v[40:43] offset:4096
    s_mov_b64 exec, s[32:33]
    s_waitcnt vmcnt(3)
    v_cvt_pk_bf16_f32 v48, v20, v21
    v_lshlrev_b32 v56, 16, v48
    v_and_b32 v57, 0xffff0000, v48
    v_sub_f32 v56, v20, v56
    v_sub_f32 v57, v21, v57
    v_cvt_pk_bf16_f32 v52, v56, v57
    v_cvt_pk_bf16_f32 v49, v22, v23
    v_lshlrev_b32 v56, 16, v49
    v_and_b32 v57, 0xffff0000, v49
    v_sub_f32 v56, v22, v56
    v_sub_f32 v57, v23, v57
    v_cvt_pk_bf16_f32 v53, v56, v57
    v_cvt_pk_bf16_f32 v50, v24, v25
    v_lshlrev_b32 v56, 16, v50
    v_and_b32 v57, 0xffff0000, v50
    v_sub_f32 v56, v24, v56
    v_sub_f32 v57, v25, v57
    v_cvt_pk_bf16_f32 v54, v56, v57
    v_cvt_pk_bf16_f32 v51, v26, v27
    v_lshlrev_b32 v56, 16, v51
    v_and_b32 v57, 0xffff0000, v51
    v_sub_f32 v56, v26, v56
    v_sub_f32 v57, v27, v57
    v_cvt_pk_bf16_f32 v55, v56, v57
    v_lshrrev_b32 v58, 2, v0
    v_mul_u32_u24 v58, 80, v58
    v_and_b32 v59, 3, v0
    v_lshl_add_u32 v58, v59, 4, v58
    ds_write_b128 v58, v[48:51] offset:35840
    ds_write_b128 v58, v[52:55] offset:43520
    s_waitcnt vmcnt(0)
    v_alignbit_b32 v60, v39, v39, 16
    v_alignbit_b32 v61, v38, v38, 16
    v_alignbit_b32 v62, v37, v37, 16
    v_alignbit_b32 v63, v36, v36, 16
    v_alignbit_b32 v64, v35, v35, 16
    v_alignbit_b32 v65, v34, v34, 16
    v_alignbit_b32 v66, v38, v38, 16
    v_alignbit_b32 v67, v37, v37, 16
    v_alignbit_b32 v68, v36, v36, 16
    v_alignbit_b32 v69, v35, v35, 16
    v_alignbit_b32 v70, v34, v34, 16
    v_alignbit_b32 v71, v33, v33, 16
    v_mov_b32 v84, 0xffff
    v_bfi_b32 v72, v84, v39, v38
    v_bfi_b32 v73, v84, v38, v37
    v_bfi_b32 v74, v84, v37, v36
    v_bfi_b32 v75, v84, v36, v35
    v_bfi_b32 v76, v84, v35, v34
    v_bfi_b32 v77, v84, v34, v33
    v_bfi_b32 v78, v84, v38, v37
    v_bfi_b32 v79, v84, v37, v36
    v_bfi_b32 v80, v84, v36, v35
    v_bfi_b32 v81, v84, v35, v34
    v_bfi_b32 v82, v84, v34, v33
    v_bfi_b32 v83, v84, v33, v32
    v_lshlrev_b32 v85, 4, v0
    ds_write_b128 v85, v[60:63] offset:0
    ds_write_b128 v85, v[72:75] offset:4160
    ds_write_b128 v85, v[66:69] offset:8320
    ds_write_b128 v85, v[78:81] offset:12480
    ds_write_b128 v85, v[62:65] offset:16640
    ds_write_b128 v85, v[74:77] offset:20800
    ds_write_b128 v85, v[68:71] offset:24960
    ds_write_b128 v85, v[80:83] offset:29120
    s_waitcnt lgkmcnt(0)
    s_barrier
    v_and_b32 v3, 31, v1
    v_lshrrev_b32 v4, 5, v1
    v_sub_u32 v5, 2047, v3
    v_lshl_add_u32 v5, v4, 3, v5
    v_and_b32 v6, 7, v5
    v_mul_u32_u24 v6, 4160, v6
    v_lshrrev_b32 v5, 3, v5
    v_lshl_add_u32 v6, v5, 4, v6
    v_mul_u32_u24 v7, 80, v3
    v_lshl_add_u32 v7, v4, 4, v7
    v_add_u32 v7, 33280, v7
    v_mov_b32 v96, 0
    v_mov_b32 v97, 0
    v_mov_b32 v98, 0
    v_mov_b32 v99, 0
    v_mov_b32 v100, 0
    v_mov_b32 v101, 0
    v_mov_b32 v102, 0
    v_mov_b32 v103, 0
    v_mov_b32 v104, 0
    v_mov_b32 v105, 0
    v_mov_b32 v106, 0
    v_mov_b32 v107, 0
    v_mov_b32 v108, 0
    v_mov_b32 v109, 0
    v_mov_b32 v110, 0
    v_mov_b32 v111, 0
    v_mov_b32 v112, 0
    v_mov_b32 v113, 0
    v_mov_b32 v114, 0
    v_mov_b32 v115, 0
    v_mov_b32 v116, 0
    v_mov_b32 v117, 0
    v_mov_b32 v118, 0
    v_mov_b32 v119, 0
    v_mov_b32 v120, 0
    v_mov_b32 v121, 0
    v_mov_b32 v122, 0
    v_mov_b32 v123, 0
    v_mov_b32 v124, 0
    v_mov_b32 v125, 0
    v_mov_b32 v126, 0
    v_mov_b32 v127, 0
    s_cmp_eq_u32 s30, 1
    s_cbranch_scc1 L_w_22
    s_cmp_eq_u32 s30, 2
    s_cbranch_scc1 L_w_23
    s_cmp_eq_u32 s30, 3
    s_cbranch_scc1 L_w_24
L_w_21:
    v_subrev_u32 v8, 704, v6
    ds_read_b128 v[128:131], v8 offset:704
    ds_read_b128 v[132:135], v7 offset:2560
    ds_read_b128 v[136:139], v7 offset:10240
    ds_read_b128 v[140:143], v7 offset:5120
    ds_read_b128 v[144:147], v7 offset:12800
    ds_read_b128 v[148:151], v8 offset:736
    ds_read_b128 v[152:155], v7 offset:2592
    ds_read_b128 v[156:159], v7 offset:10272
    ds_read_b128 v[160:163], v7 offset:5152
    ds_read_b128 v[164:167], v7 offset:12832
    s_waitcnt lgkmcnt(5)
    v_mfma_f32_32x32x16_bf16 v[96:111], v[132:135], v[128:131], v[96:111]
    v_mfma_f32_32x32x16_bf16 v[96:111], v[136:139], v[128:131], v[96:111]
    v_mfma_f32_32x32x16_bf16 v[112:127], v[140:143], v[128:131], v[112:127]
    v_mfma_f32_32x32x16_bf16 v[112:127], v[144:147], v[128:131], v[112:127]
    ds_read_b128 v[128:131], v8 offset:640
    ds_read_b128 v[132:135], v7 offset:2480
    ds_read_b128 v[136:139], v7 offset:10160
    ds_read_b128 v[140:143], v7 offset:5040
    ds_read_b128 v[144:147], v7 offset:12720
    s_waitcnt lgkmcnt(5)
    v_mfma_f32_32x32x16_bf16 v[96:111], v[152:155], v[148:151], v[96:111]
    v_mfma_f32_32x32x16_bf16 v[96:111], v[156:159], v[148:151], v[96:111]
    v_mfma_f32_32x32x16_bf16 v[112:127], v[160:163], v[148:151], v[112:127]
    v_mfma_f32_32x32x16_bf16 v[112:127], v[164:167], v[148:151], v[112:127]
    ds_read_b128 v[148:151], v8 offset:672
    ds_read_b128 v[152:155], v7 offset:2512
    ds_read_b128 v[156:159], v7 offset:10192
    ds_read_b128 v[160:163], v7 offset:5072
    ds_read_b128 v[164:167], v7 offset:12752
    s_waitcnt lgkmcnt(5)
    v_mfma_f32_32x32x16_bf16 v[96:111], v[132:135], v[128:131], v[96:111]
    v_mfma_f32_32x32x16_bf16 v[96:111], v[136:139], v[128:131], v[96:111]
    v_mfma_f32_32x32x16_bf16 v[112:127], v[140:143], v[128:131], v[112:127]
    v_mfma_f32_32x32x16_bf16 v[112:127], v[144:147], v[128:131], v[112:127]
    ds_read_b128 v[128:131], v8 offset:576
    ds_read_b128 v[132:135], v7 offset:2400
    ds_read_b128 v[136:139], v7 offset:10080
    ds_read_b128 v[140:143], v7 offset:4960
    ds_read_b128 v[144:147], v7 offset:12640
    s_waitcnt lgkmcnt(5)
    v_mfma_f32_32x32x16_bf16 v[96:111], v[152:155], v[148:151], v[96:111]
    v_mfma_f32_32x32x16_bf16 v[96:111], v[156:159], v[148:151], v[96:111]
    v_mfma_f32_32x32x16_bf16 v[112:127], v[160:163], v[148:151], v[112:127]
    v_mfma_f32_32x32x16_bf16 v[112:127], v[164:167], v[148:151], v[112:127]
    ds_read_b128 v[148:151], v8 offset:608
    ds_read_b128 v[152:155], v7 offset:2432
    ds_read_b128 v[156:159], v7 offset:10112
    ds_read_b128 v[160:163], v7 offset:4992
    ds_read_b128 v[164:167], v7 offset:12672
    s_waitcnt lgkmcnt(5)
    v_mfma_f32_32x32x16_bf16 v[96:111], v[132:135], v[128:131], v[96:111]
    v_mfma_f32_32x32x16_bf16 v[96:111], v[136:139], v[128:131], v[96:111]
    v_mfma_f32_32x32x16_bf16 v[112:127], v[140:143], v[128:131], v[112:127]
    v_mfma_f32_32x32x16_bf16 v[112:127], v[144:147], v[128:131], v[112:127]
    ds_read_b128 v[128:131], v8 offset:512
    ds_read_b128 v[132:135], v7 offset:2320
    ds_read_b128 v[136:139], v7 offset:10000
    ds_read_b128 v[140:143], v7 offset:4880
    ds_read_b128 v[144:147], v7 offset:12560
    s_waitcnt lgkmcnt(5)
    v_mfma_f32_32x32x16_bf16 v[96:111], v[152:155], v[148:151], v[96:111]
    v_mfma_f32_32x32x16_bf16 v[96:111], v[156:159], v[148:151], v[96:111]
    v_mfma_f32_32x32x16_bf16 v[112:127], v[160:163], v[148:151], v[112:127]
    v_mfma_f32_32x32x16_bf16 v[112:127], v[164:167], v[148:151], v[112:127]
    ds_read_b128 v[148:151], v8 offset:544
    ds_read_b128 v[152:155], v7 offset:2352
    ds_read_b128 v[156:159], v7 offset:10032
    ds_read_b128 v[160:163], v7 offset:4912
    ds_read_b128 v[164:167], v7 offset:12592
    s_waitcnt lgkmcnt(5)
    v_mfma_f32_32x32x16_bf16 v[96:111], v[132:135], v[128:131], v[96:111]
    v_mfma_f32_32x32x16_bf16 v[96:111], v[136:139], v[128:131], v[96:111]
    v_mfma_f32_32x32x16_bf16 v[112:127], v[140:143], v[128:131], v[112:127]
    v_mfma_f32_32x32x16_bf16 v[112:127], v[144:147], v[128:131], v[112:127]
    ds_read_b128 v[128:131], v8 offset:448
    ds_read_b128 v[132:135], v7 offset:2240
    ds_read_b128 v[136:139], v7 offset:9920
    ds_read_b128 v[140:143], v7 offset:4800
    ds_read_b128 v[144:147], v7 offset:12480
    s_waitcnt lgkmcnt(5)
    v_mfma_f32_32x32x16_bf16 v[96:111], v[152:155], v[148:151], v[96:111]
    v_mfma_f32_32x32x16_bf16 v[96:111], v[156:159], v[148:151], v[96:111]
    v_mfma_f32_32x32x16_bf16 v[112:127], v[160:163], v[148:151], v[112:127]
    v_mfma_f32_32x32x16_bf16 v[112:127], v[164:167], v[148:151], v[112:127]
    ds_read_b128 v[148:151], v8 offset:480
    ds_read_b128 v[152:155], v7 offset:2272
    ds_read_b128 v[156:159], v7 offset:9952
    ds_read_b128 v[160:163], v7 offset:4832
    ds_read_b128 v[164:167], v7 offset:12512
    s_waitcnt lgkmcnt(5)
    v_mfma_f32_32x32x16_bf16 v[96:111], v[132:135], v[128:131], v[96:111]
    v_mfma_f32_32x32x16_bf16 v[96:111], v[136:139], v[128:131], v[96:111]
    v_mfma_f32_32x32x16_bf16 v[112:127], v[140:143], v[128:131], v[112:127]
    v_mfma_f32_32x32x16_bf16 v[112:127], v[144:147], v[128:131], v[112:127]
    ds_read_b128 v[128:131], v8 offset:384
    ds_read_b128 v[132:135], v7 offset:2160
    ds_read_b128 v[136:139], v7 offset:9840
    ds_read_b128 v[140:143], v7 offset:4720
    ds_read_b128 v[144:147], v7 offset:12400
    s_waitcnt lgkmcnt(5)
    v_mfma_f32_32x32x16_bf16 v[96:111], v[152:155], v[148:151], v[96:111]
    v_mfma_f32_32x32x16_bf16 v[96:111], v[156:159], v[148:151], v[96:111]
    v_mfma_f32_32x32x16_bf16 v[112:127], v[160:163], v[148:151], v[112:127]
    v_mfma_f32_32x32x16_bf16 v[112:127], v[164:167], v[148:151], v[112:127]
    ds_read_b128 v[148:151], v8 offset:416
    ds_read_b128 v[152:155], v7 offset:2192
    ds_read_b128 v[156:159], v7 offset:9872
    ds_read_b128 v[160:163], v7 offset:4752
    ds_read_b128 v[164:167], v7 offset:12432
    s_waitcnt lgkmcnt(5)
    v_mfma_f32_32x32x16_bf16 v[96:111], v[132:135], v[128:131], v[96:111]
    v_mfma_f32_32x32x16_bf16 v[96:111], v[136:139], v[128:131], v[96:111]
    v_mfma_f32_32x32x16_bf16 v[112:127], v[140:143], v[128:131], v[112:127]
    v_mfma_f32_32x32x16_bf16 v[112:127], v[144:147], v[128:131], v[112:127]
    ds_read_b128 v[128:131], v8 offset:320
    ds_read_b128 v[132:135], v7 offset:2080
    ds_read_b128 v[136:139], v7 offset:9760
    ds_read_b128 v[140:143], v7 offset:4640
    ds_read_b128 v[144:147], v7 offset:12320
    s_waitcnt lgkmcnt(5)
    v_mfma_f32_32x32x16_bf16 v[96:111], v[152:155], v[148:151], v[96:111]
    v_mfma_f32_32x32x16_bf16 v[96:111], v[156:159], v[148:151], v[96:111]
    v_mfma_f32_32x32x16_bf16 v[112:127], v[160:163], v[148:151], v[112:127]
    v_mfma_f32_32x32x16_bf16 v[112:127], v[164:167], v[148:151], v[112:127]
    ds_read_b128 v[148:151], v8 offset:352
    ds_read_b128 v[152:155], v7 offset:2112
    ds_read_b128 v[156:159], v7 offset:9792
    ds_read_b128 v[160:163], v7 offset:4672
    ds_read_b128 v[164:167], v7 offset:12352
    s_waitcnt lgkmcnt(5)
    v_mfma_f32_32x32x16_bf16 v[96:111], v[132:135], v[128:131], v[96:111]
    v_mfma_f32_32x32x16_bf16 v[96:111], v[136:139], v[128:131], v[96:111]
    v_mfma_f32_32x32x16_bf16 v[112:127], v[140:143], v[128:131], v[112:127]
    v_mfma_f32_32x32x16_bf16 v[112:127], v[144:147], v[128:131], v[112:127]
    ds_read_b128 v[128:131], v8 offset:256
    ds_read_b128 v[132:135], v7 offset:2000
    ds_read_b128 v[136:139], v7 offset:9680
    ds_read_b128 v[140:143], v7 offset:4560
    ds_read_b128 v[144:147], v7 offset:12240
    s_waitcnt lgkmcnt(5)
    v_mfma_f32_32x32x16_bf16 v[96:111], v[152:155], v[148:151], v[96:111]
    v_mfma_f32_32x32x16_bf16 v[96:111], v[156:159], v[148:151], v[96:111]
    v_mfma_f32_32x32x16_bf16 v[112:127], v[160:163], v[148:151], v[112:127]
    v_mfma_f32_32x32x16_bf16 v[112:127], v[164:167], v[148:151], v[112:127]
    ds_read_b128 v[148:151], v8 offset:288
    ds_read_b128 v[152:155], v7 offset:2032
    ds_read_b128 v[156:159], v7 offset:9712
    ds_read_b128 v[160:163], v7 offset:4592
    ds_read_b128 v[164:167], v7 offset:12272
    s_waitcnt lgkmcnt(5)
    v_mfma_f32_32x32x16_bf16 v[96:111], v[132:135], v[128:131], v[96:111]
    v_mfma_f32_32x32x16_bf16 v[96:111], v[136:139], v[128:131], v[96:111]
    v_mfma_f32_32x32x16_bf16 v[112:127], v[140:143], v[128:131], v[112:127]
    v_mfma_f32_32x32x16_bf16 v[112:127], v[144:147], v[128:131], v[112:127]
    ds_read_b128 v[128:131], v8 offset:192
    ds_read_b128 v[132:135], v7 offset:1920
    ds_read_b128 v[136:139], v7 offset:9600
    ds_read_b128 v[140:143], v7 offset:4480
    ds_read_b128 v[144:147], v7 offset:12160
    s_waitcnt lgkmcnt(5)
    v_mfma_f32_32x32x16_bf16 v[96:111], v[152:155], v[148:151], v[96:111]
    v_mfma_f32_32x32x16_bf16 v[96:111], v[156:159], v[148:151], v[96:111]
    v_mfma_f32_32x32x16_bf16 v[112:127], v[160:163], v[148:151], v[112:127]
    v_mfma_f32_32x32x16_bf16 v[112:127], v[164:167], v[148:151], v[112:127]
    ds_read_b128 v[148:151], v8 offset:224
    ds_read_b128 v[152:155], v7 offset:1952
    ds_read_b128 v[156:159], v7 offset:9632
    ds_read_b128 v[160:163], v7 offset:4512
    ds_read_b128 v[164:167], v7 offset:12192
    s_waitcnt lgkmcnt(5)
    v_mfma_f32_32x32x16_bf16 v[96:111], v[132:135], v[128:131], v[96:111]
    v_mfma_f32_32x32x16_bf16 v[96:111], v[136:139], v[128:131], v[96:111]
    v_mfma_f32_32x32x16_bf16 v[112:127], v[140:143], v[128:131], v[112:127]
    v_mfma_f32_32x32x16_bf16 v[112:127], v[144:147], v[128:131], v[112:127]
    ds_read_b128 v[128:131], v8 offset:128
    ds_read_b128 v[132:135], v7 offset:1840
    ds_read_b128 v[136:139], v7 offset:9520
    ds_read_b128 v[140:143], v7 offset:4400
    ds_read_b128 v[144:147], v7 offset:12080
    s_waitcnt lgkmcnt(5)
    v_mfma_f32_32x32x16_bf16 v[96:111], v[152:155], v[148:151], v[96:111]
    v_mfma_f32_32x32x16_bf16 v[96:111], v[156:159], v[148:151], v[96:111]
    v_mfma_f32_32x32x16_bf16 v[112:127], v[160:163], v[148:151], v[112:127]
    v_mfma_f32_32x32x16_bf16 v[112:127], v[164:167], v[148:151], v[112:127]
    ds_read_b128 v[148:151], v8 offset:160
    ds_read_b128 v[152:155], v7 offset:1872
    ds_read_b128 v[156:159], v7 offset:9552
    ds_read_b128 v[160:163], v7 offset:4432
    ds_read_b128 v[164:167], v7 offset:12112
    s_waitcnt lgkmcnt(5)
    v_mfma_f32_32x32x16_bf16 v[96:111], v[132:135], v[128:131], v[96:111]
    v_mfma_f32_32x32x16_bf16 v[96:111], v[136:139], v[128:131], v[96:111]
    v_mfma_f32_32x32x16_bf16 v[112:127], v[140:143], v[128:131], v[112:127]
    v_mfma_f32_32x32x16_bf16 v[112:127], v[144:147], v[128:131], v[112:127]
    ds_read_b128 v[128:131], v8 offset:64
    ds_read_b128 v[132:135], v7 offset:1760
    ds_read_b128 v[136:139], v7 offset:9440
    ds_read_b128 v[140:143], v7 offset:4320
    ds_read_b128 v[144:147], v7 offset:12000
    s_waitcnt lgkmcnt(5)
    v_mfma_f32_32x32x16_bf16 v[96:111], v[152:155], v[148:151], v[96:111]
    v_mfma_f32_32x32x16_bf16 v[96:111], v[156:159], v[148:151], v[96:111]
    v_mfma_f32_32x32x16_bf16 v[112:127], v[160:163], v[148:151], v[112:127]
    v_mfma_f32_32x32x16_bf16 v[112:127], v[164:167], v[148:151], v[112:127]
    ds_read_b128 v[148:151], v8 offset:96
    ds_read_b128 v[152:155], v7 offset:1792
    ds_read_b128 v[156:159], v7 offset:9472
    ds_read_b128 v[160:163], v7 offset:4352
    ds_read_b128 v[164:167], v7 offset:12032
    s_waitcnt lgkmcnt(5)
    v_mfma_f32_32x32x16_bf16 v[96:111], v[132:135], v[128:131], v[96:111]
    v_mfma_f32_32x32x16_bf16 v[96:111], v[136:139], v[128:131], v[96:111]
    v_mfma_f32_32x32x16_bf16 v[112:127], v[140:143], v[128:131], v[112:127]
    v_mfma_f32_32x32x16_bf16 v[112:127], v[144:147], v[128:131], v[112:127]
    ds_read_b128 v[128:131], v8 offset:0
    ds_read_b128 v[132:135], v7 offset:1680
    ds_read_b128 v[136:139], v7 offset:9360
    ds_read_b128 v[140:143], v7 offset:4240
    ds_read_b128 v[144:147], v7 offset:11920
    s_waitcnt lgkmcnt(5)
    v_mfma_f32_32x32x16_bf16 v[96:111], v[152:155], v[148:151], v[96:111]
    v_mfma_f32_32x32x16_bf16 v[96:111], v[156:159], v[148:151], v[96:111]
    v_mfma_f32_32x32x16_bf16 v[112:127], v[160:163], v[148:151], v[112:127]
    v_mfma_f32_32x32x16_bf16 v[112:127], v[164:167], v[148:151], v[112:127]
    ds_read_b128 v[148:151], v8 offset:32
    ds_read_b128 v[152:155], v7 offset:1712
    ds_read_b128 v[156:159], v7 offset:9392
    ds_read_b128 v[160:163], v7 offset:4272
    ds_read_b128 v[164:167], v7 offset:11952
    s_waitcnt lgkmcnt(5)
    v_mfma_f32_32x32x16_bf16 v[96:111], v[132:135], v[128:131], v[96:111]
    v_mfma_f32_32x32x16_bf16 v[96:111], v[136:139], v[128:131], v[96:111]
    v_mfma_f32_32x32x16_bf16 v[112:127], v[140:143], v[128:131], v[112:127]
    v_mfma_f32_32x32x16_bf16 v[112:127], v[144:147], v[128:131], v[112:127]
    s_waitcnt lgkmcnt(0)
    v_mfma_f32_32x32x16_bf16 v[96:111], v[152:155], v[148:151], v[96:111]
    v_mfma_f32_32x32x16_bf16 v[96:111], v[156:159], v[148:151], v[96:111]
    v_mfma_f32_32x32x16_bf16 v[112:127], v[160:163], v[148:151], v[112:127]
    v_mfma_f32_32x32x16_bf16 v[112:127], v[164:167], v[148:151], v[112:127]
    s_branch L_red_20
L_w_22:
    v_subrev_u32 v8, 1472, v6
    ds_read_b128 v[128:131], v8 offset:704
    ds_read_b128 v[132:135], v7 offset:1600
    ds_read_b128 v[136:139], v7 offset:9280
    ds_read_b128 v[140:143], v7 offset:4160
    ds_read_b128 v[144:147], v7 offset:11840
    ds_read_b128 v[148:151], v8 offset:736
    ds_read_b128 v[152:155], v7 offset:1632
    ds_read_b128 v[156:159], v7 offset:9312
    ds_read_b128 v[160:163], v7 offset:4192
    ds_read_b128 v[164:167], v7 offset:11872
    s_waitcnt lgkmcnt(5)
    v_mfma_f32_32x32x16_bf16 v[96:111], v[132:135], v[128:131], v[96:111]
    v_mfma_f32_32x32x16_bf16 v[96:111], v[136:139], v[128:131], v[96:111]
    v_mfma_f32_32x32x16_bf16 v[112:127], v[140:143], v[128:131], v[112:127]
    v_mfma_f32_32x32x16_bf16 v[112:127], v[144:147], v[128:131], v[112:127]
    ds_read_b128 v[128:131], v8 offset:640
    ds_read_b128 v[132:135], v7 offset:1520
    ds_read_b128 v[136:139], v7 offset:9200
    ds_read_b128 v[140:143], v7 offset:4080
    ds_read_b128 v[144:147], v7 offset:11760
    s_waitcnt lgkmcnt(5)
    v_mfma_f32_32x32x16_bf16 v[96:111], v[152:155], v[148:151], v[96:111]
    v_mfma_f32_32x32x16_bf16 v[96:111], v[156:159], v[148:151], v[96:111]
    v_mfma_f32_32x32x16_bf16 v[112:127], v[160:163], v[148:151], v[112:127]
    v_mfma_f32_32x32x16_bf16 v[112:127], v[164:167], v[148:151], v[112:127]
    ds_read_b128 v[148:151], v8 offset:672
    ds_read_b128 v[152:155], v7 offset:1552
    ds_read_b128 v[156:159], v7 offset:9232
    ds_read_b128 v[160:163], v7 offset:4112
    ds_read_b128 v[164:167], v7 offset:11792
    s_waitcnt lgkmcnt(5)
    v_mfma_f32_32x32x16_bf16 v[96:111], v[132:135], v[128:131], v[96:111]
    v_mfma_f32_32x32x16_bf16 v[96:111], v[136:139], v[128:131], v[96:111]
    v_mfma_f32_32x32x16_bf16 v[112:127], v[140:143], v[128:131], v[112:127]
    v_mfma_f32_32x32x16_bf16 v[112:127], v[144:147], v[128:131], v[112:127]
    ds_read_b128 v[128:131], v8 offset:576
    ds_read_b128 v[132:135], v7 offset:1440
    ds_read_b128 v[136:139], v7 offset:9120
    ds_read_b128 v[140:143], v7 offset:4000
    ds_read_b128 v[144:147], v7 offset:11680
    s_waitcnt lgkmcnt(5)
    v_mfma_f32_32x32x16_bf16 v[96:111], v[152:155], v[148:151], v[96:111]
    v_mfma_f32_32x32x16_bf16 v[96:111], v[156:159], v[148:151], v[96:111]
    v_mfma_f32_32x32x16_bf16 v[112:127], v[160:163], v[148:151], v[112:127]
    v_mfma_f32_32x32x16_bf16 v[112:127], v[164:167], v[148:151], v[112:127]
    ds_read_b128 v[148:151], v8 offset:608
    ds_read_b128 v[152:155], v7 offset:1472
    ds_read_b128 v[156:159], v7 offset:9152
    ds_read_b128 v[160:163], v7 offset:4032
    ds_read_b128 v[164:167], v7 offset:11712
    s_waitcnt lgkmcnt(5)
    v_mfma_f32_32x32x16_bf16 v[96:111], v[132:135], v[128:131], v[96:111]
    v_mfma_f32_32x32x16_bf16 v[96:111], v[136:139], v[128:131], v[96:111]
    v_mfma_f32_32x32x16_bf16 v[112:127], v[140:143], v[128:131], v[112:127]
    v_mfma_f32_32x32x16_bf16 v[112:127], v[144:147], v[128:131], v[112:127]
    ds_read_b128 v[128:131], v8 offset:512
    ds_read_b128 v[132:135], v7 offset:1360
    ds_read_b128 v[136:139], v7 offset:9040
    ds_read_b128 v[140:143], v7 offset:3920
    ds_read_b128 v[144:147], v7 offset:11600
    s_waitcnt lgkmcnt(5)
    v_mfma_f32_32x32x16_bf16 v[96:111], v[152:155], v[148:151], v[96:111]
    v_mfma_f32_32x32x16_bf16 v[96:111], v[156:159], v[148:151], v[96:111]
    v_mfma_f32_32x32x16_bf16 v[112:127], v[160:163], v[148:151], v[112:127]
    v_mfma_f32_32x32x16_bf16 v[112:127], v[164:167], v[148:151], v[112:127]
    ds_read_b128 v[148:151], v8 offset:544
    ds_read_b128 v[152:155], v7 offset:1392
    ds_read_b128 v[156:159], v7 offset:9072
    ds_read_b128 v[160:163], v7 offset:3952
    ds_read_b128 v[164:167], v7 offset:11632
    s_waitcnt lgkmcnt(5)
    v_mfma_f32_32x32x16_bf16 v[96:111], v[132:135], v[128:131], v[96:111]
    v_mfma_f32_32x32x16_bf16 v[96:111], v[136:139], v[128:131], v[96:111]
    v_mfma_f32_32x32x16_bf16 v[112:127], v[140:143], v[128:131], v[112:127]
    v_mfma_f32_32x32x16_bf16 v[112:127], v[144:147], v[128:131], v[112:127]
    ds_read_b128 v[128:131], v8 offset:448
    ds_read_b128 v[132:135], v7 offset:1280
    ds_read_b128 v[136:139], v7 offset:8960
    ds_read_b128 v[140:143], v7 offset:3840
    ds_read_b128 v[144:147], v7 offset:11520
    s_waitcnt lgkmcnt(5)
    v_mfma_f32_32x32x16_bf16 v[96:111], v[152:155], v[148:151], v[96:111]
    v_mfma_f32_32x32x16_bf16 v[96:111], v[156:159], v[148:151], v[96:111]
    v_mfma_f32_32x32x16_bf16 v[112:127], v[160:163], v[148:151], v[112:127]
    v_mfma_f32_32x32x16_bf16 v[112:127], v[164:167], v[148:151], v[112:127]
    ds_read_b128 v[148:151], v8 offset:480
    ds_read_b128 v[152:155], v7 offset:1312
    ds_read_b128 v[156:159], v7 offset:8992
    ds_read_b128 v[160:163], v7 offset:3872
    ds_read_b128 v[164:167], v7 offset:11552
    s_waitcnt lgkmcnt(5)
    v_mfma_f32_32x32x16_bf16 v[96:111], v[132:135], v[128:131], v[96:111]
    v_mfma_f32_32x32x16_bf16 v[96:111], v[136:139], v[128:131], v[96:111]
    v_mfma_f32_32x32x16_bf16 v[112:127], v[140:143], v[128:131], v[112:127]
    v_mfma_f32_32x32x16_bf16 v[112:127], v[144:147], v[128:131], v[112:127]
    ds_read_b128 v[128:131], v8 offset:384
    ds_read_b128 v[132:135], v7 offset:1200
    ds_read_b128 v[136:139], v7 offset:8880
    ds_read_b128 v[140:143], v7 offset:3760
    ds_read_b128 v[144:147], v7 offset:11440
    s_waitcnt lgkmcnt(5)
    v_mfma_f32_32x32x16_bf16 v[96:111], v[152:155], v[148:151], v[96:111]
    v_mfma_f32_32x32x16_bf16 v[96:111], v[156:159], v[148:151], v[96:111]
    v_mfma_f32_32x32x16_bf16 v[112:127], v[160:163], v[148:151], v[112:127]
    v_mfma_f32_32x32x16_bf16 v[112:127], v[164:167], v[148:151], v[112:127]
    ds_read_b128 v[148:151], v8 offset:416
    ds_read_b128 v[152:155], v7 offset:1232
    ds_read_b128 v[156:159], v7 offset:8912
    ds_read_b128 v[160:163], v7 offset:3792
    ds_read_b128 v[164:167], v7 offset:11472
    s_waitcnt lgkmcnt(5)
    v_mfma_f32_32x32x16_bf16 v[96:111], v[132:135], v[128:131], v[96:111]
    v_mfma_f32_32x32x16_bf16 v[96:111], v[136:139], v[128:131], v[96:111]
    v_mfma_f32_32x32x16_bf16 v[112:127], v[140:143], v[128:131], v[112:127]
    v_mfma_f32_32x32x16_bf16 v[112:127], v[144:147], v[128:131], v[112:127]
    ds_read_b128 v[128:131], v8 offset:320
    ds_read_b128 v[132:135], v7 offset:1120
    ds_read_b128 v[136:139], v7 offset:8800
    ds_read_b128 v[140:143], v7 offset:3680
    ds_read_b128 v[144:147], v7 offset:11360
    s_waitcnt lgkmcnt(5)
    v_mfma_f32_32x32x16_bf16 v[96:111], v[152:155], v[148:151], v[96:111]
    v_mfma_f32_32x32x16_bf16 v[96:111], v[156:159], v[148:151], v[96:111]
    v_mfma_f32_32x32x16_bf16 v[112:127], v[160:163], v[148:151], v[112:127]
    v_mfma_f32_32x32x16_bf16 v[112:127], v[164:167], v[148:151], v[112:127]
    ds_read_b128 v[148:151], v8 offset:352
    ds_read_b128 v[152:155], v7 offset:1152
    ds_read_b128 v[156:159], v7 offset:8832
    ds_read_b128 v[160:163], v7 offset:3712
    ds_read_b128 v[164:167], v7 offset:11392
    s_waitcnt lgkmcnt(5)
    v_mfma_f32_32x32x16_bf16 v[96:111], v[132:135], v[128:131], v[96:111]
    v_mfma_f32_32x32x16_bf16 v[96:111], v[136:139], v[128:131], v[96:111]
    v_mfma_f32_32x32x16_bf16 v[112:127], v[140:143], v[128:131], v[112:127]
    v_mfma_f32_32x32x16_bf16 v[112:127], v[144:147], v[128:131], v[112:127]
    ds_read_b128 v[128:131], v8 offset:256
    ds_read_b128 v[132:135], v7 offset:1040
    ds_read_b128 v[136:139], v7 offset:8720
    ds_read_b128 v[140:143], v7 offset:3600
    ds_read_b128 v[144:147], v7 offset:11280
    s_waitcnt lgkmcnt(5)
    v_mfma_f32_32x32x16_bf16 v[96:111], v[152:155], v[148:151], v[96:111]
    v_mfma_f32_32x32x16_bf16 v[96:111], v[156:159], v[148:151], v[96:111]
    v_mfma_f32_32x32x16_bf16 v[112:127], v[160:163], v[148:151], v[112:127]
    v_mfma_f32_32x32x16_bf16 v[112:127], v[164:167], v[148:151], v[112:127]
    ds_read_b128 v[148:151], v8 offset:288
    ds_read_b128 v[152:155], v7 offset:1072
    ds_read_b128 v[156:159], v7 offset:8752
    ds_read_b128 v[160:163], v7 offset:3632
    ds_read_b128 v[164:167], v7 offset:11312
    s_waitcnt lgkmcnt(5)
    v_mfma_f32_32x32x16_bf16 v[96:111], v[132:135], v[128:131], v[96:111]
    v_mfma_f32_32x32x16_bf16 v[96:111], v[136:139], v[128:131], v[96:111]
    v_mfma_f32_32x32x16_bf16 v[112:127], v[140:143], v[128:131], v[112:127]
    v_mfma_f32_32x32x16_bf16 v[112:127], v[144:147], v[128:131], v[112:127]
    ds_read_b128 v[128:131], v8 offset:192
    ds_read_b128 v[132:135], v7 offset:960
    ds_read_b128 v[136:139], v7 offset:8640
    ds_read_b128 v[140:143], v7 offset:3520
    ds_read_b128 v[144:147], v7 offset:11200
    s_waitcnt lgkmcnt(5)
    v_mfma_f32_32x32x16_bf16 v[96:111], v[152:155], v[148:151], v[96:111]
    v_mfma_f32_32x32x16_bf16 v[96:111], v[156:159], v[148:151], v[96:111]
    v_mfma_f32_32x32x16_bf16 v[112:127], v[160:163], v[148:151], v[112:127]
    v_mfma_f32_32x32x16_bf16 v[112:127], v[164:167], v[148:151], v[112:127]
    ds_read_b128 v[148:151], v8 offset:224
    ds_read_b128 v[152:155], v7 offset:992
    ds_read_b128 v[156:159], v7 offset:8672
    ds_read_b128 v[160:163], v7 offset:3552
    ds_read_b128 v[164:167], v7 offset:11232
    s_waitcnt lgkmcnt(5)
    v_mfma_f32_32x32x16_bf16 v[96:111], v[132:135], v[128:131], v[96:111]
    v_mfma_f32_32x32x16_bf16 v[96:111], v[136:139], v[128:131], v[96:111]
    v_mfma_f32_32x32x16_bf16 v[112:127], v[140:143], v[128:131], v[112:127]
    v_mfma_f32_32x32x16_bf16 v[112:127], v[144:147], v[128:131], v[112:127]
    ds_read_b128 v[128:131], v8 offset:128
    ds_read_b128 v[132:135], v7 offset:880
    ds_read_b128 v[136:139], v7 offset:8560
    ds_read_b128 v[140:143], v7 offset:3440
    ds_read_b128 v[144:147], v7 offset:11120
    s_waitcnt lgkmcnt(5)
    v_mfma_f32_32x32x16_bf16 v[96:111], v[152:155], v[148:151], v[96:111]
    v_mfma_f32_32x32x16_bf16 v[96:111], v[156:159], v[148:151], v[96:111]
    v_mfma_f32_32x32x16_bf16 v[112:127], v[160:163], v[148:151], v[112:127]
    v_mfma_f32_32x32x16_bf16 v[112:127], v[164:167], v[148:151], v[112:127]
    ds_read_b128 v[148:151], v8 offset:160
    ds_read_b128 v[152:155], v7 offset:912
    ds_read_b128 v[156:159], v7 offset:8592
    ds_read_b128 v[160:163], v7 offset:3472
    ds_read_b128 v[164:167], v7 offset:11152
    s_waitcnt lgkmcnt(5)
    v_mfma_f32_32x32x16_bf16 v[96:111], v[132:135], v[128:131], v[96:111]
    v_mfma_f32_32x32x16_bf16 v[96:111], v[136:139], v[128:131], v[96:111]
    v_mfma_f32_32x32x16_bf16 v[112:127], v[140:143], v[128:131], v[112:127]
    v_mfma_f32_32x32x16_bf16 v[112:127], v[144:147], v[128:131], v[112:127]
    ds_read_b128 v[128:131], v8 offset:64
    ds_read_b128 v[132:135], v7 offset:800
    ds_read_b128 v[136:139], v7 offset:8480
    ds_read_b128 v[140:143], v7 offset:3360
    ds_read_b128 v[144:147], v7 offset:11040
    s_waitcnt lgkmcnt(5)
    v_mfma_f32_32x32x16_bf16 v[96:111], v[152:155], v[148:151], v[96:111]
    v_mfma_f32_32x32x16_bf16 v[96:111], v[156:159], v[148:151], v[96:111]
    v_mfma_f32_32x32x16_bf16 v[112:127], v[160:163], v[148:151], v[112:127]
    v_mfma_f32_32x32x16_bf16 v[112:127], v[164:167], v[148:151], v[112:127]
    ds_read_b128 v[148:151], v8 offset:96
    ds_read_b128 v[152:155], v7 offset:832
    ds_read_b128 v[156:159], v7 offset:8512
    ds_read_b128 v[160:163], v7 offset:3392
    ds_read_b128 v[164:167], v7 offset:11072
    s_waitcnt lgkmcnt(5)
    v_mfma_f32_32x32x16_bf16 v[96:111], v[132:135], v[128:131], v[96:111]
    v_mfma_f32_32x32x16_bf16 v[96:111], v[136:139], v[128:131], v[96:111]
    v_mfma_f32_32x32x16_bf16 v[112:127], v[140:143], v[128:131], v[112:127]
    v_mfma_f32_32x32x16_bf16 v[112:127], v[144:147], v[128:131], v[112:127]
    ds_read_b128 v[128:131], v8 offset:0
    ds_read_b128 v[132:135], v7 offset:720
    ds_read_b128 v[136:139], v7 offset:8400
    ds_read_b128 v[140:143], v7 offset:3280
    ds_read_b128 v[144:147], v7 offset:10960
    s_waitcnt lgkmcnt(5)
    v_mfma_f32_32x32x16_bf16 v[96:111], v[152:155], v[148:151], v[96:111]
    v_mfma_f32_32x32x16_bf16 v[96:111], v[156:159], v[148:151], v[96:111]
    v_mfma_f32_32x32x16_bf16 v[112:127], v[160:163], v[148:151], v[112:127]
    v_mfma_f32_32x32x16_bf16 v[112:127], v[164:167], v[148:151], v[112:127]
    ds_read_b128 v[148:151], v8 offset:32
    ds_read_b128 v[152:155], v7 offset:752
    ds_read_b128 v[156:159], v7 offset:8432
    ds_read_b128 v[160:163], v7 offset:3312
    ds_read_b128 v[164:167], v7 offset:10992
    s_waitcnt lgkmcnt(5)
    v_mfma_f32_32x32x16_bf16 v[96:111], v[132:135], v[128:131], v[96:111]
    v_mfma_f32_32x32x16_bf16 v[96:111], v[136:139], v[128:131], v[96:111]
    v_mfma_f32_32x32x16_bf16 v[112:127], v[140:143], v[128:131], v[112:127]
    v_mfma_f32_32x32x16_bf16 v[112:127], v[144:147], v[128:131], v[112:127]
    s_waitcnt lgkmcnt(0)
    v_mfma_f32_32x32x16_bf16 v[96:111], v[152:155], v[148:151], v[96:111]
    v_mfma_f32_32x32x16_bf16 v[96:111], v[156:159], v[148:151], v[96:111]
    v_mfma_f32_32x32x16_bf16 v[112:127], v[160:163], v[148:151], v[112:127]
    v_mfma_f32_32x32x16_bf16 v[112:127], v[164:167], v[148:151], v[112:127]
    s_branch L_red_20
L_w_23:
    v_subrev_u32 v8, 2496, v6
    ds_read_b128 v[128:131], v8 offset:960
    ds_read_b128 v[132:135], v7 offset:640
    ds_read_b128 v[136:139], v7 offset:8320
    ds_read_b128 v[140:143], v7 offset:3200
    ds_read_b128 v[144:147], v7 offset:10880
    ds_read_b128 v[148:151], v8 offset:992
    ds_read_b128 v[152:155], v7 offset:672
    ds_read_b128 v[156:159], v7 offset:8352
    ds_read_b128 v[160:163], v7 offset:3232
    ds_read_b128 v[164:167], v7 offset:10912
    s_waitcnt lgkmcnt(5)
    v_mfma_f32_32x32x16_bf16 v[96:111], v[132:135], v[128:131], v[96:111]
    v_mfma_f32_32x32x16_bf16 v[96:111], v[136:139], v[128:131], v[96:111]
    v_mfma_f32_32x32x16_bf16 v[112:127], v[140:143], v[128:131], v[112:127]
    v_mfma_f32_32x32x16_bf16 v[112:127], v[144:147], v[128:131], v[112:127]
    ds_read_b128 v[128:131], v8 offset:896
    ds_read_b128 v[132:135], v7 offset:560
    ds_read_b128 v[136:139], v7 offset:8240
    ds_read_b128 v[140:143], v7 offset:3120
    ds_read_b128 v[144:147], v7 offset:10800
    s_waitcnt lgkmcnt(5)
    v_mfma_f32_32x32x16_bf16 v[96:111], v[152:155], v[148:151], v[96:111]
    v_mfma_f32_32x32x16_bf16 v[96:111], v[156:159], v[148:151], v[96:111]
    v_mfma_f32_32x32x16_bf16 v[112:127], v[160:163], v[148:151], v[112:127]
    v_mfma_f32_32x32x16_bf16 v[112:127], v[164:167], v[148:151], v[112:127]
    ds_read_b128 v[148:151], v8 offset:928
    ds_read_b128 v[152:155], v7 offset:592
    ds_read_b128 v[156:159], v7 offset:8272
    ds_read_b128 v[160:163], v7 offset:3152
    ds_read_b128 v[164:167], v7 offset:10832
    s_waitcnt lgkmcnt(5)
    v_mfma_f32_32x32x16_bf16 v[96:111], v[132:135], v[128:131], v[96:111]
    v_mfma_f32_32x32x16_bf16 v[96:111], v[136:139], v[128:131], v[96:111]
    v_mfma_f32_32x32x16_bf16 v[112:127], v[140:143], v[128:131], v[112:127]
    v_mfma_f32_32x32x16_bf16 v[112:127], v[144:147], v[128:131], v[112:127]
    ds_read_b128 v[128:131], v8 offset:832
    ds_read_b128 v[132:135], v7 offset:480
    ds_read_b128 v[136:139], v7 offset:8160
    ds_read_b128 v[140:143], v7 offset:3040
    ds_read_b128 v[144:147], v7 offset:10720
    s_waitcnt lgkmcnt(5)
    v_mfma_f32_32x32x16_bf16 v[96:111], v[152:155], v[148:151], v[96:111]
    v_mfma_f32_32x32x16_bf16 v[96:111], v[156:159], v[148:151], v[96:111]
    v_mfma_f32_32x32x16_bf16 v[112:127], v[160:163], v[148:151], v[112:127]
    v_mfma_f32_32x32x16_bf16 v[112:127], v[164:167], v[148:151], v[112:127]
    ds_read_b128 v[148:151], v8 offset:864
    ds_read_b128 v[152:155], v7 offset:512
    ds_read_b128 v[156:159], v7 offset:8192
    ds_read_b128 v[160:163], v7 offset:3072
    ds_read_b128 v[164:167], v7 offset:10752
    s_waitcnt lgkmcnt(5)
    v_mfma_f32_32x32x16_bf16 v[96:111], v[132:135], v[128:131], v[96:111]
    v_mfma_f32_32x32x16_bf16 v[96:111], v[136:139], v[128:131], v[96:111]
    v_mfma_f32_32x32x16_bf16 v[112:127], v[140:143], v[128:131], v[112:127]
    v_mfma_f32_32x32x16_bf16 v[112:127], v[144:147], v[128:131], v[112:127]
    ds_read_b128 v[128:131], v8 offset:768
    ds_read_b128 v[132:135], v7 offset:400
    ds_read_b128 v[136:139], v7 offset:8080
    ds_read_b128 v[140:143], v7 offset:2960
    ds_read_b128 v[144:147], v7 offset:10640
    s_waitcnt lgkmcnt(5)
    v_mfma_f32_32x32x16_bf16 v[96:111], v[152:155], v[148:151], v[96:111]
    v_mfma_f32_32x32x16_bf16 v[96:111], v[156:159], v[148:151], v[96:111]
    v_mfma_f32_32x32x16_bf16 v[112:127], v[160:163], v[148:151], v[112:127]
    v_mfma_f32_32x32x16_bf16 v[112:127], v[164:167], v[148:151], v[112:127]
    ds_read_b128 v[148:151], v8 offset:800
    ds_read_b128 v[152:155], v7 offset:432
    ds_read_b128 v[156:159], v7 offset:8112
    ds_read_b128 v[160:163], v7 offset:2992
    ds_read_b128 v[164:167], v7 offset:10672
    s_waitcnt lgkmcnt(5)
    v_mfma_f32_32x32x16_bf16 v[96:111], v[132:135], v[128:131], v[96:111]
    v_mfma_f32_32x32x16_bf16 v[96:111], v[136:139], v[128:131], v[96:111]
    v_mfma_f32_32x32x16_bf16 v[112:127], v[140:143], v[128:131], v[112:127]
    v_mfma_f32_32x32x16_bf16 v[112:127], v[144:147], v[128:131], v[112:127]
    ds_read_b128 v[128:131], v8 offset:704
    ds_read_b128 v[132:135], v7 offset:320
    ds_read_b128 v[136:139], v7 offset:8000
    ds_read_b128 v[140:143], v7 offset:2880
    ds_read_b128 v[144:147], v7 offset:10560
    s_waitcnt lgkmcnt(5)
    v_mfma_f32_32x32x16_bf16 v[96:111], v[152:155], v[148:151], v[96:111]
    v_mfma_f32_32x32x16_bf16 v[96:111], v[156:159], v[148:151], v[96:111]
    v_mfma_f32_32x32x16_bf16 v[112:127], v[160:163], v[148:151], v[112:127]
    v_mfma_f32_32x32x16_bf16 v[112:127], v[164:167], v[148:151], v[112:127]
    ds_read_b128 v[148:151], v8 offset:736
    ds_read_b128 v[152:155], v7 offset:352
    ds_read_b128 v[156:159], v7 offset:8032
    ds_read_b128 v[160:163], v7 offset:2912
    ds_read_b128 v[164:167], v7 offset:10592
    s_waitcnt lgkmcnt(5)
    v_mfma_f32_32x32x16_bf16 v[96:111], v[132:135], v[128:131], v[96:111]
    v_mfma_f32_32x32x16_bf16 v[96:111], v[136:139], v[128:131], v[96:111]
    v_mfma_f32_32x32x16_bf16 v[112:127], v[140:143], v[128:131], v[112:127]
    v_mfma_f32_32x32x16_bf16 v[112:127], v[144:147], v[128:131], v[112:127]
    ds_read_b128 v[128:131], v8 offset:640
    ds_read_b128 v[132:135], v7 offset:240
    ds_read_b128 v[136:139], v7 offset:7920
    ds_read_b128 v[140:143], v7 offset:2800
    ds_read_b128 v[144:147], v7 offset:10480
    s_waitcnt lgkmcnt(5)
    v_mfma_f32_32x32x16_bf16 v[96:111], v[152:155], v[148:151], v[96:111]
    v_mfma_f32_32x32x16_bf16 v[96:111], v[156:159], v[148:151], v[96:111]
    v_mfma_f32_32x32x16_bf16 v[112:127], v[160:163], v[148:151], v[112:127]
    v_mfma_f32_32x32x16_bf16 v[112:127], v[164:167], v[148:151], v[112:127]
    ds_read_b128 v[148:151], v8 offset:672
    ds_read_b128 v[152:155], v7 offset:272
    ds_read_b128 v[156:159], v7 offset:7952
    ds_read_b128 v[160:163], v7 offset:2832
    ds_read_b128 v[164:167], v7 offset:10512
    s_waitcnt lgkmcnt(5)
    v_mfma_f32_32x32x16_bf16 v[96:111], v[132:135], v[128:131], v[96:111]
    v_mfma_f32_32x32x16_bf16 v[96:111], v[136:139], v[128:131], v[96:111]
    v_mfma_f32_32x32x16_bf16 v[112:127], v[140:143], v[128:131], v[112:127]
    v_mfma_f32_32x32x16_bf16 v[112:127], v[144:147], v[128:131], v[112:127]
    ds_read_b128 v[128:131], v8 offset:576
    ds_read_b128 v[132:135], v7 offset:160
    ds_read_b128 v[136:139], v7 offset:7840
    ds_read_b128 v[140:143], v7 offset:2720
    ds_read_b128 v[144:147], v7 offset:10400
    s_waitcnt lgkmcnt(5)
    v_mfma_f32_32x32x16_bf16 v[96:111], v[152:155], v[148:151], v[96:111]
    v_mfma_f32_32x32x16_bf16 v[96:111], v[156:159], v[148:151], v[96:111]
    v_mfma_f32_32x32x16_bf16 v[112:127], v[160:163], v[148:151], v[112:127]
    v_mfma_f32_32x32x16_bf16 v[112:127], v[164:167], v[148:151], v[112:127]
    ds_read_b128 v[148:151], v8 offset:608
    ds_read_b128 v[152:155], v7 offset:192
    ds_read_b128 v[156:159], v7 offset:7872
    ds_read_b128 v[160:163], v7 offset:2752
    ds_read_b128 v[164:167], v7 offset:10432
    s_waitcnt lgkmcnt(5)
    v_mfma_f32_32x32x16_bf16 v[96:111], v[132:135], v[128:131], v[96:111]
    v_mfma_f32_32x32x16_bf16 v[96:111], v[136:139], v[128:131], v[96:111]
    v_mfma_f32_32x32x16_bf16 v[112:127], v[140:143], v[128:131], v[112:127]
    v_mfma_f32_32x32x16_bf16 v[112:127], v[144:147], v[128:131], v[112:127]
    ds_read_b128 v[128:131], v8 offset:512
    ds_read_b128 v[132:135], v7 offset:80
    ds_read_b128 v[136:139], v7 offset:7760
    ds_read_b128 v[140:143], v7 offset:2640
    ds_read_b128 v[144:147], v7 offset:10320
    s_waitcnt lgkmcnt(5)
    v_mfma_f32_32x32x16_bf16 v[96:111], v[152:155], v[148:151], v[96:111]
    v_mfma_f32_32x32x16_bf16 v[96:111], v[156:159], v[148:151], v[96:111]
    v_mfma_f32_32x32x16_bf16 v[112:127], v[160:163], v[148:151], v[112:127]
    v_mfma_f32_32x32x16_bf16 v[112:127], v[164:167], v[148:151], v[112:127]
    ds_read_b128 v[148:151], v8 offset:544
    ds_read_b128 v[152:155], v7 offset:112
    ds_read_b128 v[156:159], v7 offset:7792
    ds_read_b128 v[160:163], v7 offset:2672
    ds_read_b128 v[164:167], v7 offset:10352
    s_waitcnt lgkmcnt(5)
    v_mfma_f32_32x32x16_bf16 v[96:111], v[132:135], v[128:131], v[96:111]
    v_mfma_f32_32x32x16_bf16 v[96:111], v[136:139], v[128:131], v[96:111]
    v_mfma_f32_32x32x16_bf16 v[112:127], v[140:143], v[128:131], v[112:127]
    v_mfma_f32_32x32x16_bf16 v[112:127], v[144:147], v[128:131], v[112:127]
    ds_read_b128 v[128:131], v8 offset:448
    ds_read_b128 v[132:135], v7 offset:2560
    ds_read_b128 v[136:139], v7 offset:10240
    s_waitcnt lgkmcnt(3)
    v_mfma_f32_32x32x16_bf16 v[96:111], v[152:155], v[148:151], v[96:111]
    v_mfma_f32_32x32x16_bf16 v[96:111], v[156:159], v[148:151], v[96:111]
    v_mfma_f32_32x32x16_bf16 v[112:127], v[160:163], v[148:151], v[112:127]
    v_mfma_f32_32x32x16_bf16 v[112:127], v[164:167], v[148:151], v[112:127]
    ds_read_b128 v[148:151], v8 offset:480
    ds_read_b128 v[152:155], v7 offset:2592
    ds_read_b128 v[156:159], v7 offset:10272
    s_waitcnt lgkmcnt(3)
    v_mfma_f32_32x32x16_bf16 v[112:127], v[132:135], v[128:131], v[112:127]
    v_mfma_f32_32x32x16_bf16 v[112:127], v[136:139], v[128:131], v[112:127]
    ds_read_b128 v[128:131], v8 offset:384
    ds_read_b128 v[132:135], v7 offset:2480
    ds_read_b128 v[136:139], v7 offset:10160
    s_waitcnt lgkmcnt(3)
    v_mfma_f32_32x32x16_bf16 v[112:127], v[152:155], v[148:151], v[112:127]
    v_mfma_f32_32x32x16_bf16 v[112:127], v[156:159], v[148:151], v[112:127]
    ds_read_b128 v[148:151], v8 offset:416
    ds_read_b128 v[152:155], v7 offset:2512
    ds_read_b128 v[156:159], v7 offset:10192
    s_waitcnt lgkmcnt(3)
    v_mfma_f32_32x32x16_bf16 v[112:127], v[132:135], v[128:131], v[112:127]
    v_mfma_f32_32x32x16_bf16 v[112:127], v[136:139], v[128:131], v[112:127]
    ds_read_b128 v[128:131], v8 offset:320
    ds_read_b128 v[132:135], v7 offset:2400
    ds_read_b128 v[136:139], v7 offset:10080
    s_waitcnt lgkmcnt(3)
    v_mfma_f32_32x32x16_bf16 v[112:127], v[152:155], v[148:151], v[112:127]
    v_mfma_f32_32x32x16_bf16 v[112:127], v[156:159], v[148:151], v[112:127]
    ds_read_b128 v[148:151], v8 offset:352
    ds_read_b128 v[152:155], v7 offset:2432
    ds_read_b128 v[156:159], v7 offset:10112
    s_waitcnt lgkmcnt(3)
    v_mfma_f32_32x32x16_bf16 v[112:127], v[132:135], v[128:131], v[112:127]
    v_mfma_f32_32x32x16_bf16 v[112:127], v[136:139], v[128:131], v[112:127]
    ds_read_b128 v[128:131], v8 offset:256
    ds_read_b128 v[132:135], v7 offset:2320
    ds_read_b128 v[136:139], v7 offset:10000
    s_waitcnt lgkmcnt(3)
    v_mfma_f32_32x32x16_bf16 v[112:127], v[152:155], v[148:151], v[112:127]
    v_mfma_f32_32x32x16_bf16 v[112:127], v[156:159], v[148:151], v[112:127]
    ds_read_b128 v[148:151], v8 offset:288
    ds_read_b128 v[152:155], v7 offset:2352
    ds_read_b128 v[156:159], v7 offset:10032
    s_waitcnt lgkmcnt(3)
    v_mfma_f32_32x32x16_bf16 v[112:127], v[132:135], v[128:131], v[112:127]
    v_mfma_f32_32x32x16_bf16 v[112:127], v[136:139], v[128:131], v[112:127]
    ds_read_b128 v[128:131], v8 offset:192
    ds_read_b128 v[132:135], v7 offset:2240
    ds_read_b128 v[136:139], v7 offset:9920
    s_waitcnt lgkmcnt(3)
    v_mfma_f32_32x32x16_bf16 v[112:127], v[152:155], v[148:151], v[112:127]
    v_mfma_f32_32x32x16_bf16 v[112:127], v[156:159], v[148:151], v[112:127]
    ds_read_b128 v[148:151], v8 offset:224
    ds_read_b128 v[152:155], v7 offset:2272
    ds_read_b128 v[156:159], v7 offset:9952
    s_waitcnt lgkmcnt(3)
    v_mfma_f32_32x32x16_bf16 v[112:127], v[132:135], v[128:131], v[112:127]
    v_mfma_f32_32x32x16_bf16 v[112:127], v[136:139], v[128:131], v[112:127]
    ds_read_b128 v[128:131], v8 offset:128
    ds_read_b128 v[132:135], v7 offset:2160
    ds_read_b128 v[136:139], v7 offset:9840
    s_waitcnt lgkmcnt(3)
    v_mfma_f32_32x32x16_bf16 v[112:127], v[152:155], v[148:151], v[112:127]
    v_mfma_f32_32x32x16_bf16 v[112:127], v[156:159], v[148:151], v[112:127]
    ds_read_b128 v[148:151], v8 offset:160
    ds_read_b128 v[152:155], v7 offset:2192
    ds_read_b128 v[156:159], v7 offset:9872
    s_waitcnt lgkmcnt(3)
    v_mfma_f32_32x32x16_bf16 v[112:127], v[132:135], v[128:131], v[112:127]
    v_mfma_f32_32x32x16_bf16 v[112:127], v[136:139], v[128:131], v[112:127]
    ds_read_b128 v[128:131], v8 offset:64
    ds_read_b128 v[132:135], v7 offset:2080
    ds_read_b128 v[136:139], v7 offset:9760
    s_waitcnt lgkmcnt(3)
    v_mfma_f32_32x32x16_bf16 v[112:127], v[152:155], v[148:151], v[112:127]
    v_mfma_f32_32x32x16_bf16 v[112:127], v[156:159], v[148:151], v[112:127]
    ds_read_b128 v[148:151], v8 offset:96
    ds_read_b128 v[152:155], v7 offset:2112
    ds_read_b128 v[156:159], v7 offset:9792
    s_waitcnt lgkmcnt(3)
    v_mfma_f32_32x32x16_bf16 v[112:127], v[132:135], v[128:131], v[112:127]
    v_mfma_f32_32x32x16_bf16 v[112:127], v[136:139], v[128:131], v[112:127]
    ds_read_b128 v[128:131], v8 offset:0
    ds_read_b128 v[132:135], v7 offset:2000
    ds_read_b128 v[136:139], v7 offset:9680
    s_waitcnt lgkmcnt(3)
    v_mfma_f32_32x32x16_bf16 v[112:127], v[152:155], v[148:151], v[112:127]
    v_mfma_f32_32x32x16_bf16 v[112:127], v[156:159], v[148:151], v[112:127]
    ds_read_b128 v[148:151], v8 offset:32
    ds_read_b128 v[152:155], v7 offset:2032
    ds_read_b128 v[156:159], v7 offset:9712
    s_waitcnt lgkmcnt(3)
    v_mfma_f32_32x32x16_bf16 v[112:127], v[132:135], v[128:131], v[112:127]
    v_mfma_f32_32x32x16_bf16 v[112:127], v[136:139], v[128:131], v[112:127]
    s_waitcnt lgkmcnt(0)
    v_mfma_f32_32x32x16_bf16 v[112:127], v[152:155], v[148:151], v[112:127]
    v_mfma_f32_32x32x16_bf16 v[112:127], v[156:159], v[148:151], v[112:127]
    s_branch L_red_20
L_w_24:
    v_subrev_u32 v8, 4032, v6
    ds_read_b128 v[128:131], v8 offset:1472
    ds_read_b128 v[132:135], v7 offset:1920
    ds_read_b128 v[136:139], v7 offset:9600
    ds_read_b128 v[148:151], v8 offset:1504
    ds_read_b128 v[152:155], v7 offset:1952
    ds_read_b128 v[156:159], v7 offset:9632
    s_waitcnt lgkmcnt(3)
    v_mfma_f32_32x32x16_bf16 v[112:127], v[132:135], v[128:131], v[112:127]
    v_mfma_f32_32x32x16_bf16 v[112:127], v[136:139], v[128:131], v[112:127]
    ds_read_b128 v[128:131], v8 offset:1408
    ds_read_b128 v[132:135], v7 offset:1840
    ds_read_b128 v[136:139], v7 offset:9520
    s_waitcnt lgkmcnt(3)
    v_mfma_f32_32x32x16_bf16 v[112:127], v[152:155], v[148:151], v[112:127]
    v_mfma_f32_32x32x16_bf16 v[112:127], v[156:159], v[148:151], v[112:127]
    ds_read_b128 v[148:151], v8 offset:1440
    ds_read_b128 v[152:155], v7 offset:1872
    ds_read_b128 v[156:159], v7 offset:9552
    s_waitcnt lgkmcnt(3)
    v_mfma_f32_32x32x16_bf16 v[112:127], v[132:135], v[128:131], v[112:127]
    v_mfma_f32_32x32x16_bf16 v[112:127], v[136:139], v[128:131], v[112:127]
    ds_read_b128 v[128:131], v8 offset:1344
    ds_read_b128 v[132:135], v7 offset:1760
    ds_read_b128 v[136:139], v7 offset:9440
    s_waitcnt lgkmcnt(3)
    v_mfma_f32_32x32x16_bf16 v[112:127], v[152:155], v[148:151], v[112:127]
    v_mfma_f32_32x32x16_bf16 v[112:127], v[156:159], v[148:151], v[112:127]
    ds_read_b128 v[148:151], v8 offset:1376
    ds_read_b128 v[152:155], v7 offset:1792
    ds_read_b128 v[156:159], v7 offset:9472
    s_waitcnt lgkmcnt(3)
    v_mfma_f32_32x32x16_bf16 v[112:127], v[132:135], v[128:131], v[112:127]
    v_mfma_f32_32x32x16_bf16 v[112:127], v[136:139], v[128:131], v[112:127]
    ds_read_b128 v[128:131], v8 offset:1280
    ds_read_b128 v[132:135], v7 offset:1680
    ds_read_b128 v[136:139], v7 offset:9360
    s_waitcnt lgkmcnt(3)
    v_mfma_f32_32x32x16_bf16 v[112:127], v[152:155], v[148:151], v[112:127]
    v_mfma_f32_32x32x16_bf16 v[112:127], v[156:159], v[148:151], v[112:127]
    ds_read_b128 v[148:151], v8 offset:1312
    ds_read_b128 v[152:155], v7 offset:1712
    ds_read_b128 v[156:159], v7 offset:9392
    s_waitcnt lgkmcnt(3)
    v_mfma_f32_32x32x16_bf16 v[112:127], v[132:135], v[128:131], v[112:127]
    v_mfma_f32_32x32x16_bf16 v[112:127], v[136:139], v[128:131], v[112:127]
    ds_read_b128 v[128:131], v8 offset:1216
    ds_read_b128 v[132:135], v7 offset:1600
    ds_read_b128 v[136:139], v7 offset:9280
    s_waitcnt lgkmcnt(3)
    v_mfma_f32_32x32x16_bf16 v[112:127], v[152:155], v[148:151], v[112:127]
    v_mfma_f32_32x32x16_bf16 v[112:127], v[156:159], v[148:151], v[112:127]
    ds_read_b128 v[148:151], v8 offset:1248
    ds_read_b128 v[152:155], v7 offset:1632
    ds_read_b128 v[156:159], v7 offset:9312
    s_waitcnt lgkmcnt(3)
    v_mfma_f32_32x32x16_bf16 v[112:127], v[132:135], v[128:131], v[112:127]
    v_mfma_f32_32x32x16_bf16 v[112:127], v[136:139], v[128:131], v[112:127]
    ds_read_b128 v[128:131], v8 offset:1152
    ds_read_b128 v[132:135], v7 offset:1520
    ds_read_b128 v[136:139], v7 offset:9200
    s_waitcnt lgkmcnt(3)
    v_mfma_f32_32x32x16_bf16 v[112:127], v[152:155], v[148:151], v[112:127]
    v_mfma_f32_32x32x16_bf16 v[112:127], v[156:159], v[148:151], v[112:127]
    ds_read_b128 v[148:151], v8 offset:1184
    ds_read_b128 v[152:155], v7 offset:1552
    ds_read_b128 v[156:159], v7 offset:9232
    s_waitcnt lgkmcnt(3)
    v_mfma_f32_32x32x16_bf16 v[112:127], v[132:135], v[128:131], v[112:127]
    v_mfma_f32_32x32x16_bf16 v[112:127], v[136:139], v[128:131], v[112:127]
    ds_read_b128 v[128:131], v8 offset:1088
    ds_read_b128 v[132:135], v7 offset:1440
    ds_read_b128 v[136:139], v7 offset:9120
    s_waitcnt lgkmcnt(3)
    v_mfma_f32_32x32x16_bf16 v[112:127], v[152:155], v[148:151], v[112:127]
    v_mfma_f32_32x32x16_bf16 v[112:127], v[156:159], v[148:151], v[112:127]
    ds_read_b128 v[148:151], v8 offset:1120
    ds_read_b128 v[152:155], v7 offset:1472
    ds_read_b128 v[156:159], v7 offset:9152
    s_waitcnt lgkmcnt(3)
    v_mfma_f32_32x32x16_bf16 v[112:127], v[132:135], v[128:131], v[112:127]
    v_mfma_f32_32x32x16_bf16 v[112:127], v[136:139], v[128:131], v[112:127]
    ds_read_b128 v[128:131], v8 offset:1024
    ds_read_b128 v[132:135], v7 offset:1360
    ds_read_b128 v[136:139], v7 offset:9040
    s_waitcnt lgkmcnt(3)
    v_mfma_f32_32x32x16_bf16 v[112:127], v[152:155], v[148:151], v[112:127]
    v_mfma_f32_32x32x16_bf16 v[112:127], v[156:159], v[148:151], v[112:127]
    ds_read_b128 v[148:151], v8 offset:1056
    ds_read_b128 v[152:155], v7 offset:1392
    ds_read_b128 v[156:159], v7 offset:9072
    s_waitcnt lgkmcnt(3)
    v_mfma_f32_32x32x16_bf16 v[112:127], v[132:135], v[128:131], v[112:127]
    v_mfma_f32_32x32x16_bf16 v[112:127], v[136:139], v[128:131], v[112:127]
    ds_read_b128 v[128:131], v8 offset:960
    ds_read_b128 v[132:135], v7 offset:1280
    ds_read_b128 v[136:139], v7 offset:8960
    s_waitcnt lgkmcnt(3)
    v_mfma_f32_32x32x16_bf16 v[112:127], v[152:155], v[148:151], v[112:127]
    v_mfma_f32_32x32x16_bf16 v[112:127], v[156:159], v[148:151], v[112:127]
    ds_read_b128 v[148:151], v8 offset:992
    ds_read_b128 v[152:155], v7 offset:1312
    ds_read_b128 v[156:159], v7 offset:8992
    s_waitcnt lgkmcnt(3)
    v_mfma_f32_32x32x16_bf16 v[112:127], v[132:135], v[128:131], v[112:127]
    v_mfma_f32_32x32x16_bf16 v[112:127], v[136:139], v[128:131], v[112:127]
    ds_read_b128 v[128:131], v8 offset:896
    ds_read_b128 v[132:135], v7 offset:1200
    ds_read_b128 v[136:139], v7 offset:8880
    s_waitcnt lgkmcnt(3)
    v_mfma_f32_32x32x16_bf16 v[112:127], v[152:155], v[148:151], v[112:127]
    v_mfma_f32_32x32x16_bf16 v[112:127], v[156:159], v[148:151], v[112:127]
    ds_read_b128 v[148:151], v8 offset:928
    ds_read_b128 v[152:155], v7 offset:1232
    ds_read_b128 v[156:159], v7 offset:8912
    s_waitcnt lgkmcnt(3)
    v_mfma_f32_32x32x16_bf16 v[112:127], v[132:135], v[128:131], v[112:127]
    v_mfma_f32_32x32x16_bf16 v[112:127], v[136:139], v[128:131], v[112:127]
    ds_read_b128 v[128:131], v8 offset:832
    ds_read_b128 v[132:135], v7 offset:1120
    ds_read_b128 v[136:139], v7 offset:8800
    s_waitcnt lgkmcnt(3)
    v_mfma_f32_32x32x16_bf16 v[112:127], v[152:155], v[148:151], v[112:127]
    v_mfma_f32_32x32x16_bf16 v[112:127], v[156:159], v[148:151], v[112:127]
    ds_read_b128 v[148:151], v8 offset:864
    ds_read_b128 v[152:155], v7 offset:1152
    ds_read_b128 v[156:159], v7 offset:8832
    s_waitcnt lgkmcnt(3)
    v_mfma_f32_32x32x16_bf16 v[112:127], v[132:135], v[128:131], v[112:127]
    v_mfma_f32_32x32x16_bf16 v[112:127], v[136:139], v[128:131], v[112:127]
    ds_read_b128 v[128:131], v8 offset:768
    ds_read_b128 v[132:135], v7 offset:1040
    ds_read_b128 v[136:139], v7 offset:8720
    s_waitcnt lgkmcnt(3)
    v_mfma_f32_32x32x16_bf16 v[112:127], v[152:155], v[148:151], v[112:127]
    v_mfma_f32_32x32x16_bf16 v[112:127], v[156:159], v[148:151], v[112:127]
    ds_read_b128 v[148:151], v8 offset:800
    ds_read_b128 v[152:155], v7 offset:1072
    ds_read_b128 v[156:159], v7 offset:8752
    s_waitcnt lgkmcnt(3)
    v_mfma_f32_32x32x16_bf16 v[112:127], v[132:135], v[128:131], v[112:127]
    v_mfma_f32_32x32x16_bf16 v[112:127], v[136:139], v[128:131], v[112:127]
    ds_read_b128 v[128:131], v8 offset:704
    ds_read_b128 v[132:135], v7 offset:960
    ds_read_b128 v[136:139], v7 offset:8640
    s_waitcnt lgkmcnt(3)
    v_mfma_f32_32x32x16_bf16 v[112:127], v[152:155], v[148:151], v[112:127]
    v_mfma_f32_32x32x16_bf16 v[112:127], v[156:159], v[148:151], v[112:127]
    ds_read_b128 v[148:151], v8 offset:736
    ds_read_b128 v[152:155], v7 offset:992
    ds_read_b128 v[156:159], v7 offset:8672
    s_waitcnt lgkmcnt(3)
    v_mfma_f32_32x32x16_bf16 v[112:127], v[132:135], v[128:131], v[112:127]
    v_mfma_f32_32x32x16_bf16 v[112:127], v[136:139], v[128:131], v[112:127]
    ds_read_b128 v[128:131], v8 offset:640
    ds_read_b128 v[132:135], v7 offset:880
    ds_read_b128 v[136:139], v7 offset:8560
    s_waitcnt lgkmcnt(3)
    v_mfma_f32_32x32x16_bf16 v[112:127], v[152:155], v[148:151], v[112:127]
    v_mfma_f32_32x32x16_bf16 v[112:127], v[156:159], v[148:151], v[112:127]
    ds_read_b128 v[148:151], v8 offset:672
    ds_read_b128 v[152:155], v7 offset:912
    ds_read_b128 v[156:159], v7 offset:8592
    s_waitcnt lgkmcnt(3)
    v_mfma_f32_32x32x16_bf16 v[112:127], v[132:135], v[128:131], v[112:127]
    v_mfma_f32_32x32x16_bf16 v[112:127], v[136:139], v[128:131], v[112:127]
    ds_read_b128 v[128:131], v8 offset:576
    ds_read_b128 v[132:135], v7 offset:800
    ds_read_b128 v[136:139], v7 offset:8480
    s_waitcnt lgkmcnt(3)
    v_mfma_f32_32x32x16_bf16 v[112:127], v[152:155], v[148:151], v[112:127]
    v_mfma_f32_32x32x16_bf16 v[112:127], v[156:159], v[148:151], v[112:127]
    ds_read_b128 v[148:151], v8 offset:608
    ds_read_b128 v[152:155], v7 offset:832
    ds_read_b128 v[156:159], v7 offset:8512
    s_waitcnt lgkmcnt(3)
    v_mfma_f32_32x32x16_bf16 v[112:127], v[132:135], v[128:131], v[112:127]
    v_mfma_f32_32x32x16_bf16 v[112:127], v[136:139], v[128:131], v[112:127]
    ds_read_b128 v[128:131], v8 offset:512
    ds_read_b128 v[132:135], v7 offset:720
    ds_read_b128 v[136:139], v7 offset:8400
    s_waitcnt lgkmcnt(3)
    v_mfma_f32_32x32x16_bf16 v[112:127], v[152:155], v[148:151], v[112:127]
    v_mfma_f32_32x32x16_bf16 v[112:127], v[156:159], v[148:151], v[112:127]
    ds_read_b128 v[148:151], v8 offset:544
    ds_read_b128 v[152:155], v7 offset:752
    ds_read_b128 v[156:159], v7 offset:8432
    s_waitcnt lgkmcnt(3)
    v_mfma_f32_32x32x16_bf16 v[112:127], v[132:135], v[128:131], v[112:127]
    v_mfma_f32_32x32x16_bf16 v[112:127], v[136:139], v[128:131], v[112:127]
    ds_read_b128 v[128:131], v8 offset:448
    ds_read_b128 v[132:135], v7 offset:640
    ds_read_b128 v[136:139], v7 offset:8320
    s_waitcnt lgkmcnt(3)
    v_mfma_f32_32x32x16_bf16 v[112:127], v[152:155], v[148:151], v[112:127]
    v_mfma_f32_32x32x16_bf16 v[112:127], v[156:159], v[148:151], v[112:127]
    ds_read_b128 v[148:151], v8 offset:480
    ds_read_b128 v[152:155], v7 offset:672
    ds_read_b128 v[156:159], v7 offset:8352
    s_waitcnt lgkmcnt(3)
    v_mfma_f32_32x32x16_bf16 v[112:127], v[132:135], v[128:131], v[112:127]
    v_mfma_f32_32x32x16_bf16 v[112:127], v[136:139], v[128:131], v[112:127]
    ds_read_b128 v[128:131], v8 offset:384
    ds_read_b128 v[132:135], v7 offset:560
    ds_read_b128 v[136:139], v7 offset:8240
    s_waitcnt lgkmcnt(3)
    v_mfma_f32_32x32x16_bf16 v[112:127], v[152:155], v[148:151], v[112:127]
    v_mfma_f32_32x32x16_bf16 v[112:127], v[156:159], v[148:151], v[112:127]
    ds_read_b128 v[148:151], v8 offset:416
    ds_read_b128 v[152:155], v7 offset:592
    ds_read_b128 v[156:159], v7 offset:8272
    s_waitcnt lgkmcnt(3)
    v_mfma_f32_32x32x16_bf16 v[112:127], v[132:135], v[128:131], v[112:127]
    v_mfma_f32_32x32x16_bf16 v[112:127], v[136:139], v[128:131], v[112:127]
    ds_read_b128 v[128:131], v8 offset:320
    ds_read_b128 v[132:135], v7 offset:480
    ds_read_b128 v[136:139], v7 offset:8160
    s_waitcnt lgkmcnt(3)
    v_mfma_f32_32x32x16_bf16 v[112:127], v[152:155], v[148:151], v[112:127]
    v_mfma_f32_32x32x16_bf16 v[112:127], v[156:159], v[148:151], v[112:127]
    ds_read_b128 v[148:151], v8 offset:352
    ds_read_b128 v[152:155], v7 offset:512
    ds_read_b128 v[156:159], v7 offset:8192
    s_waitcnt lgkmcnt(3)
    v_mfma_f32_32x32x16_bf16 v[112:127], v[132:135], v[128:131], v[112:127]
    v_mfma_f32_32x32x16_bf16 v[112:127], v[136:139], v[128:131], v[112:127]
    ds_read_b128 v[128:131], v8 offset:256
    ds_read_b128 v[132:135], v7 offset:400
    ds_read_b128 v[136:139], v7 offset:8080
    s_waitcnt lgkmcnt(3)
    v_mfma_f32_32x32x16_bf16 v[112:127], v[152:155], v[148:151], v[112:127]
    v_mfma_f32_32x32x16_bf16 v[112:127], v[156:159], v[148:151], v[112:127]
    ds_read_b128 v[148:151], v8 offset:288
    ds_read_b128 v[152:155], v7 offset:432
    ds_read_b128 v[156:159], v7 offset:8112
    s_waitcnt lgkmcnt(3)
    v_mfma_f32_32x32x16_bf16 v[112:127], v[132:135], v[128:131], v[112:127]
    v_mfma_f32_32x32x16_bf16 v[112:127], v[136:139], v[128:131], v[112:127]
    ds_read_b128 v[128:131], v8 offset:192
    ds_read_b128 v[132:135], v7 offset:320
    ds_read_b128 v[136:139], v7 offset:8000
    s_waitcnt lgkmcnt(3)
    v_mfma_f32_32x32x16_bf16 v[112:127], v[152:155], v[148:151], v[112:127]
    v_mfma_f32_32x32x16_bf16 v[112:127], v[156:159], v[148:151], v[112:127]
    ds_read_b128 v[148:151], v8 offset:224
    ds_read_b128 v[152:155], v7 offset:352
    ds_read_b128 v[156:159], v7 offset:8032
    s_waitcnt lgkmcnt(3)
    v_mfma_f32_32x32x16_bf16 v[112:127], v[132:135], v[128:131], v[112:127]
    v_mfma_f32_32x32x16_bf16 v[112:127], v[136:139], v[128:131], v[112:127]
    ds_read_b128 v[128:131], v8 offset:128
    ds_read_b128 v[132:135], v7 offset:240
    ds_read_b128 v[136:139], v7 offset:7920
    s_waitcnt lgkmcnt(3)
    v_mfma_f32_32x32x16_bf16 v[112:127], v[152:155], v[148:151], v[112:127]
    v_mfma_f32_32x32x16_bf16 v[112:127], v[156:159], v[148:151], v[112:127]
    ds_read_b128 v[148:151], v8 offset:160
    ds_read_b128 v[152:155], v7 offset:272
    ds_read_b128 v[156:159], v7 offset:7952
    s_waitcnt lgkmcnt(3)
    v_mfma_f32_32x32x16_bf16 v[112:127], v[132:135], v[128:131], v[112:127]
    v_mfma_f32_32x32x16_bf16 v[112:127], v[136:139], v[128:131], v[112:127]
    ds_read_b128 v[128:131], v8 offset:64
    ds_read_b128 v[132:135], v7 offset:160
    ds_read_b128 v[136:139], v7 offset:7840
    s_waitcnt lgkmcnt(3)
    v_mfma_f32_32x32x16_bf16 v[112:127], v[152:155], v[148:151], v[112:127]
    v_mfma_f32_32x32x16_bf16 v[112:127], v[156:159], v[148:151], v[112:127]
    ds_read_b128 v[148:151], v8 offset:96
    ds_read_b128 v[152:155], v7 offset:192
    ds_read_b128 v[156:159], v7 offset:7872
    s_waitcnt lgkmcnt(3)
    v_mfma_f32_32x32x16_bf16 v[112:127], v[132:135], v[128:131], v[112:127]
    v_mfma_f32_32x32x16_bf16 v[112:127], v[136:139], v[128:131], v[112:127]
    ds_read_b128 v[128:131], v8 offset:0
    ds_read_b128 v[132:135], v7 offset:80
    ds_read_b128 v[136:139], v7 offset:7760
    s_waitcnt lgkmcnt(3)
    v_mfma_f32_32x32x16_bf16 v[112:127], v[152:155], v[148:151], v[112:127]
    v_mfma_f32_32x32x16_bf16 v[112:127], v[156:159], v[148:151], v[112:127]
    ds_read_b128 v[148:151], v8 offset:32
    ds_read_b128 v[152:155], v7 offset:112
    ds_read_b128 v[156:159], v7 offset:7792
    s_waitcnt lgkmcnt(3)
    v_mfma_f32_32x32x16_bf16 v[112:127], v[132:135], v[128:131], v[112:127]
    v_mfma_f32_32x32x16_bf16 v[112:127], v[136:139], v[128:131], v[112:127]
    s_waitcnt lgkmcnt(0)
    v_mfma_f32_32x32x16_bf16 v[112:127], v[152:155], v[148:151], v[112:127]
    v_mfma_f32_32x32x16_bf16 v[112:127], v[156:159], v[148:151], v[112:127]
    s_branch L_red_20
L_red_20:
    s_nop 7
    s_nop 7
    s_barrier
    s_lshl_b32 s31, s30, 13
    v_lshlrev_b32 v9, 2, v1
    v_add_u32 v9, s31, v9
    ds_write_b32 v9, v96 offset:0
    ds_write_b32 v9, v97 offset:256
    ds_write_b32 v9, v98 offset:512
    ds_write_b32 v9, v99 offset:768
    ds_write_b32 v9, v100 offset:1024
    ds_write_b32 v9, v101 offset:1280
    ds_write_b32 v9, v102 offset:1536
    ds_write_b32 v9, v103 offset:1792
    ds_write_b32 v9, v104 offset:2048
    ds_write_b32 v9, v105 offset:2304
    ds_write_b32 v9, v106 offset:2560
    ds_write_b32 v9, v107 offset:2816
    ds_write_b32 v9, v108 offset:3072
    ds_write_b32 v9, v109 offset:3328
    ds_write_b32 v9, v110 offset:3584
    ds_write_b32 v9, v111 offset:3840
    ds_write_b32 v9, v112 offset:4096
    ds_write_b32 v9, v113 offset:4352
    ds_write_b32 v9, v114 offset:4608
    ds_write_b32 v9, v115 offset:4864
    ds_write_b32 v9, v116 offset:5120
    ds_write_b32 v9, v117 offset:5376
    ds_write_b32 v9, v118 offset:5632
    ds_write_b32 v9, v119 offset:5888
    ds_write_b32 v9, v120 offset:6144
    ds_write_b32 v9, v121 offset:6400
    ds_write_b32 v9, v122 offset:6656
    ds_write_b32 v9, v123 offset:6912
    ds_write_b32 v9, v124 offset:7168
    ds_write_b32 v9, v125 offset:7424
    ds_write_b32 v9, v126 offset:7680
    ds_write_b32 v9, v127 offset:7936
    s_waitcnt lgkmcnt(0)
    s_barrier
    s_lshl_b32 s31, s30, 11
    v_lshlrev_b32 v9, 2, v1
    v_add_u32 v9, s31, v9
    ds_read_b32 v128, v9 offset:0
    ds_read_b32 v129, v9 offset:8192
    ds_read_b32 v130, v9 offset:16384
    ds_read_b32 v131, v9 offset:24576
    ds_read_b32 v132, v9 offset:256
    ds_read_b32 v133, v9 offset:8448
    ds_read_b32 v134, v9 offset:16640
    ds_read_b32 v135, v9 offset:24832
    ds_read_b32 v136, v9 offset:512
    ds_read_b32 v137, v9 offset:8704
    ds_read_b32 v138, v9 offset:16896
    ds_read_b32 v139, v9 offset:25088
    ds_read_b32 v140, v9 offset:768
    ds_read_b32 v141, v9 offset:8960
    ds_read_b32 v142, v9 offset:17152
    ds_read_b32 v143, v9 offset:25344
    ds_read_b32 v144, v9 offset:1024
    ds_read_b32 v145, v9 offset:9216
    ds_read_b32 v146, v9 offset:17408
    ds_read_b32 v147, v9 offset:25600
    ds_read_b32 v148, v9 offset:1280
    ds_read_b32 v149, v9 offset:9472
    ds_read_b32 v150, v9 offset:17664
    ds_read_b32 v151, v9 offset:25856
    ds_read_b32 v152, v9 offset:1536
    ds_read_b32 v153, v9 offset:9728
    ds_read_b32 v154, v9 offset:17920
    ds_read_b32 v155, v9 offset:26112
    ds_read_b32 v156, v9 offset:1792
    ds_read_b32 v157, v9 offset:9984
    ds_read_b32 v158, v9 offset:18176
    ds_read_b32 v159, v9 offset:26368
    s_lshr_b32 s34, s30, 1
    s_and_b32 s35, s30, 1
    s_lshl_b32 s34, s34, 10
    s_lshl_b32 s35, s35, 9
    s_add_u32 s34, s34, s35
    v_lshl_add_u32 v10, v4, 7, v3
    v_add_u32 v10, s34, v10
    v_add_u32 v11, 0, v10
    v_lshlrev_b32 v11, 1, v11
    buffer_load_ushort v20, v11, s[12:15], 0 offen
    v_add_u32 v12, 32, v10
    v_lshlrev_b32 v12, 1, v12
    buffer_load_ushort v21, v12, s[12:15], 0 offen
    v_add_u32 v13, 64, v10
    v_lshlrev_b32 v13, 1, v13
    buffer_load_ushort v22, v13, s[12:15], 0 offen
    v_add_u32 v14, 96, v10
    v_lshlrev_b32 v14, 1, v14
    buffer_load_ushort v23, v14, s[12:15], 0 offen
    v_add_u32 v15, 256, v10
    v_lshlrev_b32 v15, 1, v15
    buffer_load_ushort v24, v15, s[12:15], 0 offen
    v_add_u32 v16, 288, v10
    v_lshlrev_b32 v16, 1, v16
    buffer_load_ushort v25, v16, s[12:15], 0 offen
    v_add_u32 v17, 320, v10
    v_lshlrev_b32 v17, 1, v17
    buffer_load_ushort v26, v17, s[12:15], 0 offen
    v_add_u32 v18, 352, v10
    v_lshlrev_b32 v18, 1, v18
    buffer_load_ushort v27, v18, s[12:15], 0 offen
    v_lshlrev_b32 v31, 16, v31
    s_waitcnt lgkmcnt(0)
    v_add_f32 v128, v128, v129
    v_add_f32 v130, v130, v131
    v_add_f32 v132, v132, v133
    v_add_f32 v134, v134, v135
    v_add_f32 v136, v136, v137
    v_add_f32 v138, v138, v139
    v_add_f32 v140, v140, v141
    v_add_f32 v142, v142, v143
    v_add_f32 v144, v144, v145
    v_add_f32 v146, v146, v147
    v_add_f32 v148, v148, v149
    v_add_f32 v150, v150, v151
    v_add_f32 v152, v152, v153
    v_add_f32 v154, v154, v155
    v_add_f32 v156, v156, v157
    v_add_f32 v158, v158, v159
    v_add_f32 v128, v128, v130
    v_add_f32 v132, v132, v134
    v_add_f32 v136, v136, v138
    v_add_f32 v140, v140, v142
    v_add_f32 v144, v144, v146
    v_add_f32 v148, v148, v150
    v_add_f32 v152, v152, v154
    v_add_f32 v156, v156, v158
    v_cvt_pk_bf16_f32 v128, v128, v128
    v_lshlrev_b32 v128, 16, v128
    v_cvt_pk_bf16_f32 v132, v132, v132
    v_lshlrev_b32 v132, 16, v132
    v_cvt_pk_bf16_f32 v136, v136, v136
    v_lshlrev_b32 v136, 16, v136
    v_cvt_pk_bf16_f32 v140, v140, v140
    v_lshlrev_b32 v140, 16, v140
    v_cvt_pk_bf16_f32 v144, v144, v144
    v_lshlrev_b32 v144, 16, v144
    v_cvt_pk_bf16_f32 v148, v148, v148
    v_lshlrev_b32 v148, 16, v148
    v_cvt_pk_bf16_f32 v152, v152, v152
    v_lshlrev_b32 v152, 16, v152
    v_cvt_pk_bf16_f32 v156, v156, v156
    v_lshlrev_b32 v156, 16, v156
    s_waitcnt vmcnt(0)
    v_lshlrev_b32 v20, 16, v20
    v_mul_f32 v20, v20, v31
    v_lshlrev_b32 v21, 16, v21
    v_mul_f32 v21, v21, v31
    v_lshlrev_b32 v22, 16, v22
    v_mul_f32 v22, v22, v31
    v_lshlrev_b32 v23, 16, v23
    v_mul_f32 v23, v23, v31
    v_lshlrev_b32 v24, 16, v24
    v_mul_f32 v24, v24, v31
    v_lshlrev_b32 v25, 16, v25
    v_mul_f32 v25, v25, v31
    v_lshlrev_b32 v26, 16, v26
    v_mul_f32 v26, v26, v31
    v_lshlrev_b32 v27, 16, v27
    v_mul_f32 v27, v27, v31
    v_cvt_pk_bf16_f32 v20, v20, v20
    v_lshlrev_b32 v20, 16, v20
    v_cvt_pk_bf16_f32 v21, v21, v21
    v_lshlrev_b32 v21, 16, v21
    v_cvt_pk_bf16_f32 v22, v22, v22
    v_lshlrev_b32 v22, 16, v22
    v_cvt_pk_bf16_f32 v23, v23, v23
    v_lshlrev_b32 v23, 16, v23
    v_cvt_pk_bf16_f32 v24, v24, v24
    v_lshlrev_b32 v24, 16, v24
    v_cvt_pk_bf16_f32 v25, v25, v25
    v_lshlrev_b32 v25, 16, v25
    v_cvt_pk_bf16_f32 v26, v26, v26
    v_lshlrev_b32 v26, 16, v26
    v_cvt_pk_bf16_f32 v27, v27, v27
    v_lshlrev_b32 v27, 16, v27
    v_add_f32 v20, v20, v128
    v_add_f32 v21, v21, v132
    v_add_f32 v22, v22, v136
    v_add_f32 v23, v23, v140
    v_add_f32 v24, v24, v144
    v_add_f32 v25, v25, v148
    v_add_f32 v26, v26, v152
    v_add_f32 v27, v27, v156
    v_cvt_pk_bf16_f32 v20, v20, v20
    buffer_store_short v20, v11, s[16:19], 0 offen
    v_cvt_pk_bf16_f32 v21, v21, v21
    buffer_store_short v21, v12, s[16:19], 0 offen
    v_cvt_pk_bf16_f32 v22, v22, v22
    buffer_store_short v22, v13, s[16:19], 0 offen
    v_cvt_pk_bf16_f32 v23, v23, v23
    buffer_store_short v23, v14, s[16:19], 0 offen
    v_cvt_pk_bf16_f32 v24, v24, v24
    buffer_store_short v24, v15, s[16:19], 0 offen
    v_cvt_pk_bf16_f32 v25, v25, v25
    buffer_store_short v25, v16, s[16:19], 0 offen
    v_cvt_pk_bf16_f32 v26, v26, v26
    buffer_store_short v26, v17, s[16:19], 0 offen
    v_cvt_pk_bf16_f32 v27, v27, v27
    buffer_store_short v27, v18, s[16:19], 0 offen
L_end_19:
    s_endpgm
.text
.globl ln2_kernel
.p2align 8
.type ln2_kernel,@function
ln2_kernel:
    s_cmp_ge_u32 s2, 128
    s_cbranch_scc1 L_end_25
    s_load_dwordx2 s[4:5], s[0:1], 0
    s_load_dwordx2 s[6:7], s[0:1], 112
    s_waitcnt lgkmcnt(0)
    s_mov_b32 s8, s4
    s_mov_b32 s9, s5
    s_mov_b32 s10, 0x280000
    s_mov_b32 s11, 0x00020000
    s_add_u32 s12, s6, 0x920000
    s_addc_u32 s13, s7, 0
    s_mov_b32 s14, 0x280000
    s_mov_b32 s15, 0x00020000
    s_add_u32 s32, s6, 0x420000
    s_addc_u32 s33, s7, 0
    s_mov_b32 s34, 0x280000
    s_mov_b32 s35, 0x00020000
    s_add_u32 s36, s6, 0x6a0000
    s_addc_u32 s37, s7, 0
    s_mov_b32 s38, 0x280000
    s_mov_b32 s39, 0x00020000
    s_mul_i32 s17, s2, 20480
    v_and_b32 v1, 63, v0
    v_lshrrev_b32 v2, 6, v0
    v_mul_u32_u24 v3, 5120, v2
    v_lshl_add_u32 v3, v1, 2, v3
    s_add_u32 s20, s17, 0
    s_add_u32 s21, s17, 1280
    s_add_u32 s22, s17, 2560
    s_add_u32 s23, s17, 3840
    buffer_load_dword v10, v3, s[8:11], s20 offen offset:0
    buffer_load_dword v11, v3, s[8:11], s20 offen offset:256
    buffer_load_dword v12, v3, s[8:11], s20 offen offset:512
    buffer_load_dword v13, v3, s[8:11], s20 offen offset:768
    buffer_load_dword v14, v3, s[8:11], s20 offen offset:1024
    buffer_load_dword v15, v3, s[8:11], s21 offen offset:0
    buffer_load_dword v16, v3, s[8:11], s21 offen offset:256
    buffer_load_dword v17, v3, s[8:11], s21 offen offset:512
    buffer_load_dword v18, v3, s[8:11], s21 offen offset:768
    buffer_load_dword v19, v3, s[8:11], s21 offen offset:1024
    buffer_load_dword v20, v3, s[8:11], s22 offen offset:0
    buffer_load_dword v21, v3, s[8:11], s22 offen offset:256
    buffer_load_dword v22, v3, s[8:11], s22 offen offset:512
    buffer_load_dword v23, v3, s[8:11], s22 offen offset:768
    buffer_load_dword v24, v3, s[8:11], s22 offen offset:1024
    buffer_load_dword v25, v3, s[8:11], s23 offen offset:0
    buffer_load_dword v26, v3, s[8:11], s23 offen offset:256
    buffer_load_dword v27, v3, s[8:11], s23 offen offset:512
    buffer_load_dword v28, v3, s[8:11], s23 offen offset:768
    buffer_load_dword v29, v3, s[8:11], s23 offen offset:1024
    v_lshlrev_b32 v5, 5, v0
    v_lshlrev_b32 v6, 12, v0
    s_lshl_b32 s18, s2, 5
    s_add_u32 s19, s18, 1048576
    s_add_u32 s28, s18, 2097152
    buffer_load_dwordx4 v[96:99], v6, s[32:35], s18 offen
    buffer_load_dwordx4 v[100:103], v6, s[32:35], s18 offen offset:16
    buffer_load_dwordx4 v[104:107], v6, s[32:35], s19 offen
    buffer_load_dwordx4 v[108:111], v6, s[32:35], s19 offen offset:16
    v_cmp_gt_u32 vcc, 128, v0
    s_and_saveexec_b64 s[30:31], vcc
    s_cbranch_execz L_skip_26
    buffer_load_dwordx4 v[112:115], v6, s[32:35], s28 offen
    buffer_load_dwordx4 v[116:119], v6, s[32:35], s28 offen offset:16
    s_waitcnt vmcnt(0)
    ds_write_b128 v5, v[112:115] offset:16384
    ds_write_b128 v5, v[116:119] offset:16400
L_skip_26:
    s_mov_b64 exec, s[30:31]
    s_waitcnt vmcnt(0)
    ds_write_b128 v5, v[96:99] offset:0
    ds_write_b128 v5, v[100:103] offset:16
    ds_write_b128 v5, v[104:107] offset:8192
    ds_write_b128 v5, v[108:111] offset:8208
    s_waitcnt lgkmcnt(0)
    s_barrier
    v_lshlrev_b32 v4, 6, v1
    v_lshl_add_u32 v4, v2, 3, v4
    ds_read_b64 v[96:97], v4 offset:0
    ds_read_b64 v[98:99], v4 offset:32
    ds_read_b64 v[100:101], v4 offset:4096
    ds_read_b64 v[102:103], v4 offset:4128
    ds_read_b64 v[104:105], v4 offset:8192
    ds_read_b64 v[106:107], v4 offset:8224
    ds_read_b64 v[108:109], v4 offset:12288
    ds_read_b64 v[110:111], v4 offset:12320
    ds_read_b64 v[112:113], v4 offset:16384
    ds_read_b64 v[114:115], v4 offset:16416
    v_lshlrev_b32 v30, 16, v10
    v_and_b32 v31, 0xffff0000, v10
    v_lshlrev_b32 v32, 16, v11
    v_and_b32 v33, 0xffff0000, v11
    v_lshlrev_b32 v34, 16, v12
    v_and_b32 v35, 0xffff0000, v12
    v_lshlrev_b32 v36, 16, v13
    v_and_b32 v37, 0xffff0000, v13
    v_lshlrev_b32 v38, 16, v14
    v_and_b32 v39, 0xffff0000, v14
    v_lshlrev_b32 v40, 16, v15
    v_and_b32 v41, 0xffff0000, v15
    v_lshlrev_b32 v42, 16, v16
    v_and_b32 v43, 0xffff0000, v16
    v_lshlrev_b32 v44, 16, v17
    v_and_b32 v45, 0xffff0000, v17
    v_lshlrev_b32 v46, 16, v18
    v_and_b32 v47, 0xffff0000, v18
    v_lshlrev_b32 v48, 16, v19
    v_and_b32 v49, 0xffff0000, v19
    v_lshlrev_b32 v50, 16, v20
    v_and_b32 v51, 0xffff0000, v20
    v_lshlrev_b32 v52, 16, v21
    v_and_b32 v53, 0xffff0000, v21
    v_lshlrev_b32 v54, 16, v22
    v_and_b32 v55, 0xffff0000, v22
    v_lshlrev_b32 v56, 16, v23
    v_and_b32 v57, 0xffff0000, v23
    v_lshlrev_b32 v58, 16, v24
    v_and_b32 v59, 0xffff0000, v24
    v_lshlrev_b32 v60, 16, v25
    v_and_b32 v61, 0xffff0000, v25
    v_lshlrev_b32 v62, 16, v26
    v_and_b32 v63, 0xffff0000, v26
    v_lshlrev_b32 v64, 16, v27
    v_and_b32 v65, 0xffff0000, v27
    v_lshlrev_b32 v66, 16, v28
    v_and_b32 v67, 0xffff0000, v28
    v_lshlrev_b32 v68, 16, v29
    v_and_b32 v69, 0xffff0000, v29
    s_waitcnt lgkmcnt(0)
    s_barrier
    v_lshlrev_b32 v120, 16, v96
    v_and_b32 v121, 0xffff0000, v96
    v_lshlrev_b32 v122, 16, v97
    v_and_b32 v123, 0xffff0000, v97
    v_add_f32 v30, v30, v120
    v_add_f32 v40, v40, v121
    v_add_f32 v50, v50, v122
    v_add_f32 v60, v60, v123
    v_cvt_pk_bf16_f32 v30, v30, v30
    v_lshlrev_b32 v30, 16, v30
    v_cvt_pk_bf16_f32 v40, v40, v40
    v_lshlrev_b32 v40, 16, v40
    v_cvt_pk_bf16_f32 v50, v50, v50
    v_lshlrev_b32 v50, 16, v50
    v_cvt_pk_bf16_f32 v60, v60, v60
    v_lshlrev_b32 v60, 16, v60
    v_lshlrev_b32 v120, 16, v98
    v_and_b32 v121, 0xffff0000, v98
    v_lshlrev_b32 v122, 16, v99
    v_and_b32 v123, 0xffff0000, v99
    v_add_f32 v31, v31, v120
    v_add_f32 v41, v41, v121
    v_add_f32 v51, v51, v122
    v_add_f32 v61, v61, v123
    v_cvt_pk_bf16_f32 v31, v31, v31
    v_lshlrev_b32 v31, 16, v31
    v_cvt_pk_bf16_f32 v41, v41, v41
    v_lshlrev_b32 v41, 16, v41
    v_cvt_pk_bf16_f32 v51, v51, v51
    v_lshlrev_b32 v51, 16, v51
    v_cvt_pk_bf16_f32 v61, v61, v61
    v_lshlrev_b32 v61, 16, v61
    v_lshlrev_b32 v120, 16, v100
    v_and_b32 v121, 0xffff0000, v100
    v_lshlrev_b32 v122, 16, v101
    v_and_b32 v123, 0xffff0000, v101
    v_add_f32 v32, v32, v120
    v_add_f32 v42, v42, v121
    v_add_f32 v52, v52, v122
    v_add_f32 v62, v62, v123
    v_cvt_pk_bf16_f32 v32, v32, v32
    v_lshlrev_b32 v32, 16, v32
    v_cvt_pk_bf16_f32 v42, v42, v42
    v_lshlrev_b32 v42, 16, v42
    v_cvt_pk_bf16_f32 v52, v52, v52
    v_lshlrev_b32 v52, 16, v52
    v_cvt_pk_bf16_f32 v62, v62, v62
    v_lshlrev_b32 v62, 16, v62
    v_lshlrev_b32 v120, 16, v102
    v_and_b32 v121, 0xffff0000, v102
    v_lshlrev_b32 v122, 16, v103
    v_and_b32 v123, 0xffff0000, v103
    v_add_f32 v33, v33, v120
    v_add_f32 v43, v43, v121
    v_add_f32 v53, v53, v122
    v_add_f32 v63, v63, v123
    v_cvt_pk_bf16_f32 v33, v33, v33
    v_lshlrev_b32 v33, 16, v33
    v_cvt_pk_bf16_f32 v43, v43, v43
    v_lshlrev_b32 v43, 16, v43
    v_cvt_pk_bf16_f32 v53, v53, v53
    v_lshlrev_b32 v53, 16, v53
    v_cvt_pk_bf16_f32 v63, v63, v63
    v_lshlrev_b32 v63, 16, v63
    v_lshlrev_b32 v120, 16, v104
    v_and_b32 v121, 0xffff0000, v104
    v_lshlrev_b32 v122, 16, v105
    v_and_b32 v123, 0xffff0000, v105
    v_add_f32 v34, v34, v120
    v_add_f32 v44, v44, v121
    v_add_f32 v54, v54, v122
    v_add_f32 v64, v64, v123
    v_cvt_pk_bf16_f32 v34, v34, v34
    v_lshlrev_b32 v34, 16, v34
    v_cvt_pk_bf16_f32 v44, v44, v44
    v_lshlrev_b32 v44, 16, v44
    v_cvt_pk_bf16_f32 v54, v54, v54
    v_lshlrev_b32 v54, 16, v54
    v_cvt_pk_bf16_f32 v64, v64, v64
    v_lshlrev_b32 v64, 16, v64
    v_lshlrev_b32 v120, 16, v106
    v_and_b32 v121, 0xffff0000, v106
    v_lshlrev_b32 v122, 16, v107
    v_and_b32 v123, 0xffff0000, v107
    v_add_f32 v35, v35, v120
    v_add_f32 v45, v45, v121
    v_add_f32 v55, v55, v122
    v_add_f32 v65, v65, v123
    v_cvt_pk_bf16_f32 v35, v35, v35
    v_lshlrev_b32 v35, 16, v35
    v_cvt_pk_bf16_f32 v45, v45, v45
    v_lshlrev_b32 v45, 16, v45
    v_cvt_pk_bf16_f32 v55, v55, v55
    v_lshlrev_b32 v55, 16, v55
    v_cvt_pk_bf16_f32 v65, v65, v65
    v_lshlrev_b32 v65, 16, v65
    v_lshlrev_b32 v120, 16, v108
    v_and_b32 v121, 0xffff0000, v108
    v_lshlrev_b32 v122, 16, v109
    v_and_b32 v123, 0xffff0000, v109
    v_add_f32 v36, v36, v120
    v_add_f32 v46, v46, v121
    v_add_f32 v56, v56, v122
    v_add_f32 v66, v66, v123
    v_cvt_pk_bf16_f32 v36, v36, v36
    v_lshlrev_b32 v36, 16, v36
    v_cvt_pk_bf16_f32 v46, v46, v46
    v_lshlrev_b32 v46, 16, v46
    v_cvt_pk_bf16_f32 v56, v56, v56
    v_lshlrev_b32 v56, 16, v56
    v_cvt_pk_bf16_f32 v66, v66, v66
    v_lshlrev_b32 v66, 16, v66
    v_lshlrev_b32 v120, 16, v110
    v_and_b32 v121, 0xffff0000, v110
    v_lshlrev_b32 v122, 16, v111
    v_and_b32 v123, 0xffff0000, v111
    v_add_f32 v37, v37, v120
    v_add_f32 v47, v47, v121
    v_add_f32 v57, v57, v122
    v_add_f32 v67, v67, v123
    v_cvt_pk_bf16_f32 v37, v37, v37
    v_lshlrev_b32 v37, 16, v37
    v_cvt_pk_bf16_f32 v47, v47, v47
    v_lshlrev_b32 v47, 16, v47
    v_cvt_pk_bf16_f32 v57, v57, v57
    v_lshlrev_b32 v57, 16, v57
    v_cvt_pk_bf16_f32 v67, v67, v67
    v_lshlrev_b32 v67, 16, v67
    v_lshlrev_b32 v120, 16, v112
    v_and_b32 v121, 0xffff0000, v112
    v_lshlrev_b32 v122, 16, v113
    v_and_b32 v123, 0xffff0000, v113
    v_add_f32 v38, v38, v120
    v_add_f32 v48, v48, v121
    v_add_f32 v58, v58, v122
    v_add_f32 v68, v68, v123
    v_cvt_pk_bf16_f32 v38, v38, v38
    v_lshlrev_b32 v38, 16, v38
    v_cvt_pk_bf16_f32 v48, v48, v48
    v_lshlrev_b32 v48, 16, v48
    v_cvt_pk_bf16_f32 v58, v58, v58
    v_lshlrev_b32 v58, 16, v58
    v_cvt_pk_bf16_f32 v68, v68, v68
    v_lshlrev_b32 v68, 16, v68
    v_lshlrev_b32 v120, 16, v114
    v_and_b32 v121, 0xffff0000, v114
    v_lshlrev_b32 v122, 16, v115
    v_and_b32 v123, 0xffff0000, v115
    v_add_f32 v39, v39, v120
    v_add_f32 v49, v49, v121
    v_add_f32 v59, v59, v122
    v_add_f32 v69, v69, v123
    v_cvt_pk_bf16_f32 v39, v39, v39
    v_lshlrev_b32 v39, 16, v39
    v_cvt_pk_bf16_f32 v49, v49, v49
    v_lshlrev_b32 v49, 16, v49
    v_cvt_pk_bf16_f32 v59, v59, v59
    v_lshlrev_b32 v59, 16, v59
    v_cvt_pk_bf16_f32 v69, v69, v69
    v_lshlrev_b32 v69, 16, v69
    v_cvt_pk_bf16_f32 v10, v30, v31
    buffer_store_dword v10, v3, s[36:39], s20 offen offset:0
    v_cvt_pk_bf16_f32 v11, v32, v33
    buffer_store_dword v11, v3, s[36:39], s20 offen offset:256
    v_cvt_pk_bf16_f32 v12, v34, v35
    buffer_store_dword v12, v3, s[36:39], s20 offen offset:512
    v_cvt_pk_bf16_f32 v13, v36, v37
    buffer_store_dword v13, v3, s[36:39], s20 offen offset:768
    v_cvt_pk_bf16_f32 v14, v38, v39
    buffer_store_dword v14, v3, s[36:39], s20 offen offset:1024
    v_cvt_pk_bf16_f32 v15, v40, v41
    buffer_store_dword v15, v3, s[36:39], s21 offen offset:0
    v_cvt_pk_bf16_f32 v16, v42, v43
    buffer_store_dword v16, v3, s[36:39], s21 offen offset:256
    v_cvt_pk_bf16_f32 v17, v44, v45
    buffer_store_dword v17, v3, s[36:39], s21 offen offset:512
    v_cvt_pk_bf16_f32 v18, v46, v47
    buffer_store_dword v18, v3, s[36:39], s21 offen offset:768
    v_cvt_pk_bf16_f32 v19, v48, v49
    buffer_store_dword v19, v3, s[36:39], s21 offen offset:1024
    v_cvt_pk_bf16_f32 v20, v50, v51
    buffer_store_dword v20, v3, s[36:39], s22 offen offset:0
    v_cvt_pk_bf16_f32 v21, v52, v53
    buffer_store_dword v21, v3, s[36:39], s22 offen offset:256
    v_cvt_pk_bf16_f32 v22, v54, v55
    buffer_store_dword v22, v3, s[36:39], s22 offen offset:512
    v_cvt_pk_bf16_f32 v23, v56, v57
    buffer_store_dword v23, v3, s[36:39], s22 offen offset:768
    v_cvt_pk_bf16_f32 v24, v58, v59
    buffer_store_dword v24, v3, s[36:39], s22 offen offset:1024
    v_cvt_pk_bf16_f32 v25, v60, v61
    buffer_store_dword v25, v3, s[36:39], s23 offen offset:0
    v_cvt_pk_bf16_f32 v26, v62, v63
    buffer_store_dword v26, v3, s[36:39], s23 offen offset:256
    v_cvt_pk_bf16_f32 v27, v64, v65
    buffer_store_dword v27, v3, s[36:39], s23 offen offset:512
    v_cvt_pk_bf16_f32 v28, v66, v67
    buffer_store_dword v28, v3, s[36:39], s23 offen offset:768
    v_cvt_pk_bf16_f32 v29, v68, v69
    buffer_store_dword v29, v3, s[36:39], s23 offen offset:1024
    v_mov_b32 v9, 0x3acccccd
    v_add_f32 v70, v30, v31
    v_add_f32 v71, v40, v41
    v_add_f32 v72, v50, v51
    v_add_f32 v73, v60, v61
    v_add_f32 v70, v70, v32
    v_add_f32 v71, v71, v42
    v_add_f32 v72, v72, v52
    v_add_f32 v73, v73, v62
    v_add_f32 v70, v70, v33
    v_add_f32 v71, v71, v43
    v_add_f32 v72, v72, v53
    v_add_f32 v73, v73, v63
    v_add_f32 v70, v70, v34
    v_add_f32 v71, v71, v44
    v_add_f32 v72, v72, v54
    v_add_f32 v73, v73, v64
    v_add_f32 v70, v70, v35
    v_add_f32 v71, v71, v45
    v_add_f32 v72, v72, v55
    v_add_f32 v73, v73, v65
    v_add_f32 v70, v70, v36
    v_add_f32 v71, v71, v46
    v_add_f32 v72, v72, v56
    v_add_f32 v73, v73, v66
    v_add_f32 v70, v70, v37
    v_add_f32 v71, v71, v47
    v_add_f32 v72, v72, v57
    v_add_f32 v73, v73, v67
    v_add_f32 v70, v70, v38
    v_add_f32 v71, v71, v48
    v_add_f32 v72, v72, v58
    v_add_f32 v73, v73, v68
    v_add_f32 v70, v70, v39
    v_add_f32 v71, v71, v49
    v_add_f32 v72, v72, v59
    v_add_f32 v73, v73, v69
    s_nop 1
    v_add_f32_dpp v70, v70, v70 row_shr:1 row_mask:0xf bank_mask:0xf
    v_add_f32_dpp v71, v71, v71 row_shr:1 row_mask:0xf bank_mask:0xf
    v_add_f32_dpp v72, v72, v72 row_shr:1 row_mask:0xf bank_mask:0xf
    v_add_f32_dpp v73, v73, v73 row_shr:1 row_mask:0xf bank_mask:0xf
    v_add_f32_dpp v70, v70, v70 row_shr:2 row_mask:0xf bank_mask:0xf
    v_add_f32_dpp v71, v71, v71 row_shr:2 row_mask:0xf bank_mask:0xf
    v_add_f32_dpp v72, v72, v72 row_shr:2 row_mask:0xf bank_mask:0xf
    v_add_f32_dpp v73, v73, v73 row_shr:2 row_mask:0xf bank_mask:0xf
    v_add_f32_dpp v70, v70, v70 row_shr:4 row_mask:0xf bank_mask:0xf
    v_add_f32_dpp v71, v71, v71 row_shr:4 row_mask:0xf bank_mask:0xf
    v_add_f32_dpp v72, v72, v72 row_shr:4 row_mask:0xf bank_mask:0xf
    v_add_f32_dpp v73, v73, v73 row_shr:4 row_mask:0xf bank_mask:0xf
    v_add_f32_dpp v70, v70, v70 row_shr:8 row_mask:0xf bank_mask:0xf
    v_add_f32_dpp v71, v71, v71 row_shr:8 row_mask:0xf bank_mask:0xf
    v_add_f32_dpp v72, v72, v72 row_shr:8 row_mask:0xf bank_mask:0xf
    v_add_f32_dpp v73, v73, v73 row_shr:8 row_mask:0xf bank_mask:0xf
    v_add_f32_dpp v70, v70, v70 row_bcast:15 row_mask:0xa bank_mask:0xf
    v_add_f32_dpp v71, v71, v71 row_bcast:15 row_mask:0xa bank_mask:0xf
    v_add_f32_dpp v72, v72, v72 row_bcast:15 row_mask:0xa bank_mask:0xf
    v_add_f32_dpp v73, v73, v73 row_bcast:15 row_mask:0xa bank_mask:0xf
    v_add_f32_dpp v70, v70, v70 row_bcast:31 row_mask:0xc bank_mask:0xf
    v_add_f32_dpp v71, v71, v71 row_bcast:31 row_mask:0xc bank_mask:0xf
    v_add_f32_dpp v72, v72, v72 row_bcast:31 row_mask:0xc bank_mask:0xf
    v_add_f32_dpp v73, v73, v73 row_bcast:31 row_mask:0xc bank_mask:0xf
    s_nop 1
    v_readlane_b32 s24, v70, 63
    v_readlane_b32 s25, v71, 63
    v_readlane_b32 s26, v72, 63
    v_readlane_b32 s27, v73, 63
    s_nop 1
    v_mul_f32 v74, s24, v9
    v_mul_f32 v75, s25, v9
    v_mul_f32 v76, s26, v9
    v_mul_f32 v77, s27, v9
    v_mov_b32 v70, 0
    v_mov_b32 v71, 0
    v_mov_b32 v72, 0
    v_mov_b32 v73, 0
    v_sub_f32 v78, v30, v74
    v_sub_f32 v79, v40, v75
    v_sub_f32 v80, v50, v76
    v_sub_f32 v81, v60, v77
    v_fmac_f32 v70, v78, v78
    v_fmac_f32 v71, v79, v79
    v_fmac_f32 v72, v80, v80
    v_fmac_f32 v73, v81, v81
    v_sub_f32 v78, v31, v74
    v_sub_f32 v79, v41, v75
    v_sub_f32 v80, v51, v76
    v_sub_f32 v81, v61, v77
    v_fmac_f32 v70, v78, v78
    v_fmac_f32 v71, v79, v79
    v_fmac_f32 v72, v80, v80
    v_fmac_f32 v73, v81, v81
    v_sub_f32 v78, v32, v74
    v_sub_f32 v79, v42, v75
    v_sub_f32 v80, v52, v76
    v_sub_f32 v81, v62, v77
    v_fmac_f32 v70, v78, v78
    v_fmac_f32 v71, v79, v79
    v_fmac_f32 v72, v80, v80
    v_fmac_f32 v73, v81, v81
    v_sub_f32 v78, v33, v74
    v_sub_f32 v79, v43, v75
    v_sub_f32 v80, v53, v76
    v_sub_f32 v81, v63, v77
    v_fmac_f32 v70, v78, v78
    v_fmac_f32 v71, v79, v79
    v_fmac_f32 v72, v80, v80
    v_fmac_f32 v73, v81, v81
    v_sub_f32 v78, v34, v74
    v_sub_f32 v79, v44, v75
    v_sub_f32 v80, v54, v76
    v_sub_f32 v81, v64, v77
    v_fmac_f32 v70, v78, v78
    v_fmac_f32 v71, v79, v79
    v_fmac_f32 v72, v80, v80
    v_fmac_f32 v73, v81, v81
    v_sub_f32 v78, v35, v74
    v_sub_f32 v79, v45, v75
    v_sub_f32 v80, v55, v76
    v_sub_f32 v81, v65, v77
    v_fmac_f32 v70, v78, v78
    v_fmac_f32 v71, v79, v79
    v_fmac_f32 v72, v80, v80
    v_fmac_f32 v73, v81, v81
    v_sub_f32 v78, v36, v74
    v_sub_f32 v79, v46, v75
    v_sub_f32 v80, v56, v76
    v_sub_f32 v81, v66, v77
    v_fmac_f32 v70, v78, v78
    v_fmac_f32 v71, v79, v79
    v_fmac_f32 v72, v80, v80
    v_fmac_f32 v73, v81, v81
    v_sub_f32 v78, v37, v74
    v_sub_f32 v79, v47, v75
    v_sub_f32 v80, v57, v76
    v_sub_f32 v81, v67, v77
    v_fmac_f32 v70, v78, v78
    v_fmac_f32 v71, v79, v79
    v_fmac_f32 v72, v80, v80
    v_fmac_f32 v73, v81, v81
    v_sub_f32 v78, v38, v74
    v_sub_f32 v79, v48, v75
    v_sub_f32 v80, v58, v76
    v_sub_f32 v81, v68, v77
    v_fmac_f32 v70, v78, v78
    v_fmac_f32 v71, v79, v79
    v_fmac_f32 v72, v80, v80
    v_fmac_f32 v73, v81, v81
    v_sub_f32 v78, v39, v74
    v_sub_f32 v79, v49, v75
    v_sub_f32 v80, v59, v76
    v_sub_f32 v81, v69, v77
    v_fmac_f32 v70, v78, v78
    v_fmac_f32 v71, v79, v79
    v_fmac_f32 v72, v80, v80
    v_fmac_f32 v73, v81, v81
    s_nop 1
    v_add_f32_dpp v70, v70, v70 row_shr:1 row_mask:0xf bank_mask:0xf
    v_add_f32_dpp v71, v71, v71 row_shr:1 row_mask:0xf bank_mask:0xf
    v_add_f32_dpp v72, v72, v72 row_shr:1 row_mask:0xf bank_mask:0xf
    v_add_f32_dpp v73, v73, v73 row_shr:1 row_mask:0xf bank_mask:0xf
    v_add_f32_dpp v70, v70, v70 row_shr:2 row_mask:0xf bank_mask:0xf
    v_add_f32_dpp v71, v71, v71 row_shr:2 row_mask:0xf bank_mask:0xf
    v_add_f32_dpp v72, v72, v72 row_shr:2 row_mask:0xf bank_mask:0xf
    v_add_f32_dpp v73, v73, v73 row_shr:2 row_mask:0xf bank_mask:0xf
    v_add_f32_dpp v70, v70, v70 row_shr:4 row_mask:0xf bank_mask:0xf
    v_add_f32_dpp v71, v71, v71 row_shr:4 row_mask:0xf bank_mask:0xf
    v_add_f32_dpp v72, v72, v72 row_shr:4 row_mask:0xf bank_mask:0xf
    v_add_f32_dpp v73, v73, v73 row_shr:4 row_mask:0xf bank_mask:0xf
    v_add_f32_dpp v70, v70, v70 row_shr:8 row_mask:0xf bank_mask:0xf
    v_add_f32_dpp v71, v71, v71 row_shr:8 row_mask:0xf bank_mask:0xf
    v_add_f32_dpp v72, v72, v72 row_shr:8 row_mask:0xf bank_mask:0xf
    v_add_f32_dpp v73, v73, v73 row_shr:8 row_mask:0xf bank_mask:0xf
    v_add_f32_dpp v70, v70, v70 row_bcast:15 row_mask:0xa bank_mask:0xf
    v_add_f32_dpp v71, v71, v71 row_bcast:15 row_mask:0xa bank_mask:0xf
    v_add_f32_dpp v72, v72, v72 row_bcast:15 row_mask:0xa bank_mask:0xf
    v_add_f32_dpp v73, v73, v73 row_bcast:15 row_mask:0xa bank_mask:0xf
    v_add_f32_dpp v70, v70, v70 row_bcast:31 row_mask:0xc bank_mask:0xf
    v_add_f32_dpp v71, v71, v71 row_bcast:31 row_mask:0xc bank_mask:0xf
    v_add_f32_dpp v72, v72, v72 row_bcast:31 row_mask:0xc bank_mask:0xf
    v_add_f32_dpp v73, v73, v73 row_bcast:31 row_mask:0xc bank_mask:0xf
    s_nop 1
    v_readlane_b32 s24, v70, 63
    v_readlane_b32 s25, v71, 63
    v_readlane_b32 s26, v72, 63
    v_readlane_b32 s27, v73, 63
    s_nop 1
    v_mul_f32 v82, s24, v9
    v_mul_f32 v83, s25, v9
    v_mul_f32 v84, s26, v9
    v_mul_f32 v85, s27, v9
    v_mov_b32 v8, 0x3727c5ac
    v_cvt_pk_bf16_f32 v74, v74, v74
    v_lshlrev_b32 v74, 16, v74
    v_cvt_pk_bf16_f32 v75, v75, v75
    v_lshlrev_b32 v75, 16, v75
    v_cvt_pk_bf16_f32 v76, v76, v76
    v_lshlrev_b32 v76, 16, v76
    v_cvt_pk_bf16_f32 v77, v77, v77
    v_lshlrev_b32 v77, 16, v77
    v_cvt_pk_bf16_f32 v82, v82, v82
    v_lshlrev_b32 v82, 16, v82
    v_cvt_pk_bf16_f32 v83, v83, v83
    v_lshlrev_b32 v83, 16, v83
    v_cvt_pk_bf16_f32 v84, v84, v84
    v_lshlrev_b32 v84, 16, v84
    v_cvt_pk_bf16_f32 v85, v85, v85
    v_lshlrev_b32 v85, 16, v85
    v_add_f32 v82, v82, v8
    v_add_f32 v83, v83, v8
    v_add_f32 v84, v84, v8
    v_add_f32 v85, v85, v8
    v_cvt_pk_bf16_f32 v82, v82, v82
    v_lshlrev_b32 v82, 16, v82
    v_cvt_pk_bf16_f32 v83, v83, v83
    v_lshlrev_b32 v83, 16, v83
    v_cvt_pk_bf16_f32 v84, v84, v84
    v_lshlrev_b32 v84, 16, v84
    v_cvt_pk_bf16_f32 v85, v85, v85
    v_lshlrev_b32 v85, 16, v85
    v_sqrt_f32 v82, v82
    v_sqrt_f32 v83, v83
    v_sqrt_f32 v84, v84
    v_sqrt_f32 v85, v85
    s_nop 0
    v_cvt_pk_bf16_f32 v82, v82, v82
    v_lshlrev_b32 v82, 16, v82
    v_cvt_pk_bf16_f32 v83, v83, v83
    v_lshlrev_b32 v83, 16, v83
    v_cvt_pk_bf16_f32 v84, v84, v84
    v_lshlrev_b32 v84, 16, v84
    v_cvt_pk_bf16_f32 v85, v85, v85
    v_lshlrev_b32 v85, 16, v85
    v_rcp_f32 v86, v82
    v_rcp_f32 v87, v83
    v_rcp_f32 v88, v84
    v_rcp_f32 v89, v85
    s_nop 0
    v_sub_f32 v30, v30, v74
    v_sub_f32 v40, v40, v75
    v_sub_f32 v50, v50, v76
    v_sub_f32 v60, v60, v77
    v_cvt_pk_bf16_f32 v30, v30, v30
    v_lshlrev_b32 v30, 16, v30
    v_cvt_pk_bf16_f32 v40, v40, v40
    v_lshlrev_b32 v40, 16, v40
    v_cvt_pk_bf16_f32 v50, v50, v50
    v_lshlrev_b32 v50, 16, v50
    v_cvt_pk_bf16_f32 v60, v60, v60
    v_lshlrev_b32 v60, 16, v60
    v_mul_f32 v78, v30, v86
    v_mul_f32 v79, v40, v87
    v_mul_f32 v80, v50, v88
    v_mul_f32 v81, v60, v89
    v_fma_f32 v30, -v78, v82, v30
    v_fma_f32 v40, -v79, v83, v40
    v_fma_f32 v50, -v80, v84, v50
    v_fma_f32 v60, -v81, v85, v60
    v_fma_f32 v30, v30, v86, v78
    v_fma_f32 v40, v40, v87, v79
    v_fma_f32 v50, v50, v88, v80
    v_fma_f32 v60, v60, v89, v81
    v_sub_f32 v31, v31, v74
    v_sub_f32 v41, v41, v75
    v_sub_f32 v51, v51, v76
    v_sub_f32 v61, v61, v77
    v_cvt_pk_bf16_f32 v31, v31, v31
    v_lshlrev_b32 v31, 16, v31
    v_cvt_pk_bf16_f32 v41, v41, v41
    v_lshlrev_b32 v41, 16, v41
    v_cvt_pk_bf16_f32 v51, v51, v51
    v_lshlrev_b32 v51, 16, v51
    v_cvt_pk_bf16_f32 v61, v61, v61
    v_lshlrev_b32 v61, 16, v61
    v_mul_f32 v78, v31, v86
    v_mul_f32 v79, v41, v87
    v_mul_f32 v80, v51, v88
    v_mul_f32 v81, v61, v89
    v_fma_f32 v31, -v78, v82, v31
    v_fma_f32 v41, -v79, v83, v41
    v_fma_f32 v51, -v80, v84, v51
    v_fma_f32 v61, -v81, v85, v61
    v_fma_f32 v31, v31, v86, v78
    v_fma_f32 v41, v41, v87, v79
    v_fma_f32 v51, v51, v88, v80
    v_fma_f32 v61, v61, v89, v81
    v_sub_f32 v32, v32, v74
    v_sub_f32 v42, v42, v75
    v_sub_f32 v52, v52, v76
    v_sub_f32 v62, v62, v77
    v_cvt_pk_bf16_f32 v32, v32, v32
    v_lshlrev_b32 v32, 16, v32
    v_cvt_pk_bf16_f32 v42, v42, v42
    v_lshlrev_b32 v42, 16, v42
    v_cvt_pk_bf16_f32 v52, v52, v52
    v_lshlrev_b32 v52, 16, v52
    v_cvt_pk_bf16_f32 v62, v62, v62
    v_lshlrev_b32 v62, 16, v62
    v_mul_f32 v78, v32, v86
    v_mul_f32 v79, v42, v87
    v_mul_f32 v80, v52, v88
    v_mul_f32 v81, v62, v89
    v_fma_f32 v32, -v78, v82, v32
    v_fma_f32 v42, -v79, v83, v42
    v_fma_f32 v52, -v80, v84, v52
    v_fma_f32 v62, -v81, v85, v62
    v_fma_f32 v32, v32, v86, v78
    v_fma_f32 v42, v42, v87, v79
    v_fma_f32 v52, v52, v88, v80
    v_fma_f32 v62, v62, v89, v81
    v_sub_f32 v33, v33, v74
    v_sub_f32 v43, v43, v75
    v_sub_f32 v53, v53, v76
    v_sub_f32 v63, v63, v77
    v_cvt_pk_bf16_f32 v33, v33, v33
    v_lshlrev_b32 v33, 16, v33
    v_cvt_pk_bf16_f32 v43, v43, v43
    v_lshlrev_b32 v43, 16, v43
    v_cvt_pk_bf16_f32 v53, v53, v53
    v_lshlrev_b32 v53, 16, v53
    v_cvt_pk_bf16_f32 v63, v63, v63
    v_lshlrev_b32 v63, 16, v63
    v_mul_f32 v78, v33, v86
    v_mul_f32 v79, v43, v87
    v_mul_f32 v80, v53, v88
    v_mul_f32 v81, v63, v89
    v_fma_f32 v33, -v78, v82, v33
    v_fma_f32 v43, -v79, v83, v43
    v_fma_f32 v53, -v80, v84, v53
    v_fma_f32 v63, -v81, v85, v63
    v_fma_f32 v33, v33, v86, v78
    v_fma_f32 v43, v43, v87, v79
    v_fma_f32 v53, v53, v88, v80
    v_fma_f32 v63, v63, v89, v81
    v_sub_f32 v34, v34, v74
    v_sub_f32 v44, v44, v75
    v_sub_f32 v54, v54, v76
    v_sub_f32 v64, v64, v77
    v_cvt_pk_bf16_f32 v34, v34, v34
    v_lshlrev_b32 v34, 16, v34
    v_cvt_pk_bf16_f32 v44, v44, v44
    v_lshlrev_b32 v44, 16, v44
    v_cvt_pk_bf16_f32 v54, v54, v54
    v_lshlrev_b32 v54, 16, v54
    v_cvt_pk_bf16_f32 v64, v64, v64
    v_lshlrev_b32 v64, 16, v64
    v_mul_f32 v78, v34, v86
    v_mul_f32 v79, v44, v87
    v_mul_f32 v80, v54, v88
    v_mul_f32 v81, v64, v89
    v_fma_f32 v34, -v78, v82, v34
    v_fma_f32 v44, -v79, v83, v44
    v_fma_f32 v54, -v80, v84, v54
    v_fma_f32 v64, -v81, v85, v64
    v_fma_f32 v34, v34, v86, v78
    v_fma_f32 v44, v44, v87, v79
    v_fma_f32 v54, v54, v88, v80
    v_fma_f32 v64, v64, v89, v81
    v_sub_f32 v35, v35, v74
    v_sub_f32 v45, v45, v75
    v_sub_f32 v55, v55, v76
    v_sub_f32 v65, v65, v77
    v_cvt_pk_bf16_f32 v35, v35, v35
    v_lshlrev_b32 v35, 16, v35
    v_cvt_pk_bf16_f32 v45, v45, v45
    v_lshlrev_b32 v45, 16, v45
    v_cvt_pk_bf16_f32 v55, v55, v55
    v_lshlrev_b32 v55, 16, v55
    v_cvt_pk_bf16_f32 v65, v65, v65
    v_lshlrev_b32 v65, 16, v65
    v_mul_f32 v78, v35, v86
    v_mul_f32 v79, v45, v87
    v_mul_f32 v80, v55, v88
    v_mul_f32 v81, v65, v89
    v_fma_f32 v35, -v78, v82, v35
    v_fma_f32 v45, -v79, v83, v45
    v_fma_f32 v55, -v80, v84, v55
    v_fma_f32 v65, -v81, v85, v65
    v_fma_f32 v35, v35, v86, v78
    v_fma_f32 v45, v45, v87, v79
    v_fma_f32 v55, v55, v88, v80
    v_fma_f32 v65, v65, v89, v81
    v_sub_f32 v36, v36, v74
    v_sub_f32 v46, v46, v75
    v_sub_f32 v56, v56, v76
    v_sub_f32 v66, v66, v77
    v_cvt_pk_bf16_f32 v36, v36, v36
    v_lshlrev_b32 v36, 16, v36
    v_cvt_pk_bf16_f32 v46, v46, v46
    v_lshlrev_b32 v46, 16, v46
    v_cvt_pk_bf16_f32 v56, v56, v56
    v_lshlrev_b32 v56, 16, v56
    v_cvt_pk_bf16_f32 v66, v66, v66
    v_lshlrev_b32 v66, 16, v66
    v_mul_f32 v78, v36, v86
    v_mul_f32 v79, v46, v87
    v_mul_f32 v80, v56, v88
    v_mul_f32 v81, v66, v89
    v_fma_f32 v36, -v78, v82, v36
    v_fma_f32 v46, -v79, v83, v46
    v_fma_f32 v56, -v80, v84, v56
    v_fma_f32 v66, -v81, v85, v66
    v_fma_f32 v36, v36, v86, v78
    v_fma_f32 v46, v46, v87, v79
    v_fma_f32 v56, v56, v88, v80
    v_fma_f32 v66, v66, v89, v81
    v_sub_f32 v37, v37, v74
    v_sub_f32 v47, v47, v75
    v_sub_f32 v57, v57, v76
    v_sub_f32 v67, v67, v77
    v_cvt_pk_bf16_f32 v37, v37, v37
    v_lshlrev_b32 v37, 16, v37
    v_cvt_pk_bf16_f32 v47, v47, v47
    v_lshlrev_b32 v47, 16, v47
    v_cvt_pk_bf16_f32 v57, v57, v57
    v_lshlrev_b32 v57, 16, v57
    v_cvt_pk_bf16_f32 v67, v67, v67
    v_lshlrev_b32 v67, 16, v67
    v_mul_f32 v78, v37, v86
    v_mul_f32 v79, v47, v87
    v_mul_f32 v80, v57, v88
    v_mul_f32 v81, v67, v89
    v_fma_f32 v37, -v78, v82, v37
    v_fma_f32 v47, -v79, v83, v47
    v_fma_f32 v57, -v80, v84, v57
    v_fma_f32 v67, -v81, v85, v67
    v_fma_f32 v37, v37, v86, v78
    v_fma_f32 v47, v47, v87, v79
    v_fma_f32 v57, v57, v88, v80
    v_fma_f32 v67, v67, v89, v81
    v_sub_f32 v38, v38, v74
    v_sub_f32 v48, v48, v75
    v_sub_f32 v58, v58, v76
    v_sub_f32 v68, v68, v77
    v_cvt_pk_bf16_f32 v38, v38, v38
    v_lshlrev_b32 v38, 16, v38
    v_cvt_pk_bf16_f32 v48, v48, v48
    v_lshlrev_b32 v48, 16, v48
    v_cvt_pk_bf16_f32 v58, v58, v58
    v_lshlrev_b32 v58, 16, v58
    v_cvt_pk_bf16_f32 v68, v68, v68
    v_lshlrev_b32 v68, 16, v68
    v_mul_f32 v78, v38, v86
    v_mul_f32 v79, v48, v87
    v_mul_f32 v80, v58, v88
    v_mul_f32 v81, v68, v89
    v_fma_f32 v38, -v78, v82, v38
    v_fma_f32 v48, -v79, v83, v48
    v_fma_f32 v58, -v80, v84, v58
    v_fma_f32 v68, -v81, v85, v68
    v_fma_f32 v38, v38, v86, v78
    v_fma_f32 v48, v48, v87, v79
    v_fma_f32 v58, v58, v88, v80
    v_fma_f32 v68, v68, v89, v81
    v_sub_f32 v39, v39, v74
    v_sub_f32 v49, v49, v75
    v_sub_f32 v59, v59, v76
    v_sub_f32 v69, v69, v77
    v_cvt_pk_bf16_f32 v39, v39, v39
    v_lshlrev_b32 v39, 16, v39
    v_cvt_pk_bf16_f32 v49, v49, v49
    v_lshlrev_b32 v49, 16, v49
    v_cvt_pk_bf16_f32 v59, v59, v59
    v_lshlrev_b32 v59, 16, v59
    v_cvt_pk_bf16_f32 v69, v69, v69
    v_lshlrev_b32 v69, 16, v69
    v_mul_f32 v78, v39, v86
    v_mul_f32 v79, v49, v87
    v_mul_f32 v80, v59, v88
    v_mul_f32 v81, v69, v89
    v_fma_f32 v39, -v78, v82, v39
    v_fma_f32 v49, -v79, v83, v49
    v_fma_f32 v59, -v80, v84, v59
    v_fma_f32 v69, -v81, v85, v69
    v_fma_f32 v39, v39, v86, v78
    v_fma_f32 v49, v49, v87, v79
    v_fma_f32 v59, v59, v88, v80
    v_fma_f32 v69, v69, v89, v81
    v_cvt_pk_bf16_f32 v30, v30, v30
    v_lshlrev_b32 v30, 16, v30
    v_cvt_pk_bf16_f32 v40, v40, v40
    v_lshlrev_b32 v40, 16, v40
    v_cvt_pk_bf16_f32 v50, v50, v50
    v_lshlrev_b32 v50, 16, v50
    v_cvt_pk_bf16_f32 v60, v60, v60
    v_lshlrev_b32 v60, 16, v60
    v_cvt_pk_bf16_f32 v31, v31, v31
    v_lshlrev_b32 v31, 16, v31
    v_cvt_pk_bf16_f32 v41, v41, v41
    v_lshlrev_b32 v41, 16, v41
    v_cvt_pk_bf16_f32 v51, v51, v51
    v_lshlrev_b32 v51, 16, v51
    v_cvt_pk_bf16_f32 v61, v61, v61
    v_lshlrev_b32 v61, 16, v61
    v_cvt_pk_bf16_f32 v32, v32, v32
    v_lshlrev_b32 v32, 16, v32
    v_cvt_pk_bf16_f32 v42, v42, v42
    v_lshlrev_b32 v42, 16, v42
    v_cvt_pk_bf16_f32 v52, v52, v52
    v_lshlrev_b32 v52, 16, v52
    v_cvt_pk_bf16_f32 v62, v62, v62
    v_lshlrev_b32 v62, 16, v62
    v_cvt_pk_bf16_f32 v33, v33, v33
    v_lshlrev_b32 v33, 16, v33
    v_cvt_pk_bf16_f32 v43, v43, v43
    v_lshlrev_b32 v43, 16, v43
    v_cvt_pk_bf16_f32 v53, v53, v53
    v_lshlrev_b32 v53, 16, v53
    v_cvt_pk_bf16_f32 v63, v63, v63
    v_lshlrev_b32 v63, 16, v63
    v_cvt_pk_bf16_f32 v34, v34, v34
    v_lshlrev_b32 v34, 16, v34
    v_cvt_pk_bf16_f32 v44, v44, v44
    v_lshlrev_b32 v44, 16, v44
    v_cvt_pk_bf16_f32 v54, v54, v54
    v_lshlrev_b32 v54, 16, v54
    v_cvt_pk_bf16_f32 v64, v64, v64
    v_lshlrev_b32 v64, 16, v64
    v_cvt_pk_bf16_f32 v35, v35, v35
    v_lshlrev_b32 v35, 16, v35
    v_cvt_pk_bf16_f32 v45, v45, v45
    v_lshlrev_b32 v45, 16, v45
    v_cvt_pk_bf16_f32 v55, v55, v55
    v_lshlrev_b32 v55, 16, v55
    v_cvt_pk_bf16_f32 v65, v65, v65
    v_lshlrev_b32 v65, 16, v65
    v_cvt_pk_bf16_f32 v36, v36, v36
    v_lshlrev_b32 v36, 16, v36
    v_cvt_pk_bf16_f32 v46, v46, v46
    v_lshlrev_b32 v46, 16, v46
    v_cvt_pk_bf16_f32 v56, v56, v56
    v_lshlrev_b32 v56, 16, v56
    v_cvt_pk_bf16_f32 v66, v66, v66
    v_lshlrev_b32 v66, 16, v66
    v_cvt_pk_bf16_f32 v37, v37, v37
    v_lshlrev_b32 v37, 16, v37
    v_cvt_pk_bf16_f32 v47, v47, v47
    v_lshlrev_b32 v47, 16, v47
    v_cvt_pk_bf16_f32 v57, v57, v57
    v_lshlrev_b32 v57, 16, v57
    v_cvt_pk_bf16_f32 v67, v67, v67
    v_lshlrev_b32 v67, 16, v67
    v_cvt_pk_bf16_f32 v38, v38, v38
    v_lshlrev_b32 v38, 16, v38
    v_cvt_pk_bf16_f32 v48, v48, v48
    v_lshlrev_b32 v48, 16, v48
    v_cvt_pk_bf16_f32 v58, v58, v58
    v_lshlrev_b32 v58, 16, v58
    v_cvt_pk_bf16_f32 v68, v68, v68
    v_lshlrev_b32 v68, 16, v68
    v_cvt_pk_bf16_f32 v39, v39, v39
    v_lshlrev_b32 v39, 16, v39
    v_cvt_pk_bf16_f32 v49, v49, v49
    v_lshlrev_b32 v49, 16, v49
    v_cvt_pk_bf16_f32 v59, v59, v59
    v_lshlrev_b32 v59, 16, v59
    v_cvt_pk_bf16_f32 v69, v69, v69
    v_lshlrev_b32 v69, 16, v69
    v_mov_b32 v9, 0x3acccccd
    v_add_f32 v70, v30, v31
    v_add_f32 v71, v40, v41
    v_add_f32 v72, v50, v51
    v_add_f32 v73, v60, v61
    v_add_f32 v70, v70, v32
    v_add_f32 v71, v71, v42
    v_add_f32 v72, v72, v52
    v_add_f32 v73, v73, v62
    v_add_f32 v70, v70, v33
    v_add_f32 v71, v71, v43
    v_add_f32 v72, v72, v53
    v_add_f32 v73, v73, v63
    v_add_f32 v70, v70, v34
    v_add_f32 v71, v71, v44
    v_add_f32 v72, v72, v54
    v_add_f32 v73, v73, v64
    v_add_f32 v70, v70, v35
    v_add_f32 v71, v71, v45
    v_add_f32 v72, v72, v55
    v_add_f32 v73, v73, v65
    v_add_f32 v70, v70, v36
    v_add_f32 v71, v71, v46
    v_add_f32 v72, v72, v56
    v_add_f32 v73, v73, v66
    v_add_f32 v70, v70, v37
    v_add_f32 v71, v71, v47
    v_add_f32 v72, v72, v57
    v_add_f32 v73, v73, v67
    v_add_f32 v70, v70, v38
    v_add_f32 v71, v71, v48
    v_add_f32 v72, v72, v58
    v_add_f32 v73, v73, v68
    v_add_f32 v70, v70, v39
    v_add_f32 v71, v71, v49
    v_add_f32 v72, v72, v59
    v_add_f32 v73, v73, v69
    s_nop 1
    v_add_f32_dpp v70, v70, v70 row_shr:1 row_mask:0xf bank_mask:0xf
    v_add_f32_dpp v71, v71, v71 row_shr:1 row_mask:0xf bank_mask:0xf
    v_add_f32_dpp v72, v72, v72 row_shr:1 row_mask:0xf bank_mask:0xf
    v_add_f32_dpp v73, v73, v73 row_shr:1 row_mask:0xf bank_mask:0xf
    v_add_f32_dpp v70, v70, v70 row_shr:2 row_mask:0xf bank_mask:0xf
    v_add_f32_dpp v71, v71, v71 row_shr:2 row_mask:0xf bank_mask:0xf
    v_add_f32_dpp v72, v72, v72 row_shr:2 row_mask:0xf bank_mask:0xf
    v_add_f32_dpp v73, v73, v73 row_shr:2 row_mask:0xf bank_mask:0xf
    v_add_f32_dpp v70, v70, v70 row_shr:4 row_mask:0xf bank_mask:0xf
    v_add_f32_dpp v71, v71, v71 row_shr:4 row_mask:0xf bank_mask:0xf
    v_add_f32_dpp v72, v72, v72 row_shr:4 row_mask:0xf bank_mask:0xf
    v_add_f32_dpp v73, v73, v73 row_shr:4 row_mask:0xf bank_mask:0xf
    v_add_f32_dpp v70, v70, v70 row_shr:8 row_mask:0xf bank_mask:0xf
    v_add_f32_dpp v71, v71, v71 row_shr:8 row_mask:0xf bank_mask:0xf
    v_add_f32_dpp v72, v72, v72 row_shr:8 row_mask:0xf bank_mask:0xf
    v_add_f32_dpp v73, v73, v73 row_shr:8 row_mask:0xf bank_mask:0xf
    v_add_f32_dpp v70, v70, v70 row_bcast:15 row_mask:0xa bank_mask:0xf
    v_add_f32_dpp v71, v71, v71 row_bcast:15 row_mask:0xa bank_mask:0xf
    v_add_f32_dpp v72, v72, v72 row_bcast:15 row_mask:0xa bank_mask:0xf
    v_add_f32_dpp v73, v73, v73 row_bcast:15 row_mask:0xa bank_mask:0xf
    v_add_f32_dpp v70, v70, v70 row_bcast:31 row_mask:0xc bank_mask:0xf
    v_add_f32_dpp v71, v71, v71 row_bcast:31 row_mask:0xc bank_mask:0xf
    v_add_f32_dpp v72, v72, v72 row_bcast:31 row_mask:0xc bank_mask:0xf
    v_add_f32_dpp v73, v73, v73 row_bcast:31 row_mask:0xc bank_mask:0xf
    s_nop 1
    v_readlane_b32 s24, v70, 63
    v_readlane_b32 s25, v71, 63
    v_readlane_b32 s26, v72, 63
    v_readlane_b32 s27, v73, 63
    s_nop 1
    v_mul_f32 v74, s24, v9
    v_mul_f32 v75, s25, v9
    v_mul_f32 v76, s26, v9
    v_mul_f32 v77, s27, v9
    v_mov_b32 v70, 0
    v_mov_b32 v71, 0
    v_mov_b32 v72, 0
    v_mov_b32 v73, 0
    v_sub_f32 v78, v30, v74
    v_sub_f32 v79, v40, v75
    v_sub_f32 v80, v50, v76
    v_sub_f32 v81, v60, v77
    v_fmac_f32 v70, v78, v78
    v_fmac_f32 v71, v79, v79
    v_fmac_f32 v72, v80, v80
    v_fmac_f32 v73, v81, v81
    v_sub_f32 v78, v31, v74
    v_sub_f32 v79, v41, v75
    v_sub_f32 v80, v51, v76
    v_sub_f32 v81, v61, v77
    v_fmac_f32 v70, v78, v78
    v_fmac_f32 v71, v79, v79
    v_fmac_f32 v72, v80, v80
    v_fmac_f32 v73, v81, v81
    v_sub_f32 v78, v32, v74
    v_sub_f32 v79, v42, v75
    v_sub_f32 v80, v52, v76
    v_sub_f32 v81, v62, v77
    v_fmac_f32 v70, v78, v78
    v_fmac_f32 v71, v79, v79
    v_fmac_f32 v72, v80, v80
    v_fmac_f32 v73, v81, v81
    v_sub_f32 v78, v33, v74
    v_sub_f32 v79, v43, v75
    v_sub_f32 v80, v53, v76
    v_sub_f32 v81, v63, v77
    v_fmac_f32 v70, v78, v78
    v_fmac_f32 v71, v79, v79
    v_fmac_f32 v72, v80, v80
    v_fmac_f32 v73, v81, v81
    v_sub_f32 v78, v34, v74
    v_sub_f32 v79, v44, v75
    v_sub_f32 v80, v54, v76
    v_sub_f32 v81, v64, v77
    v_fmac_f32 v70, v78, v78
    v_fmac_f32 v71, v79, v79
    v_fmac_f32 v72, v80, v80
    v_fmac_f32 v73, v81, v81
    v_sub_f32 v78, v35, v74
    v_sub_f32 v79, v45, v75
    v_sub_f32 v80, v55, v76
    v_sub_f32 v81, v65, v77
    v_fmac_f32 v70, v78, v78
    v_fmac_f32 v71, v79, v79
    v_fmac_f32 v72, v80, v80
    v_fmac_f32 v73, v81, v81
    v_sub_f32 v78, v36, v74
    v_sub_f32 v79, v46, v75
    v_sub_f32 v80, v56, v76
    v_sub_f32 v81, v66, v77
    v_fmac_f32 v70, v78, v78
    v_fmac_f32 v71, v79, v79
    v_fmac_f32 v72, v80, v80
    v_fmac_f32 v73, v81, v81
    v_sub_f32 v78, v37, v74
    v_sub_f32 v79, v47, v75
    v_sub_f32 v80, v57, v76
    v_sub_f32 v81, v67, v77
    v_fmac_f32 v70, v78, v78
    v_fmac_f32 v71, v79, v79
    v_fmac_f32 v72, v80, v80
    v_fmac_f32 v73, v81, v81
    v_sub_f32 v78, v38, v74
    v_sub_f32 v79, v48, v75
    v_sub_f32 v80, v58, v76
    v_sub_f32 v81, v68, v77
    v_fmac_f32 v70, v78, v78
    v_fmac_f32 v71, v79, v79
    v_fmac_f32 v72, v80, v80
    v_fmac_f32 v73, v81, v81
    v_sub_f32 v78, v39, v74
    v_sub_f32 v79, v49, v75
    v_sub_f32 v80, v59, v76
    v_sub_f32 v81, v69, v77
    v_fmac_f32 v70, v78, v78
    v_fmac_f32 v71, v79, v79
    v_fmac_f32 v72, v80, v80
    v_fmac_f32 v73, v81, v81
    s_nop 1
    v_add_f32_dpp v70, v70, v70 row_shr:1 row_mask:0xf bank_mask:0xf
    v_add_f32_dpp v71, v71, v71 row_shr:1 row_mask:0xf bank_mask:0xf
    v_add_f32_dpp v72, v72, v72 row_shr:1 row_mask:0xf bank_mask:0xf
    v_add_f32_dpp v73, v73, v73 row_shr:1 row_mask:0xf bank_mask:0xf
    v_add_f32_dpp v70, v70, v70 row_shr:2 row_mask:0xf bank_mask:0xf
    v_add_f32_dpp v71, v71, v71 row_shr:2 row_mask:0xf bank_mask:0xf
    v_add_f32_dpp v72, v72, v72 row_shr:2 row_mask:0xf bank_mask:0xf
    v_add_f32_dpp v73, v73, v73 row_shr:2 row_mask:0xf bank_mask:0xf
    v_add_f32_dpp v70, v70, v70 row_shr:4 row_mask:0xf bank_mask:0xf
    v_add_f32_dpp v71, v71, v71 row_shr:4 row_mask:0xf bank_mask:0xf
    v_add_f32_dpp v72, v72, v72 row_shr:4 row_mask:0xf bank_mask:0xf
    v_add_f32_dpp v73, v73, v73 row_shr:4 row_mask:0xf bank_mask:0xf
    v_add_f32_dpp v70, v70, v70 row_shr:8 row_mask:0xf bank_mask:0xf
    v_add_f32_dpp v71, v71, v71 row_shr:8 row_mask:0xf bank_mask:0xf
    v_add_f32_dpp v72, v72, v72 row_shr:8 row_mask:0xf bank_mask:0xf
    v_add_f32_dpp v73, v73, v73 row_shr:8 row_mask:0xf bank_mask:0xf
    v_add_f32_dpp v70, v70, v70 row_bcast:15 row_mask:0xa bank_mask:0xf
    v_add_f32_dpp v71, v71, v71 row_bcast:15 row_mask:0xa bank_mask:0xf
    v_add_f32_dpp v72, v72, v72 row_bcast:15 row_mask:0xa bank_mask:0xf
    v_add_f32_dpp v73, v73, v73 row_bcast:15 row_mask:0xa bank_mask:0xf
    v_add_f32_dpp v70, v70, v70 row_bcast:31 row_mask:0xc bank_mask:0xf
    v_add_f32_dpp v71, v71, v71 row_bcast:31 row_mask:0xc bank_mask:0xf
    v_add_f32_dpp v72, v72, v72 row_bcast:31 row_mask:0xc bank_mask:0xf
    v_add_f32_dpp v73, v73, v73 row_bcast:31 row_mask:0xc bank_mask:0xf
    s_nop 1
    v_readlane_b32 s24, v70, 63
    v_readlane_b32 s25, v71, 63
    v_readlane_b32 s26, v72, 63
    v_readlane_b32 s27, v73, 63
    s_nop 1
    v_mul_f32 v82, s24, v9
    v_mul_f32 v83, s25, v9
    v_mul_f32 v84, s26, v9
    v_mul_f32 v85, s27, v9
    v_mov_b32 v8, 0x3727c5ac
    v_cvt_pk_bf16_f32 v74, v74, v74
    v_lshlrev_b32 v74, 16, v74
    v_cvt_pk_bf16_f32 v75, v75, v75
    v_lshlrev_b32 v75, 16, v75
    v_cvt_pk_bf16_f32 v76, v76, v76
    v_lshlrev_b32 v76, 16, v76
    v_cvt_pk_bf16_f32 v77, v77, v77
    v_lshlrev_b32 v77, 16, v77
    v_cvt_pk_bf16_f32 v82, v82, v82
    v_lshlrev_b32 v82, 16, v82
    v_cvt_pk_bf16_f32 v83, v83, v83
    v_lshlrev_b32 v83, 16, v83
    v_cvt_pk_bf16_f32 v84, v84, v84
    v_lshlrev_b32 v84, 16, v84
    v_cvt_pk_bf16_f32 v85, v85, v85
    v_lshlrev_b32 v85, 16, v85
    v_add_f32 v82, v82, v8
    v_add_f32 v83, v83, v8
    v_add_f32 v84, v84, v8
    v_add_f32 v85, v85, v8
    v_cvt_pk_bf16_f32 v82, v82, v82
    v_lshlrev_b32 v82, 16, v82
    v_cvt_pk_bf16_f32 v83, v83, v83
    v_lshlrev_b32 v83, 16, v83
    v_cvt_pk_bf16_f32 v84, v84, v84
    v_lshlrev_b32 v84, 16, v84
    v_cvt_pk_bf16_f32 v85, v85, v85
    v_lshlrev_b32 v85, 16, v85
    v_sqrt_f32 v82, v82
    v_sqrt_f32 v83, v83
    v_sqrt_f32 v84, v84
    v_sqrt_f32 v85, v85
    s_nop 0
    v_cvt_pk_bf16_f32 v82, v82, v82
    v_lshlrev_b32 v82, 16, v82
    v_cvt_pk_bf16_f32 v83, v83, v83
    v_lshlrev_b32 v83, 16, v83
    v_cvt_pk_bf16_f32 v84, v84, v84
    v_lshlrev_b32 v84, 16, v84
    v_cvt_pk_bf16_f32 v85, v85, v85
    v_lshlrev_b32 v85, 16, v85
    v_rcp_f32 v86, v82
    v_rcp_f32 v87, v83
    v_rcp_f32 v88, v84
    v_rcp_f32 v89, v85
    s_nop 0
    v_sub_f32 v30, v30, v74
    v_sub_f32 v40, v40, v75
    v_sub_f32 v50, v50, v76
    v_sub_f32 v60, v60, v77
    v_cvt_pk_bf16_f32 v30, v30, v30
    v_lshlrev_b32 v30, 16, v30
    v_cvt_pk_bf16_f32 v40, v40, v40
    v_lshlrev_b32 v40, 16, v40
    v_cvt_pk_bf16_f32 v50, v50, v50
    v_lshlrev_b32 v50, 16, v50
    v_cvt_pk_bf16_f32 v60, v60, v60
    v_lshlrev_b32 v60, 16, v60
    v_mul_f32 v78, v30, v86
    v_mul_f32 v79, v40, v87
    v_mul_f32 v80, v50, v88
    v_mul_f32 v81, v60, v89
    v_fma_f32 v30, -v78, v82, v30
    v_fma_f32 v40, -v79, v83, v40
    v_fma_f32 v50, -v80, v84, v50
    v_fma_f32 v60, -v81, v85, v60
    v_fma_f32 v30, v30, v86, v78
    v_fma_f32 v40, v40, v87, v79
    v_fma_f32 v50, v50, v88, v80
    v_fma_f32 v60, v60, v89, v81
    v_sub_f32 v31, v31, v74
    v_sub_f32 v41, v41, v75
    v_sub_f32 v51, v51, v76
    v_sub_f32 v61, v61, v77
    v_cvt_pk_bf16_f32 v31, v31, v31
    v_lshlrev_b32 v31, 16, v31
    v_cvt_pk_bf16_f32 v41, v41, v41
    v_lshlrev_b32 v41, 16, v41
    v_cvt_pk_bf16_f32 v51, v51, v51
    v_lshlrev_b32 v51, 16, v51
    v_cvt_pk_bf16_f32 v61, v61, v61
    v_lshlrev_b32 v61, 16, v61
    v_mul_f32 v78, v31, v86
    v_mul_f32 v79, v41, v87
    v_mul_f32 v80, v51, v88
    v_mul_f32 v81, v61, v89
    v_fma_f32 v31, -v78, v82, v31
    v_fma_f32 v41, -v79, v83, v41
    v_fma_f32 v51, -v80, v84, v51
    v_fma_f32 v61, -v81, v85, v61
    v_fma_f32 v31, v31, v86, v78
    v_fma_f32 v41, v41, v87, v79
    v_fma_f32 v51, v51, v88, v80
    v_fma_f32 v61, v61, v89, v81
    v_sub_f32 v32, v32, v74
    v_sub_f32 v42, v42, v75
    v_sub_f32 v52, v52, v76
    v_sub_f32 v62, v62, v77
    v_cvt_pk_bf16_f32 v32, v32, v32
    v_lshlrev_b32 v32, 16, v32
    v_cvt_pk_bf16_f32 v42, v42, v42
    v_lshlrev_b32 v42, 16, v42
    v_cvt_pk_bf16_f32 v52, v52, v52
    v_lshlrev_b32 v52, 16, v52
    v_cvt_pk_bf16_f32 v62, v62, v62
    v_lshlrev_b32 v62, 16, v62
    v_mul_f32 v78, v32, v86
    v_mul_f32 v79, v42, v87
    v_mul_f32 v80, v52, v88
    v_mul_f32 v81, v62, v89
    v_fma_f32 v32, -v78, v82, v32
    v_fma_f32 v42, -v79, v83, v42
    v_fma_f32 v52, -v80, v84, v52
    v_fma_f32 v62, -v81, v85, v62
    v_fma_f32 v32, v32, v86, v78
    v_fma_f32 v42, v42, v87, v79
    v_fma_f32 v52, v52, v88, v80
    v_fma_f32 v62, v62, v89, v81
    v_sub_f32 v33, v33, v74
    v_sub_f32 v43, v43, v75
    v_sub_f32 v53, v53, v76
    v_sub_f32 v63, v63, v77
    v_cvt_pk_bf16_f32 v33, v33, v33
    v_lshlrev_b32 v33, 16, v33
    v_cvt_pk_bf16_f32 v43, v43, v43
    v_lshlrev_b32 v43, 16, v43
    v_cvt_pk_bf16_f32 v53, v53, v53
    v_lshlrev_b32 v53, 16, v53
    v_cvt_pk_bf16_f32 v63, v63, v63
    v_lshlrev_b32 v63, 16, v63
    v_mul_f32 v78, v33, v86
    v_mul_f32 v79, v43, v87
    v_mul_f32 v80, v53, v88
    v_mul_f32 v81, v63, v89
    v_fma_f32 v33, -v78, v82, v33
    v_fma_f32 v43, -v79, v83, v43
    v_fma_f32 v53, -v80, v84, v53
    v_fma_f32 v63, -v81, v85, v63
    v_fma_f32 v33, v33, v86, v78
    v_fma_f32 v43, v43, v87, v79
    v_fma_f32 v53, v53, v88, v80
    v_fma_f32 v63, v63, v89, v81
    v_sub_f32 v34, v34, v74
    v_sub_f32 v44, v44, v75
    v_sub_f32 v54, v54, v76
    v_sub_f32 v64, v64, v77
    v_cvt_pk_bf16_f32 v34, v34, v34
    v_lshlrev_b32 v34, 16, v34
    v_cvt_pk_bf16_f32 v44, v44, v44
    v_lshlrev_b32 v44, 16, v44
    v_cvt_pk_bf16_f32 v54, v54, v54
    v_lshlrev_b32 v54, 16, v54
    v_cvt_pk_bf16_f32 v64, v64, v64
    v_lshlrev_b32 v64, 16, v64
    v_mul_f32 v78, v34, v86
    v_mul_f32 v79, v44, v87
    v_mul_f32 v80, v54, v88
    v_mul_f32 v81, v64, v89
    v_fma_f32 v34, -v78, v82, v34
    v_fma_f32 v44, -v79, v83, v44
    v_fma_f32 v54, -v80, v84, v54
    v_fma_f32 v64, -v81, v85, v64
    v_fma_f32 v34, v34, v86, v78
    v_fma_f32 v44, v44, v87, v79
    v_fma_f32 v54, v54, v88, v80
    v_fma_f32 v64, v64, v89, v81
    v_sub_f32 v35, v35, v74
    v_sub_f32 v45, v45, v75
    v_sub_f32 v55, v55, v76
    v_sub_f32 v65, v65, v77
    v_cvt_pk_bf16_f32 v35, v35, v35
    v_lshlrev_b32 v35, 16, v35
    v_cvt_pk_bf16_f32 v45, v45, v45
    v_lshlrev_b32 v45, 16, v45
    v_cvt_pk_bf16_f32 v55, v55, v55
    v_lshlrev_b32 v55, 16, v55
    v_cvt_pk_bf16_f32 v65, v65, v65
    v_lshlrev_b32 v65, 16, v65
    v_mul_f32 v78, v35, v86
    v_mul_f32 v79, v45, v87
    v_mul_f32 v80, v55, v88
    v_mul_f32 v81, v65, v89
    v_fma_f32 v35, -v78, v82, v35
    v_fma_f32 v45, -v79, v83, v45
    v_fma_f32 v55, -v80, v84, v55
    v_fma_f32 v65, -v81, v85, v65
    v_fma_f32 v35, v35, v86, v78
    v_fma_f32 v45, v45, v87, v79
    v_fma_f32 v55, v55, v88, v80
    v_fma_f32 v65, v65, v89, v81
    v_sub_f32 v36, v36, v74
    v_sub_f32 v46, v46, v75
    v_sub_f32 v56, v56, v76
    v_sub_f32 v66, v66, v77
    v_cvt_pk_bf16_f32 v36, v36, v36
    v_lshlrev_b32 v36, 16, v36
    v_cvt_pk_bf16_f32 v46, v46, v46
    v_lshlrev_b32 v46, 16, v46
    v_cvt_pk_bf16_f32 v56, v56, v56
    v_lshlrev_b32 v56, 16, v56
    v_cvt_pk_bf16_f32 v66, v66, v66
    v_lshlrev_b32 v66, 16, v66
    v_mul_f32 v78, v36, v86
    v_mul_f32 v79, v46, v87
    v_mul_f32 v80, v56, v88
    v_mul_f32 v81, v66, v89
    v_fma_f32 v36, -v78, v82, v36
    v_fma_f32 v46, -v79, v83, v46
    v_fma_f32 v56, -v80, v84, v56
    v_fma_f32 v66, -v81, v85, v66
    v_fma_f32 v36, v36, v86, v78
    v_fma_f32 v46, v46, v87, v79
    v_fma_f32 v56, v56, v88, v80
    v_fma_f32 v66, v66, v89, v81
    v_sub_f32 v37, v37, v74
    v_sub_f32 v47, v47, v75
    v_sub_f32 v57, v57, v76
    v_sub_f32 v67, v67, v77
    v_cvt_pk_bf16_f32 v37, v37, v37
    v_lshlrev_b32 v37, 16, v37
    v_cvt_pk_bf16_f32 v47, v47, v47
    v_lshlrev_b32 v47, 16, v47
    v_cvt_pk_bf16_f32 v57, v57, v57
    v_lshlrev_b32 v57, 16, v57
    v_cvt_pk_bf16_f32 v67, v67, v67
    v_lshlrev_b32 v67, 16, v67
    v_mul_f32 v78, v37, v86
    v_mul_f32 v79, v47, v87
    v_mul_f32 v80, v57, v88
    v_mul_f32 v81, v67, v89
    v_fma_f32 v37, -v78, v82, v37
    v_fma_f32 v47, -v79, v83, v47
    v_fma_f32 v57, -v80, v84, v57
    v_fma_f32 v67, -v81, v85, v67
    v_fma_f32 v37, v37, v86, v78
    v_fma_f32 v47, v47, v87, v79
    v_fma_f32 v57, v57, v88, v80
    v_fma_f32 v67, v67, v89, v81
    v_sub_f32 v38, v38, v74
    v_sub_f32 v48, v48, v75
    v_sub_f32 v58, v58, v76
    v_sub_f32 v68, v68, v77
    v_cvt_pk_bf16_f32 v38, v38, v38
    v_lshlrev_b32 v38, 16, v38
    v_cvt_pk_bf16_f32 v48, v48, v48
    v_lshlrev_b32 v48, 16, v48
    v_cvt_pk_bf16_f32 v58, v58, v58
    v_lshlrev_b32 v58, 16, v58
    v_cvt_pk_bf16_f32 v68, v68, v68
    v_lshlrev_b32 v68, 16, v68
    v_mul_f32 v78, v38, v86
    v_mul_f32 v79, v48, v87
    v_mul_f32 v80, v58, v88
    v_mul_f32 v81, v68, v89
    v_fma_f32 v38, -v78, v82, v38
    v_fma_f32 v48, -v79, v83, v48
    v_fma_f32 v58, -v80, v84, v58
    v_fma_f32 v68, -v81, v85, v68
    v_fma_f32 v38, v38, v86, v78
    v_fma_f32 v48, v48, v87, v79
    v_fma_f32 v58, v58, v88, v80
    v_fma_f32 v68, v68, v89, v81
    v_sub_f32 v39, v39, v74
    v_sub_f32 v49, v49, v75
    v_sub_f32 v59, v59, v76
    v_sub_f32 v69, v69, v77
    v_cvt_pk_bf16_f32 v39, v39, v39
    v_lshlrev_b32 v39, 16, v39
    v_cvt_pk_bf16_f32 v49, v49, v49
    v_lshlrev_b32 v49, 16, v49
    v_cvt_pk_bf16_f32 v59, v59, v59
    v_lshlrev_b32 v59, 16, v59
    v_cvt_pk_bf16_f32 v69, v69, v69
    v_lshlrev_b32 v69, 16, v69
    v_mul_f32 v78, v39, v86
    v_mul_f32 v79, v49, v87
    v_mul_f32 v80, v59, v88
    v_mul_f32 v81, v69, v89
    v_fma_f32 v39, -v78, v82, v39
    v_fma_f32 v49, -v79, v83, v49
    v_fma_f32 v59, -v80, v84, v59
    v_fma_f32 v69, -v81, v85, v69
    v_fma_f32 v39, v39, v86, v78
    v_fma_f32 v49, v49, v87, v79
    v_fma_f32 v59, v59, v88, v80
    v_fma_f32 v69, v69, v89, v81
    v_cvt_pk_bf16_f32 v90, v30, v40
    v_cvt_pk_bf16_f32 v91, v50, v60
    ds_write_b64 v4, v[90:91] offset:0
    v_cvt_pk_bf16_f32 v92, v31, v41
    v_cvt_pk_bf16_f32 v93, v51, v61
    ds_write_b64 v4, v[92:93] offset:32
    v_cvt_pk_bf16_f32 v90, v32, v42
    v_cvt_pk_bf16_f32 v91, v52, v62
    ds_write_b64 v4, v[90:91] offset:4096
    v_cvt_pk_bf16_f32 v92, v33, v43
    v_cvt_pk_bf16_f32 v93, v53, v63
    ds_write_b64 v4, v[92:93] offset:4128
    v_cvt_pk_bf16_f32 v90, v34, v44
    v_cvt_pk_bf16_f32 v91, v54, v64
    ds_write_b64 v4, v[90:91] offset:8192
    v_cvt_pk_bf16_f32 v92, v35, v45
    v_cvt_pk_bf16_f32 v93, v55, v65
    ds_write_b64 v4, v[92:93] offset:8224
    v_cvt_pk_bf16_f32 v90, v36, v46
    v_cvt_pk_bf16_f32 v91, v56, v66
    ds_write_b64 v4, v[90:91] offset:12288
    v_cvt_pk_bf16_f32 v92, v37, v47
    v_cvt_pk_bf16_f32 v93, v57, v67
    ds_write_b64 v4, v[92:93] offset:12320
    v_cvt_pk_bf16_f32 v90, v38, v48
    v_cvt_pk_bf16_f32 v91, v58, v68
    ds_write_b64 v4, v[90:91] offset:16384
    v_cvt_pk_bf16_f32 v92, v39, v49
    v_cvt_pk_bf16_f32 v93, v59, v69
    ds_write_b64 v4, v[92:93] offset:16416
    s_waitcnt lgkmcnt(0)
    s_barrier
    ds_read_b128 v[96:99], v5 offset:0
    ds_read_b128 v[100:103], v5 offset:16
    ds_read_b128 v[104:107], v5 offset:8192
    ds_read_b128 v[108:111], v5 offset:8208
    s_waitcnt lgkmcnt(0)
    buffer_store_dwordx4 v[96:99], v6, s[12:15], s18 offen
    buffer_store_dwordx4 v[100:103], v6, s[12:15], s18 offen offset:16
    buffer_store_dwordx4 v[104:107], v6, s[12:15], s19 offen
    buffer_store_dwordx4 v[108:111], v6, s[12:15], s19 offen offset:16
    v_cmp_gt_u32 vcc, 128, v0
    s_and_saveexec_b64 s[30:31], vcc
    s_cbranch_execz L_end_25
    ds_read_b128 v[112:115], v5 offset:16384
    ds_read_b128 v[116:119], v5 offset:16400
    s_waitcnt lgkmcnt(0)
    buffer_store_dwordx4 v[112:115], v6, s[12:15], s28 offen
    buffer_store_dwordx4 v[116:119], v6, s[12:15], s28 offen offset:16
L_end_25:
    s_endpgm
.text
.globl gemm1_kernel
.p2align 8
.type gemm1_kernel,@function
gemm1_kernel:
    s_cmp_ge_u32 s2, 240
    s_cbranch_scc1 L_end_27
    s_load_dwordx2 s[4:5], s[0:1], 112
    s_waitcnt lgkmcnt(0)
    s_add_u32 s8, s4, 0x920000
    s_addc_u32 s9, s5, 0
    s_mov_b32 s10, 0x280000
    s_mov_b32 s11, 0x00020000
    s_add_u32 s12, s4, 0xd80000
    s_addc_u32 s13, s5, 0
    s_mov_b32 s14, 0x600000
    s_mov_b32 s15, 0x00020000
    s_mul_hi_u32 s16, s2, 178956971
    s_mul_i32 s17, s16, 24
    s_sub_u32 s17, s2, s17
    v_and_b32 v1, 63, v0
    v_lshrrev_b32 v2, 6, v0
    s_nop 0
    v_readfirstlane_b32 s18, v2
    v_lshrrev_b32 v3, 3, v1
    v_lshl_add_u32 v3, v2, 4, v3
    v_and_b32 v4, 7, v1
    v_add_u32 v5, 0, v3
    v_lshrrev_b32 v6, 1, v5
    v_and_b32 v6, 7, v6
    v_xor_b32 v6, v6, v4
    v_mul_u32_u24 v10, 4096, v5
    v_lshl_add_u32 v10, v6, 4, v10
    v_add_u32 v5, 8, v3
    v_lshrrev_b32 v6, 1, v5
    v_and_b32 v6, 7, v6
    v_xor_b32 v6, v6, v4
    v_mul_u32_u24 v11, 4096, v5
    v_lshl_add_u32 v11, v6, 4, v11
    s_mul_i32 s20, s16, 262144
    s_mul_i32 s21, s17, 262144
    v_and_b32 v3, 31, v1
    v_lshrrev_b32 v4, 5, v1
    v_lshrrev_b32 v5, 1, v2
    v_and_b32 v6, 1, v2
    v_lshl_add_u32 v7, v5, 5, v3
    v_lshrrev_b32 v8, 1, v7
    v_and_b32 v8, 7, v8
    v_add_u32 v9, 0, v4
    v_xor_b32 v9, v9, v8
    v_lshl_add_u32 v9, v7, 3, v9
    v_lshlrev_b32 v12, 4, v9
    v_add_u32 v9, 2, v4
    v_xor_b32 v9, v9, v8
    v_lshl_add_u32 v9, v7, 3, v9
    v_lshlrev_b32 v13, 4, v9
    v_add_u32 v9, 4, v4
    v_xor_b32 v9, v9, v8
    v_lshl_add_u32 v9, v7, 3, v9
    v_lshlrev_b32 v14, 4, v9
    v_add_u32 v9, 6, v4
    v_xor_b32 v9, v9, v8
    v_lshl_add_u32 v9, v7, 3, v9
    v_lshlrev_b32 v15, 4, v9
    v_lshl_add_u32 v7, v6, 5, v3
    v_lshrrev_b32 v8, 1, v7
    v_and_b32 v8, 7, v8
    v_add_u32 v9, 0, v4
    v_xor_b32 v9, v9, v8
    v_lshl_add_u32 v9, v7, 3, v9
    v_lshlrev_b32 v16, 4, v9
    v_add_u32 v9, 2, v4
    v_xor_b32 v9, v9, v8
    v_lshl_add_u32 v9, v7, 3, v9
    v_lshlrev_b32 v17, 4, v9
    v_add_u32 v9, 4, v4
    v_xor_b32 v9, v9, v8
    v_lshl_add_u32 v9, v7, 3, v9
    v_lshlrev_b32 v18, 4, v9
    v_add_u32 v9, 6, v4
    v_xor_b32 v9, v9, v8
    v_lshl_add_u32 v9, v7, 3, v9
    v_lshlrev_b32 v19, 4, v9
    v_mov_b32 v32, 0
    v_mov_b32 v33, 0
    v_mov_b32 v34, 0
    v_mov_b32 v35, 0
    v_mov_b32 v36, 0
    v_mov_b32 v37, 0
    v_mov_b32 v38, 0
    v_mov_b32 v39, 0
    v_mov_b32 v40, 0
    v_mov_b32 v41, 0
    v_mov_b32 v42, 0
    v_mov_b32 v43, 0
    v_mov_b32 v44, 0
    v_mov_b32 v45, 0
    v_mov_b32 v46, 0
    v_mov_b32 v47, 0
    s_lshl_b32 s22, s18, 11
    s_add_u32 m0, s22, 0
    s_nop 0
    buffer_load_dwordx4 v10, s[8:11], s20 offen lds
    s_add_u32 m0, s22, 1024
    s_nop 0
    buffer_load_dwordx4 v11, s[8:11], s20 offen lds
    s_add_u32 m0, s22, 8192
    s_nop 0
    buffer_load_dwordx4 v10, s[12:15], s21 offen lds
    s_add_u32 m0, s22, 9216
    s_nop 0
    buffer_load_dwordx4 v11, s[12:15], s21 offen lds
    s_add_u32 s20, s20, 128
    s_add_u32 s21, s21, 128
    s_add_u32 m0, s22, 16384
    s_nop 0
    buffer_load_dwordx4 v10, s[8:11], s20 offen lds
    s_add_u32 m0, s22, 17408
    s_nop 0
    buffer_load_dwordx4 v11, s[8:11], s20 offen lds
    s_add_u32 m0, s22, 24576
    s_nop 0
    buffer_load_dwordx4 v10, s[12:15], s21 offen lds
    s_add_u32 m0, s22, 25600
    s_nop 0
    buffer_load_dwordx4 v11, s[12:15], s21 offen lds
    s_add_u32 s20, s20, 128
    s_add_u32 s21, s21, 128
    s_add_u32 m0, s22, 32768
    s_nop 0
    buffer_load_dwordx4 v10, s[8:11], s20 offen lds
    s_add_u32 m0, s22, 33792
    s_nop 0
    buffer_load_dwordx4 v11, s[8:11], s20 offen lds
    s_add_u32 m0, s22, 40960
    s_nop 0
    buffer_load_dwordx4 v10, s[12:15], s21 offen lds
    s_add_u32 m0, s22, 41984
    s_nop 0
    buffer_load_dwordx4 v11, s[12:15], s21 offen lds
    s_add_u32 s20, s20, 128
    s_add_u32 s21, s21, 128
    s_waitcnt vmcnt(8)
    s_barrier
    s_add_u32 m0, s22, 49152
    s_nop 0
    buffer_load_dwordx4 v10, s[8:11], s20 offen lds
    s_add_u32 m0, s22, 50176
    s_nop 0
    buffer_load_dwordx4 v11, s[8:11], s20 offen lds
    s_add_u32 m0, s22, 57344
    s_nop 0
    buffer_load_dwordx4 v10, s[12:15], s21 offen lds
    s_add_u32 m0, s22, 58368
    s_nop 0
    buffer_load_dwordx4 v11, s[12:15], s21 offen lds
    s_add_u32 s20, s20, 128
    s_add_u32 s21, s21, 128
    ds_read_b128 v[48:51], v12 offset:0
    ds_read_b128 v[64:67], v16 offset:8192
    ds_read_b128 v[52:55], v13 offset:0
    ds_read_b128 v[68:71], v17 offset:8192
    ds_read_b128 v[56:59], v14 offset:0
    ds_read_b128 v[72:75], v18 offset:8192
    ds_read_b128 v[60:63], v15 offset:0
    ds_read_b128 v[76:79], v19 offset:8192
    s_waitcnt lgkmcnt(6)
    v_mfma_f32_32x32x16_bf16 v[32:47], v[48:51], v[64:67], v[32:47]
    s_waitcnt lgkmcnt(4)
    v_mfma_f32_32x32x16_bf16 v[32:47], v[52:55], v[68:71], v[32:47]
    s_waitcnt lgkmcnt(2)
    v_mfma_f32_32x32x16_bf16 v[32:47], v[56:59], v[72:75], v[32:47]
    s_waitcnt lgkmcnt(0)
    v_mfma_f32_32x32x16_bf16 v[32:47], v[60:63], v[76:79], v[32:47]
    s_waitcnt vmcnt(8)
    s_barrier
    s_add_u32 m0, s22, 0
    s_nop 0
    buffer_load_dwordx4 v10, s[8:11], s20 offen lds
    s_add_u32 m0, s22, 1024
    s_nop 0
    buffer_load_dwordx4 v11, s[8:11], s20 offen lds
    s_add_u32 m0, s22, 8192
    s_nop 0
    buffer_load_dwordx4 v10, s[12:15], s21 offen lds
    s_add_u32 m0, s22, 9216
    s_nop 0
    buffer_load_dwordx4 v11, s[12:15], s21 offen lds
    s_add_u32 s20, s20, 128
    s_add_u32 s21, s21, 128
    ds_read_b128 v[48:51], v12 offset:16384
    ds_read_b128 v[64:67], v16 offset:24576
    ds_read_b128 v[52:55], v13 offset:16384
    ds_read_b128 v[68:71], v17 offset:24576
    ds_read_b128 v[56:59], v14 offset:16384
    ds_read_b128 v[72:75], v18 offset:24576
    ds_read_b128 v[60:63], v15 offset:16384
    ds_read_b128 v[76:79], v19 offset:24576
    s_waitcnt lgkmcnt(6)
    v_mfma_f32_32x32x16_bf16 v[32:47], v[48:51], v[64:67], v[32:47]
    s_waitcnt lgkmcnt(4)
    v_mfma_f32_32x32x16_bf16 v[32:47], v[52:55], v[68:71], v[32:47]
    s_waitcnt lgkmcnt(2)
    v_mfma_f32_32x32x16_bf16 v[32:47], v[56:59], v[72:75], v[32:47]
    s_waitcnt lgkmcnt(0)
    v_mfma_f32_32x32x16_bf16 v[32:47], v[60:63], v[76:79], v[32:47]
    s_waitcnt vmcnt(8)
    s_barrier
    s_add_u32 m0, s22, 16384
    s_nop 0
    buffer_load_dwordx4 v10, s[8:11], s20 offen lds
    s_add_u32 m0, s22, 17408
    s_nop 0
    buffer_load_dwordx4 v11, s[8:11], s20 offen lds
    s_add_u32 m0, s22, 24576
    s_nop 0
    buffer_load_dwordx4 v10, s[12:15], s21 offen lds
    s_add_u32 m0, s22, 25600
    s_nop 0
    buffer_load_dwordx4 v11, s[12:15], s21 offen lds
    s_add_u32 s20, s20, 128
    s_add_u32 s21, s21, 128
    ds_read_b128 v[48:51], v12 offset:32768
    ds_read_b128 v[64:67], v16 offset:40960
    ds_read_b128 v[52:55], v13 offset:32768
    ds_read_b128 v[68:71], v17 offset:40960
    ds_read_b128 v[56:59], v14 offset:32768
    ds_read_b128 v[72:75], v18 offset:40960
    ds_read_b128 v[60:63], v15 offset:32768
    ds_read_b128 v[76:79], v19 offset:40960
    s_waitcnt lgkmcnt(6)
    v_mfma_f32_32x32x16_bf16 v[32:47], v[48:51], v[64:67], v[32:47]
    s_waitcnt lgkmcnt(4)
    v_mfma_f32_32x32x16_bf16 v[32:47], v[52:55], v[68:71], v[32:47]
    s_waitcnt lgkmcnt(2)
    v_mfma_f32_32x32x16_bf16 v[32:47], v[56:59], v[72:75], v[32:47]
    s_waitcnt lgkmcnt(0)
    v_mfma_f32_32x32x16_bf16 v[32:47], v[60:63], v[76:79], v[32:47]
    s_waitcnt vmcnt(8)
    s_barrier
    s_add_u32 m0, s22, 32768
    s_nop 0
    buffer_load_dwordx4 v10, s[8:11], s20 offen lds
    s_add_u32 m0, s22, 33792
    s_nop 0
    buffer_load_dwordx4 v11, s[8:11], s20 offen lds
    s_add_u32 m0, s22, 40960
    s_nop 0
    buffer_load_dwordx4 v10, s[12:15], s21 offen lds
    s_add_u32 m0, s22, 41984
    s_nop 0
    buffer_load_dwordx4 v11, s[12:15], s21 offen lds
    s_add_u32 s20, s20, 128
    s_add_u32 s21, s21, 128
    ds_read_b128 v[48:51], v12 offset:49152
    ds_read_b128 v[64:67], v16 offset:57344
    ds_read_b128 v[52:55], v13 offset:49152
    ds_read_b128 v[68:71], v17 offset:57344
    ds_read_b128 v[56:59], v14 offset:49152
    ds_read_b128 v[72:75], v18 offset:57344
    ds_read_b128 v[60:63], v15 offset:49152
    ds_read_b128 v[76:79], v19 offset:57344
    s_waitcnt lgkmcnt(6)
    v_mfma_f32_32x32x16_bf16 v[32:47], v[48:51], v[64:67], v[32:47]
    s_waitcnt lgkmcnt(4)
    v_mfma_f32_32x32x16_bf16 v[32:47], v[52:55], v[68:71], v[32:47]
    s_waitcnt lgkmcnt(2)
    v_mfma_f32_32x32x16_bf16 v[32:47], v[56:59], v[72:75], v[32:47]
    s_waitcnt lgkmcnt(0)
    v_mfma_f32_32x32x16_bf16 v[32:47], v[60:63], v[76:79], v[32:47]
    s_waitcnt vmcnt(8)
    s_barrier
    s_add_u32 m0, s22, 49152
    s_nop 0
    buffer_load_dwordx4 v10, s[8:11], s20 offen lds
    s_add_u32 m0, s22, 50176
    s_nop 0
    buffer_load_dwordx4 v11, s[8:11], s20 offen lds
    s_add_u32 m0, s22, 57344
    s_nop 0
    buffer_load_dwordx4 v10, s[12:15], s21 offen lds
    s_add_u32 m0, s22, 58368
    s_nop 0
    buffer_load_dwordx4 v11, s[12:15], s21 offen lds
    s_add_u32 s20, s20, 128
    s_add_u32 s21, s21, 128
    ds_read_b128 v[48:51], v12 offset:0
    ds_read_b128 v[64:67], v16 offset:8192
    ds_read_b128 v[52:55], v13 offset:0
    ds_read_b128 v[68:71], v17 offset:8192
    ds_read_b128 v[56:59], v14 offset:0
    ds_read_b128 v[72:75], v18 offset:8192
    ds_read_b128 v[60:63], v15 offset:0
    ds_read_b128 v[76:79], v19 offset:8192
    s_waitcnt lgkmcnt(6)
    v_mfma_f32_32x32x16_bf16 v[32:47], v[48:51], v[64:67], v[32:47]
    s_waitcnt lgkmcnt(4)
    v_mfma_f32_32x32x16_bf16 v[32:47], v[52:55], v[68:71], v[32:47]
    s_waitcnt lgkmcnt(2)
    v_mfma_f32_32x32x16_bf16 v[32:47], v[56:59], v[72:75], v[32:47]
    s_waitcnt lgkmcnt(0)
    v_mfma_f32_32x32x16_bf16 v[32:47], v[60:63], v[76:79], v[32:47]
    s_waitcnt vmcnt(8)
    s_barrier
    s_add_u32 m0, s22, 0
    s_nop 0
    buffer_load_dwordx4 v10, s[8:11], s20 offen lds
    s_add_u32 m0, s22, 1024
    s_nop 0
    buffer_load_dwordx4 v11, s[8:11], s20 offen lds
    s_add_u32 m0, s22, 8192
    s_nop 0
    buffer_load_dwordx4 v10, s[12:15], s21 offen lds
    s_add_u32 m0, s22, 9216
    s_nop 0
    buffer_load_dwordx4 v11, s[12:15], s21 offen lds
    s_add_u32 s20, s20, 128
    s_add_u32 s21, s21, 128
    ds_read_b128 v[48:51], v12 offset:16384
    ds_read_b128 v[64:67], v16 offset:24576
    ds_read_b128 v[52:55], v13 offset:16384
    ds_read_b128 v[68:71], v17 offset:24576
    ds_read_b128 v[56:59], v14 offset:16384
    ds_read_b128 v[72:75], v18 offset:24576
    ds_read_b128 v[60:63], v15 offset:16384
    ds_read_b128 v[76:79], v19 offset:24576
    s_waitcnt lgkmcnt(6)
    v_mfma_f32_32x32x16_bf16 v[32:47], v[48:51], v[64:67], v[32:47]
    s_waitcnt lgkmcnt(4)
    v_mfma_f32_32x32x16_bf16 v[32:47], v[52:55], v[68:71], v[32:47]
    s_waitcnt lgkmcnt(2)
    v_mfma_f32_32x32x16_bf16 v[32:47], v[56:59], v[72:75], v[32:47]
    s_waitcnt lgkmcnt(0)
    v_mfma_f32_32x32x16_bf16 v[32:47], v[60:63], v[76:79], v[32:47]
    s_waitcnt vmcnt(8)
    s_barrier
    s_add_u32 m0, s22, 16384
    s_nop 0
    buffer_load_dwordx4 v10, s[8:11], s20 offen lds
    s_add_u32 m0, s22, 17408
    s_nop 0
    buffer_load_dwordx4 v11, s[8:11], s20 offen lds
    s_add_u32 m0, s22, 24576
    s_nop 0
    buffer_load_dwordx4 v10, s[12:15], s21 offen lds
    s_add_u32 m0, s22, 25600
    s_nop 0
    buffer_load_dwordx4 v11, s[12:15], s21 offen lds
    s_add_u32 s20, s20, 128
    s_add_u32 s21, s21, 128
    ds_read_b128 v[48:51], v12 offset:32768
    ds_read_b128 v[64:67], v16 offset:40960
    ds_read_b128 v[52:55], v13 offset:32768
    ds_read_b128 v[68:71], v17 offset:40960
    ds_read_b128 v[56:59], v14 offset:32768
    ds_read_b128 v[72:75], v18 offset:40960
    ds_read_b128 v[60:63], v15 offset:32768
    ds_read_b128 v[76:79], v19 offset:40960
    s_waitcnt lgkmcnt(6)
    v_mfma_f32_32x32x16_bf16 v[32:47], v[48:51], v[64:67], v[32:47]
    s_waitcnt lgkmcnt(4)
    v_mfma_f32_32x32x16_bf16 v[32:47], v[52:55], v[68:71], v[32:47]
    s_waitcnt lgkmcnt(2)
    v_mfma_f32_32x32x16_bf16 v[32:47], v[56:59], v[72:75], v[32:47]
    s_waitcnt lgkmcnt(0)
    v_mfma_f32_32x32x16_bf16 v[32:47], v[60:63], v[76:79], v[32:47]
    s_waitcnt vmcnt(8)
    s_barrier
    s_add_u32 m0, s22, 32768
    s_nop 0
    buffer_load_dwordx4 v10, s[8:11], s20 offen lds
    s_add_u32 m0, s22, 33792
    s_nop 0
    buffer_load_dwordx4 v11, s[8:11], s20 offen lds
    s_add_u32 m0, s22, 40960
    s_nop 0
    buffer_load_dwordx4 v10, s[12:15], s21 offen lds
    s_add_u32 m0, s22, 41984
    s_nop 0
    buffer_load_dwordx4 v11, s[12:15], s21 offen lds
    s_add_u32 s20, s20, 128
    s_add_u32 s21, s21, 128
    ds_read_b128 v[48:51], v12 offset:49152
    ds_read_b128 v[64:67], v16 offset:57344
    ds_read_b128 v[52:55], v13 offset:49152
    ds_read_b128 v[68:71], v17 offset:57344
    ds_read_b128 v[56:59], v14 offset:49152
    ds_read_b128 v[72:75], v18 offset:57344
    ds_read_b128 v[60:63], v15 offset:49152
    ds_read_b128 v[76:79], v19 offset:57344
    s_waitcnt lgkmcnt(6)
    v_mfma_f32_32x32x16_bf16 v[32:47], v[48:51], v[64:67], v[32:47]
    s_waitcnt lgkmcnt(4)
    v_mfma_f32_32x32x16_bf16 v[32:47], v[52:55], v[68:71], v[32:47]
    s_waitcnt lgkmcnt(2)
    v_mfma_f32_32x32x16_bf16 v[32:47], v[56:59], v[72:75], v[32:47]
    s_waitcnt lgkmcnt(0)
    v_mfma_f32_32x32x16_bf16 v[32:47], v[60:63], v[76:79], v[32:47]
    s_waitcnt vmcnt(8)
    s_barrier
    s_add_u32 m0, s22, 49152
    s_nop 0
    buffer_load_dwordx4 v10, s[8:11], s20 offen lds
    s_add_u32 m0, s22, 50176
    s_nop 0
    buffer_load_dwordx4 v11, s[8:11], s20 offen lds
    s_add_u32 m0, s22, 57344
    s_nop 0
    buffer_load_dwordx4 v10, s[12:15], s21 offen lds
    s_add_u32 m0, s22, 58368
    s_nop 0
    buffer_load_dwordx4 v11, s[12:15], s21 offen lds
    s_add_u32 s20, s20, 128
    s_add_u32 s21, s21, 128
    ds_read_b128 v[48:51], v12 offset:0
    ds_read_b128 v[64:67], v16 offset:8192
    ds_read_b128 v[52:55], v13 offset:0
    ds_read_b128 v[68:71], v17 offset:8192
    ds_read_b128 v[56:59], v14 offset:0
    ds_read_b128 v[72:75], v18 offset:8192
    ds_read_b128 v[60:63], v15 offset:0
    ds_read_b128 v[76:79], v19 offset:8192
    s_waitcnt lgkmcnt(6)
    v_mfma_f32_32x32x16_bf16 v[32:47], v[48:51], v[64:67], v[32:47]
    s_waitcnt lgkmcnt(4)
    v_mfma_f32_32x32x16_bf16 v[32:47], v[52:55], v[68:71], v[32:47]
    s_waitcnt lgkmcnt(2)
    v_mfma_f32_32x32x16_bf16 v[32:47], v[56:59], v[72:75], v[32:47]
    s_waitcnt lgkmcnt(0)
    v_mfma_f32_32x32x16_bf16 v[32:47], v[60:63], v[76:79], v[32:47]
    s_waitcnt vmcnt(8)
    s_barrier
    s_add_u32 m0, s22, 0
    s_nop 0
    buffer_load_dwordx4 v10, s[8:11], s20 offen lds
    s_add_u32 m0, s22, 1024
    s_nop 0
    buffer_load_dwordx4 v11, s[8:11], s20 offen lds
    s_add_u32 m0, s22, 8192
    s_nop 0
    buffer_load_dwordx4 v10, s[12:15], s21 offen lds
    s_add_u32 m0, s22, 9216
    s_nop 0
    buffer_load_dwordx4 v11, s[12:15], s21 offen lds
    s_add_u32 s20, s20, 128
    s_add_u32 s21, s21, 128
    ds_read_b128 v[48:51], v12 offset:16384
    ds_read_b128 v[64:67], v16 offset:24576
    ds_read_b128 v[52:55], v13 offset:16384
    ds_read_b128 v[68:71], v17 offset:24576
    ds_read_b128 v[56:59], v14 offset:16384
    ds_read_b128 v[72:75], v18 offset:24576
    ds_read_b128 v[60:63], v15 offset:16384
    ds_read_b128 v[76:79], v19 offset:24576
    s_waitcnt lgkmcnt(6)
    v_mfma_f32_32x32x16_bf16 v[32:47], v[48:51], v[64:67], v[32:47]
    s_waitcnt lgkmcnt(4)
    v_mfma_f32_32x32x16_bf16 v[32:47], v[52:55], v[68:71], v[32:47]
    s_waitcnt lgkmcnt(2)
    v_mfma_f32_32x32x16_bf16 v[32:47], v[56:59], v[72:75], v[32:47]
    s_waitcnt lgkmcnt(0)
    v_mfma_f32_32x32x16_bf16 v[32:47], v[60:63], v[76:79], v[32:47]
    s_waitcnt vmcnt(8)
    s_barrier
    s_add_u32 m0, s22, 16384
    s_nop 0
    buffer_load_dwordx4 v10, s[8:11], s20 offen lds
    s_add_u32 m0, s22, 17408
    s_nop 0
    buffer_load_dwordx4 v11, s[8:11], s20 offen lds
    s_add_u32 m0, s22, 24576
    s_nop 0
    buffer_load_dwordx4 v10, s[12:15], s21 offen lds
    s_add_u32 m0, s22, 25600
    s_nop 0
    buffer_load_dwordx4 v11, s[12:15], s21 offen lds
    s_add_u32 s20, s20, 128
    s_add_u32 s21, s21, 128
    ds_read_b128 v[48:51], v12 offset:32768
    ds_read_b128 v[64:67], v16 offset:40960
    ds_read_b128 v[52:55], v13 offset:32768
    ds_read_b128 v[68:71], v17 offset:40960
    ds_read_b128 v[56:59], v14 offset:32768
    ds_read_b128 v[72:75], v18 offset:40960
    ds_read_b128 v[60:63], v15 offset:32768
    ds_read_b128 v[76:79], v19 offset:40960
    s_waitcnt lgkmcnt(6)
    v_mfma_f32_32x32x16_bf16 v[32:47], v[48:51], v[64:67], v[32:47]
    s_waitcnt lgkmcnt(4)
    v_mfma_f32_32x32x16_bf16 v[32:47], v[52:55], v[68:71], v[32:47]
    s_waitcnt lgkmcnt(2)
    v_mfma_f32_32x32x16_bf16 v[32:47], v[56:59], v[72:75], v[32:47]
    s_waitcnt lgkmcnt(0)
    v_mfma_f32_32x32x16_bf16 v[32:47], v[60:63], v[76:79], v[32:47]
    s_waitcnt vmcnt(8)
    s_barrier
    s_add_u32 m0, s22, 32768
    s_nop 0
    buffer_load_dwordx4 v10, s[8:11], s20 offen lds
    s_add_u32 m0, s22, 33792
    s_nop 0
    buffer_load_dwordx4 v11, s[8:11], s20 offen lds
    s_add_u32 m0, s22, 40960
    s_nop 0
    buffer_load_dwordx4 v10, s[12:15], s21 offen lds
    s_add_u32 m0, s22, 41984
    s_nop 0
    buffer_load_dwordx4 v11, s[12:15], s21 offen lds
    s_add_u32 s20, s20, 128
    s_add_u32 s21, s21, 128
    ds_read_b128 v[48:51], v12 offset:49152
    ds_read_b128 v[64:67], v16 offset:57344
    ds_read_b128 v[52:55], v13 offset:49152
    ds_read_b128 v[68:71], v17 offset:57344
    ds_read_b128 v[56:59], v14 offset:49152
    ds_read_b128 v[72:75], v18 offset:57344
    ds_read_b128 v[60:63], v15 offset:49152
    ds_read_b128 v[76:79], v19 offset:57344
    s_waitcnt lgkmcnt(6)
    v_mfma_f32_32x32x16_bf16 v[32:47], v[48:51], v[64:67], v[32:47]
    s_waitcnt lgkmcnt(4)
    v_mfma_f32_32x32x16_bf16 v[32:47], v[52:55], v[68:71], v[32:47]
    s_waitcnt lgkmcnt(2)
    v_mfma_f32_32x32x16_bf16 v[32:47], v[56:59], v[72:75], v[32:47]
    s_waitcnt lgkmcnt(0)
    v_mfma_f32_32x32x16_bf16 v[32:47], v[60:63], v[76:79], v[32:47]
    s_waitcnt vmcnt(8)
    s_barrier
    s_add_u32 m0, s22, 49152
    s_nop 0
    buffer_load_dwordx4 v10, s[8:11], s20 offen lds
    s_add_u32 m0, s22, 50176
    s_nop 0
    buffer_load_dwordx4 v11, s[8:11], s20 offen lds
    s_add_u32 m0, s22, 57344
    s_nop 0
    buffer_load_dwordx4 v10, s[12:15], s21 offen lds
    s_add_u32 m0, s22, 58368
    s_nop 0
    buffer_load_dwordx4 v11, s[12:15], s21 offen lds
    s_add_u32 s20, s20, 128
    s_add_u32 s21, s21, 128
    ds_read_b128 v[48:51], v12 offset:0
    ds_read_b128 v[64:67], v16 offset:8192
    ds_read_b128 v[52:55], v13 offset:0
    ds_read_b128 v[68:71], v17 offset:8192
    ds_read_b128 v[56:59], v14 offset:0
    ds_read_b128 v[72:75], v18 offset:8192
    ds_read_b128 v[60:63], v15 offset:0
    ds_read_b128 v[76:79], v19 offset:8192
    s_waitcnt lgkmcnt(6)
    v_mfma_f32_32x32x16_bf16 v[32:47], v[48:51], v[64:67], v[32:47]
    s_waitcnt lgkmcnt(4)
    v_mfma_f32_32x32x16_bf16 v[32:47], v[52:55], v[68:71], v[32:47]
    s_waitcnt lgkmcnt(2)
    v_mfma_f32_32x32x16_bf16 v[32:47], v[56:59], v[72:75], v[32:47]
    s_waitcnt lgkmcnt(0)
    v_mfma_f32_32x32x16_bf16 v[32:47], v[60:63], v[76:79], v[32:47]
    s_waitcnt vmcnt(8)
    s_barrier
    s_add_u32 m0, s22, 0
    s_nop 0
    buffer_load_dwordx4 v10, s[8:11], s20 offen lds
    s_add_u32 m0, s22, 1024
    s_nop 0
    buffer_load_dwordx4 v11, s[8:11], s20 offen lds
    s_add_u32 m0, s22, 8192
    s_nop 0
    buffer_load_dwordx4 v10, s[12:15], s21 offen lds
    s_add_u32 m0, s22, 9216
    s_nop 0
    buffer_load_dwordx4 v11, s[12:15], s21 offen lds
    s_add_u32 s20, s20, 128
    s_add_u32 s21, s21, 128
    ds_read_b128 v[48:51], v12 offset:16384
    ds_read_b128 v[64:67], v16 offset:24576
    ds_read_b128 v[52:55], v13 offset:16384
    ds_read_b128 v[68:71], v17 offset:24576
    ds_read_b128 v[56:59], v14 offset:16384
    ds_read_b128 v[72:75], v18 offset:24576
    ds_read_b128 v[60:63], v15 offset:16384
    ds_read_b128 v[76:79], v19 offset:24576
    s_waitcnt lgkmcnt(6)
    v_mfma_f32_32x32x16_bf16 v[32:47], v[48:51], v[64:67], v[32:47]
    s_waitcnt lgkmcnt(4)
    v_mfma_f32_32x32x16_bf16 v[32:47], v[52:55], v[68:71], v[32:47]
    s_waitcnt lgkmcnt(2)
    v_mfma_f32_32x32x16_bf16 v[32:47], v[56:59], v[72:75], v[32:47]
    s_waitcnt lgkmcnt(0)
    v_mfma_f32_32x32x16_bf16 v[32:47], v[60:63], v[76:79], v[32:47]
    s_waitcnt vmcnt(8)
    s_barrier
    s_add_u32 m0, s22, 16384
    s_nop 0
    buffer_load_dwordx4 v10, s[8:11], s20 offen lds
    s_add_u32 m0, s22, 17408
    s_nop 0
    buffer_load_dwordx4 v11, s[8:11], s20 offen lds
    s_add_u32 m0, s22, 24576
    s_nop 0
    buffer_load_dwordx4 v10, s[12:15], s21 offen lds
    s_add_u32 m0, s22, 25600
    s_nop 0
    buffer_load_dwordx4 v11, s[12:15], s21 offen lds
    s_add_u32 s20, s20, 128
    s_add_u32 s21, s21, 128
    ds_read_b128 v[48:51], v12 offset:32768
    ds_read_b128 v[64:67], v16 offset:40960
    ds_read_b128 v[52:55], v13 offset:32768
    ds_read_b128 v[68:71], v17 offset:40960
    ds_read_b128 v[56:59], v14 offset:32768
    ds_read_b128 v[72:75], v18 offset:40960
    ds_read_b128 v[60:63], v15 offset:32768
    ds_read_b128 v[76:79], v19 offset:40960
    s_waitcnt lgkmcnt(6)
    v_mfma_f32_32x32x16_bf16 v[32:47], v[48:51], v[64:67], v[32:47]
    s_waitcnt lgkmcnt(4)
    v_mfma_f32_32x32x16_bf16 v[32:47], v[52:55], v[68:71], v[32:47]
    s_waitcnt lgkmcnt(2)
    v_mfma_f32_32x32x16_bf16 v[32:47], v[56:59], v[72:75], v[32:47]
    s_waitcnt lgkmcnt(0)
    v_mfma_f32_32x32x16_bf16 v[32:47], v[60:63], v[76:79], v[32:47]
    s_waitcnt vmcnt(8)
    s_barrier
    s_add_u32 m0, s22, 32768
    s_nop 0
    buffer_load_dwordx4 v10, s[8:11], s20 offen lds
    s_add_u32 m0, s22, 33792
    s_nop 0
    buffer_load_dwordx4 v11, s[8:11], s20 offen lds
    s_add_u32 m0, s22, 40960
    s_nop 0
    buffer_load_dwordx4 v10, s[12:15], s21 offen lds
    s_add_u32 m0, s22, 41984
    s_nop 0
    buffer_load_dwordx4 v11, s[12:15], s21 offen lds
    s_add_u32 s20, s20, 128
    s_add_u32 s21, s21, 128
    ds_read_b128 v[48:51], v12 offset:49152
    ds_read_b128 v[64:67], v16 offset:57344
    ds_read_b128 v[52:55], v13 offset:49152
    ds_read_b128 v[68:71], v17 offset:57344
    ds_read_b128 v[56:59], v14 offset:49152
    ds_read_b128 v[72:75], v18 offset:57344
    ds_read_b128 v[60:63], v15 offset:49152
    ds_read_b128 v[76:79], v19 offset:57344
    s_waitcnt lgkmcnt(6)
    v_mfma_f32_32x32x16_bf16 v[32:47], v[48:51], v[64:67], v[32:47]
    s_waitcnt lgkmcnt(4)
    v_mfma_f32_32x32x16_bf16 v[32:47], v[52:55], v[68:71], v[32:47]
    s_waitcnt lgkmcnt(2)
    v_mfma_f32_32x32x16_bf16 v[32:47], v[56:59], v[72:75], v[32:47]
    s_waitcnt lgkmcnt(0)
    v_mfma_f32_32x32x16_bf16 v[32:47], v[60:63], v[76:79], v[32:47]
    s_waitcnt vmcnt(8)
    s_barrier
    s_add_u32 m0, s22, 49152
    s_nop 0
    buffer_load_dwordx4 v10, s[8:11], s20 offen lds
    s_add_u32 m0, s22, 50176
    s_nop 0
    buffer_load_dwordx4 v11, s[8:11], s20 offen lds
    s_add_u32 m0, s22, 57344
    s_nop 0
    buffer_load_dwordx4 v10, s[12:15], s21 offen lds
    s_add_u32 m0, s22, 58368
    s_nop 0
    buffer_load_dwordx4 v11, s[12:15], s21 offen lds
    s_add_u32 s20, s20, 128
    s_add_u32 s21, s21, 128
    ds_read_b128 v[48:51], v12 offset:0
    ds_read_b128 v[64:67], v16 offset:8192
    ds_read_b128 v[52:55], v13 offset:0
    ds_read_b128 v[68:71], v17 offset:8192
    ds_read_b128 v[56:59], v14 offset:0
    ds_read_b128 v[72:75], v18 offset:8192
    ds_read_b128 v[60:63], v15 offset:0
    ds_read_b128 v[76:79], v19 offset:8192
    s_waitcnt lgkmcnt(6)
    v_mfma_f32_32x32x16_bf16 v[32:47], v[48:51], v[64:67], v[32:47]
    s_waitcnt lgkmcnt(4)
    v_mfma_f32_32x32x16_bf16 v[32:47], v[52:55], v[68:71], v[32:47]
    s_waitcnt lgkmcnt(2)
    v_mfma_f32_32x32x16_bf16 v[32:47], v[56:59], v[72:75], v[32:47]
    s_waitcnt lgkmcnt(0)
    v_mfma_f32_32x32x16_bf16 v[32:47], v[60:63], v[76:79], v[32:47]
    s_waitcnt vmcnt(8)
    s_barrier
    s_add_u32 m0, s22, 0
    s_nop 0
    buffer_load_dwordx4 v10, s[8:11], s20 offen lds
    s_add_u32 m0, s22, 1024
    s_nop 0
    buffer_load_dwordx4 v11, s[8:11], s20 offen lds
    s_add_u32 m0, s22, 8192
    s_nop 0
    buffer_load_dwordx4 v10, s[12:15], s21 offen lds
    s_add_u32 m0, s22, 9216
    s_nop 0
    buffer_load_dwordx4 v11, s[12:15], s21 offen lds
    s_add_u32 s20, s20, 128
    s_add_u32 s21, s21, 128
    ds_read_b128 v[48:51], v12 offset:16384
    ds_read_b128 v[64:67], v16 offset:24576
    ds_read_b128 v[52:55], v13 offset:16384
    ds_read_b128 v[68:71], v17 offset:24576
    ds_read_b128 v[56:59], v14 offset:16384
    ds_read_b128 v[72:75], v18 offset:24576
    ds_read_b128 v[60:63], v15 offset:16384
    ds_read_b128 v[76:79], v19 offset:24576
    s_waitcnt lgkmcnt(6)
    v_mfma_f32_32x32x16_bf16 v[32:47], v[48:51], v[64:67], v[32:47]
    s_waitcnt lgkmcnt(4)
    v_mfma_f32_32x32x16_bf16 v[32:47], v[52:55], v[68:71], v[32:47]
    s_waitcnt lgkmcnt(2)
    v_mfma_f32_32x32x16_bf16 v[32:47], v[56:59], v[72:75], v[32:47]
    s_waitcnt lgkmcnt(0)
    v_mfma_f32_32x32x16_bf16 v[32:47], v[60:63], v[76:79], v[32:47]
    s_waitcnt vmcnt(8)
    s_barrier
    s_add_u32 m0, s22, 16384
    s_nop 0
    buffer_load_dwordx4 v10, s[8:11], s20 offen lds
    s_add_u32 m0, s22, 17408
    s_nop 0
    buffer_load_dwordx4 v11, s[8:11], s20 offen lds
    s_add_u32 m0, s22, 24576
    s_nop 0
    buffer_load_dwordx4 v10, s[12:15], s21 offen lds
    s_add_u32 m0, s22, 25600
    s_nop 0
    buffer_load_dwordx4 v11, s[12:15], s21 offen lds
    s_add_u32 s20, s20, 128
    s_add_u32 s21, s21, 128
    ds_read_b128 v[48:51], v12 offset:32768
    ds_read_b128 v[64:67], v16 offset:40960
    ds_read_b128 v[52:55], v13 offset:32768
    ds_read_b128 v[68:71], v17 offset:40960
    ds_read_b128 v[56:59], v14 offset:32768
    ds_read_b128 v[72:75], v18 offset:40960
    ds_read_b128 v[60:63], v15 offset:32768
    ds_read_b128 v[76:79], v19 offset:40960
    s_waitcnt lgkmcnt(6)
    v_mfma_f32_32x32x16_bf16 v[32:47], v[48:51], v[64:67], v[32:47]
    s_waitcnt lgkmcnt(4)
    v_mfma_f32_32x32x16_bf16 v[32:47], v[52:55], v[68:71], v[32:47]
    s_waitcnt lgkmcnt(2)
    v_mfma_f32_32x32x16_bf16 v[32:47], v[56:59], v[72:75], v[32:47]
    s_waitcnt lgkmcnt(0)
    v_mfma_f32_32x32x16_bf16 v[32:47], v[60:63], v[76:79], v[32:47]
    s_waitcnt vmcnt(8)
    s_barrier
    s_add_u32 m0, s22, 32768
    s_nop 0
    buffer_load_dwordx4 v10, s[8:11], s20 offen lds
    s_add_u32 m0, s22, 33792
    s_nop 0
    buffer_load_dwordx4 v11, s[8:11], s20 offen lds
    s_add_u32 m0, s22, 40960
    s_nop 0
    buffer_load_dwordx4 v10, s[12:15], s21 offen lds
    s_add_u32 m0, s22, 41984
    s_nop 0
    buffer_load_dwordx4 v11, s[12:15], s21 offen lds
    s_add_u32 s20, s20, 128
    s_add_u32 s21, s21, 128
    ds_read_b128 v[48:51], v12 offset:49152
    ds_read_b128 v[64:67], v16 offset:57344
    ds_read_b128 v[52:55], v13 offset:49152
    ds_read_b128 v[68:71], v17 offset:57344
    ds_read_b128 v[56:59], v14 offset:49152
    ds_read_b128 v[72:75], v18 offset:57344
    ds_read_b128 v[60:63], v15 offset:49152
    ds_read_b128 v[76:79], v19 offset:57344
    s_waitcnt lgkmcnt(6)
    v_mfma_f32_32x32x16_bf16 v[32:47], v[48:51], v[64:67], v[32:47]
    s_waitcnt lgkmcnt(4)
    v_mfma_f32_32x32x16_bf16 v[32:47], v[52:55], v[68:71], v[32:47]
    s_waitcnt lgkmcnt(2)
    v_mfma_f32_32x32x16_bf16 v[32:47], v[56:59], v[72:75], v[32:47]
    s_waitcnt lgkmcnt(0)
    v_mfma_f32_32x32x16_bf16 v[32:47], v[60:63], v[76:79], v[32:47]
    s_waitcnt vmcnt(8)
    s_barrier
    s_add_u32 m0, s22, 49152
    s_nop 0
    buffer_load_dwordx4 v10, s[8:11], s20 offen lds
    s_add_u32 m0, s22, 50176
    s_nop 0
    buffer_load_dwordx4 v11, s[8:11], s20 offen lds
    s_add_u32 m0, s22, 57344
    s_nop 0
    buffer_load_dwordx4 v10, s[12:15], s21 offen lds
    s_add_u32 m0, s22, 58368
    s_nop 0
    buffer_load_dwordx4 v11, s[12:15], s21 offen lds
    s_add_u32 s20, s20, 128
    s_add_u32 s21, s21, 128
    ds_read_b128 v[48:51], v12 offset:0
    ds_read_b128 v[64:67], v16 offset:8192
    ds_read_b128 v[52:55], v13 offset:0
    ds_read_b128 v[68:71], v17 offset:8192
    ds_read_b128 v[56:59], v14 offset:0
    ds_read_b128 v[72:75], v18 offset:8192
    ds_read_b128 v[60:63], v15 offset:0
    ds_read_b128 v[76:79], v19 offset:8192
    s_waitcnt lgkmcnt(6)
    v_mfma_f32_32x32x16_bf16 v[32:47], v[48:51], v[64:67], v[32:47]
    s_waitcnt lgkmcnt(4)
    v_mfma_f32_32x32x16_bf16 v[32:47], v[52:55], v[68:71], v[32:47]
    s_waitcnt lgkmcnt(2)
    v_mfma_f32_32x32x16_bf16 v[32:47], v[56:59], v[72:75], v[32:47]
    s_waitcnt lgkmcnt(0)
    v_mfma_f32_32x32x16_bf16 v[32:47], v[60:63], v[76:79], v[32:47]
    s_waitcnt vmcnt(8)
    s_barrier
    s_add_u32 m0, s22, 0
    s_nop 0
    buffer_load_dwordx4 v10, s[8:11], s20 offen lds
    s_add_u32 m0, s22, 1024
    s_nop 0
    buffer_load_dwordx4 v11, s[8:11], s20 offen lds
    s_add_u32 m0, s22, 8192
    s_nop 0
    buffer_load_dwordx4 v10, s[12:15], s21 offen lds
    s_add_u32 m0, s22, 9216
    s_nop 0
    buffer_load_dwordx4 v11, s[12:15], s21 offen lds
    s_add_u32 s20, s20, 128
    s_add_u32 s21, s21, 128
    ds_read_b128 v[48:51], v12 offset:16384
    ds_read_b128 v[64:67], v16 offset:24576
    ds_read_b128 v[52:55], v13 offset:16384
    ds_read_b128 v[68:71], v17 offset:24576
    ds_read_b128 v[56:59], v14 offset:16384
    ds_read_b128 v[72:75], v18 offset:24576
    ds_read_b128 v[60:63], v15 offset:16384
    ds_read_b128 v[76:79], v19 offset:24576
    s_waitcnt lgkmcnt(6)
    v_mfma_f32_32x32x16_bf16 v[32:47], v[48:51], v[64:67], v[32:47]
    s_waitcnt lgkmcnt(4)
    v_mfma_f32_32x32x16_bf16 v[32:47], v[52:55], v[68:71], v[32:47]
    s_waitcnt lgkmcnt(2)
    v_mfma_f32_32x32x16_bf16 v[32:47], v[56:59], v[72:75], v[32:47]
    s_waitcnt lgkmcnt(0)
    v_mfma_f32_32x32x16_bf16 v[32:47], v[60:63], v[76:79], v[32:47]
    s_waitcnt vmcnt(8)
    s_barrier
    s_add_u32 m0, s22, 16384
    s_nop 0
    buffer_load_dwordx4 v10, s[8:11], s20 offen lds
    s_add_u32 m0, s22, 17408
    s_nop 0
    buffer_load_dwordx4 v11, s[8:11], s20 offen lds
    s_add_u32 m0, s22, 24576
    s_nop 0
    buffer_load_dwordx4 v10, s[12:15], s21 offen lds
    s_add_u32 m0, s22, 25600
    s_nop 0
    buffer_load_dwordx4 v11, s[12:15], s21 offen lds
    s_add_u32 s20, s20, 128
    s_add_u32 s21, s21, 128
    ds_read_b128 v[48:51], v12 offset:32768
    ds_read_b128 v[64:67], v16 offset:40960
    ds_read_b128 v[52:55], v13 offset:32768
    ds_read_b128 v[68:71], v17 offset:40960
    ds_read_b128 v[56:59], v14 offset:32768
    ds_read_b128 v[72:75], v18 offset:40960
    ds_read_b128 v[60:63], v15 offset:32768
    ds_read_b128 v[76:79], v19 offset:40960
    s_waitcnt lgkmcnt(6)
    v_mfma_f32_32x32x16_bf16 v[32:47], v[48:51], v[64:67], v[32:47]
    s_waitcnt lgkmcnt(4)
    v_mfma_f32_32x32x16_bf16 v[32:47], v[52:55], v[68:71], v[32:47]
    s_waitcnt lgkmcnt(2)
    v_mfma_f32_32x32x16_bf16 v[32:47], v[56:59], v[72:75], v[32:47]
    s_waitcnt lgkmcnt(0)
    v_mfma_f32_32x32x16_bf16 v[32:47], v[60:63], v[76:79], v[32:47]
    s_waitcnt vmcnt(8)
    s_barrier
    s_add_u32 m0, s22, 32768
    s_nop 0
    buffer_load_dwordx4 v10, s[8:11], s20 offen lds
    s_add_u32 m0, s22, 33792
    s_nop 0
    buffer_load_dwordx4 v11, s[8:11], s20 offen lds
    s_add_u32 m0, s22, 40960
    s_nop 0
    buffer_load_dwordx4 v10, s[12:15], s21 offen lds
    s_add_u32 m0, s22, 41984
    s_nop 0
    buffer_load_dwordx4 v11, s[12:15], s21 offen lds
    s_add_u32 s20, s20, 128
    s_add_u32 s21, s21, 128
    ds_read_b128 v[48:51], v12 offset:49152
    ds_read_b128 v[64:67], v16 offset:57344
    ds_read_b128 v[52:55], v13 offset:49152
    ds_read_b128 v[68:71], v17 offset:57344
    ds_read_b128 v[56:59], v14 offset:49152
    ds_read_b128 v[72:75], v18 offset:57344
    ds_read_b128 v[60:63], v15 offset:49152
    ds_read_b128 v[76:79], v19 offset:57344
    s_waitcnt lgkmcnt(6)
    v_mfma_f32_32x32x16_bf16 v[32:47], v[48:51], v[64:67], v[32:47]
    s_waitcnt lgkmcnt(4)
    v_mfma_f32_32x32x16_bf16 v[32:47], v[52:55], v[68:71], v[32:47]
    s_waitcnt lgkmcnt(2)
    v_mfma_f32_32x32x16_bf16 v[32:47], v[56:59], v[72:75], v[32:47]
    s_waitcnt lgkmcnt(0)
    v_mfma_f32_32x32x16_bf16 v[32:47], v[60:63], v[76:79], v[32:47]
    s_waitcnt vmcnt(8)
    s_barrier
    s_add_u32 m0, s22, 49152
    s_nop 0
    buffer_load_dwordx4 v10, s[8:11], s20 offen lds
    s_add_u32 m0, s22, 50176
    s_nop 0
    buffer_load_dwordx4 v11, s[8:11], s20 offen lds
    s_add_u32 m0, s22, 57344
    s_nop 0
    buffer_load_dwordx4 v10, s[12:15], s21 offen lds
    s_add_u32 m0, s22, 58368
    s_nop 0
    buffer_load_dwordx4 v11, s[12:15], s21 offen lds
    s_add_u32 s20, s20, 128
    s_add_u32 s21, s21, 128
    ds_read_b128 v[48:51], v12 offset:0
    ds_read_b128 v[64:67], v16 offset:8192
    ds_read_b128 v[52:55], v13 offset:0
    ds_read_b128 v[68:71], v17 offset:8192
    ds_read_b128 v[56:59], v14 offset:0
    ds_read_b128 v[72:75], v18 offset:8192
    ds_read_b128 v[60:63], v15 offset:0
    ds_read_b128 v[76:79], v19 offset:8192
    s_waitcnt lgkmcnt(6)
    v_mfma_f32_32x32x16_bf16 v[32:47], v[48:51], v[64:67], v[32:47]
    s_waitcnt lgkmcnt(4)
    v_mfma_f32_32x32x16_bf16 v[32:47], v[52:55], v[68:71], v[32:47]
    s_waitcnt lgkmcnt(2)
    v_mfma_f32_32x32x16_bf16 v[32:47], v[56:59], v[72:75], v[32:47]
    s_waitcnt lgkmcnt(0)
    v_mfma_f32_32x32x16_bf16 v[32:47], v[60:63], v[76:79], v[32:47]
    s_waitcnt vmcnt(8)
    s_barrier
    s_add_u32 m0, s22, 0
    s_nop 0
    buffer_load_dwordx4 v10, s[8:11], s20 offen lds
    s_add_u32 m0, s22, 1024
    s_nop 0
    buffer_load_dwordx4 v11, s[8:11], s20 offen lds
    s_add_u32 m0, s22, 8192
    s_nop 0
    buffer_load_dwordx4 v10, s[12:15], s21 offen lds
    s_add_u32 m0, s22, 9216
    s_nop 0
    buffer_load_dwordx4 v11, s[12:15], s21 offen lds
    s_add_u32 s20, s20, 128
    s_add_u32 s21, s21, 128
    ds_read_b128 v[48:51], v12 offset:16384
    ds_read_b128 v[64:67], v16 offset:24576
    ds_read_b128 v[52:55], v13 offset:16384
    ds_read_b128 v[68:71], v17 offset:24576
    ds_read_b128 v[56:59], v14 offset:16384
    ds_read_b128 v[72:75], v18 offset:24576
    ds_read_b128 v[60:63], v15 offset:16384
    ds_read_b128 v[76:79], v19 offset:24576
    s_waitcnt lgkmcnt(6)
    v_mfma_f32_32x32x16_bf16 v[32:47], v[48:51], v[64:67], v[32:47]
    s_waitcnt lgkmcnt(4)
    v_mfma_f32_32x32x16_bf16 v[32:47], v[52:55], v[68:71], v[32:47]
    s_waitcnt lgkmcnt(2)
    v_mfma_f32_32x32x16_bf16 v[32:47], v[56:59], v[72:75], v[32:47]
    s_waitcnt lgkmcnt(0)
    v_mfma_f32_32x32x16_bf16 v[32:47], v[60:63], v[76:79], v[32:47]
    s_waitcnt vmcnt(8)
    s_barrier
    s_add_u32 m0, s22, 16384
    s_nop 0
    buffer_load_dwordx4 v10, s[8:11], s20 offen lds
    s_add_u32 m0, s22, 17408
    s_nop 0
    buffer_load_dwordx4 v11, s[8:11], s20 offen lds
    s_add_u32 m0, s22, 24576
    s_nop 0
    buffer_load_dwordx4 v10, s[12:15], s21 offen lds
    s_add_u32 m0, s22, 25600
    s_nop 0
    buffer_load_dwordx4 v11, s[12:15], s21 offen lds
    s_add_u32 s20, s20, 128
    s_add_u32 s21, s21, 128
    ds_read_b128 v[48:51], v12 offset:32768
    ds_read_b128 v[64:67], v16 offset:40960
    ds_read_b128 v[52:55], v13 offset:32768
    ds_read_b128 v[68:71], v17 offset:40960
    ds_read_b128 v[56:59], v14 offset:32768
    ds_read_b128 v[72:75], v18 offset:40960
    ds_read_b128 v[60:63], v15 offset:32768
    ds_read_b128 v[76:79], v19 offset:40960
    s_waitcnt lgkmcnt(6)
    v_mfma_f32_32x32x16_bf16 v[32:47], v[48:51], v[64:67], v[32:47]
    s_waitcnt lgkmcnt(4)
    v_mfma_f32_32x32x16_bf16 v[32:47], v[52:55], v[68:71], v[32:47]
    s_waitcnt lgkmcnt(2)
    v_mfma_f32_32x32x16_bf16 v[32:47], v[56:59], v[72:75], v[32:47]
    s_waitcnt lgkmcnt(0)
    v_mfma_f32_32x32x16_bf16 v[32:47], v[60:63], v[76:79], v[32:47]
    s_waitcnt vmcnt(8)
    s_barrier
    s_add_u32 m0, s22, 32768
    s_nop 0
    buffer_load_dwordx4 v10, s[8:11], s20 offen lds
    s_add_u32 m0, s22, 33792
    s_nop 0
    buffer_load_dwordx4 v11, s[8:11], s20 offen lds
    s_add_u32 m0, s22, 40960
    s_nop 0
    buffer_load_dwordx4 v10, s[12:15], s21 offen lds
    s_add_u32 m0, s22, 41984
    s_nop 0
    buffer_load_dwordx4 v11, s[12:15], s21 offen lds
    s_add_u32 s20, s20, 128
    s_add_u32 s21, s21, 128
    ds_read_b128 v[48:51], v12 offset:49152
    ds_read_b128 v[64:67], v16 offset:57344
    ds_read_b128 v[52:55], v13 offset:49152
    ds_read_b128 v[68:71], v17 offset:57344
    ds_read_b128 v[56:59], v14 offset:49152
    ds_read_b128 v[72:75], v18 offset:57344
    ds_read_b128 v[60:63], v15 offset:49152
    ds_read_b128 v[76:79], v19 offset:57344
    s_waitcnt lgkmcnt(6)
    v_mfma_f32_32x32x16_bf16 v[32:47], v[48:51], v[64:67], v[32:47]
    s_waitcnt lgkmcnt(4)
    v_mfma_f32_32x32x16_bf16 v[32:47], v[52:55], v[68:71], v[32:47]
    s_waitcnt lgkmcnt(2)
    v_mfma_f32_32x32x16_bf16 v[32:47], v[56:59], v[72:75], v[32:47]
    s_waitcnt lgkmcnt(0)
    v_mfma_f32_32x32x16_bf16 v[32:47], v[60:63], v[76:79], v[32:47]
    s_waitcnt vmcnt(8)
    s_barrier
    s_add_u32 m0, s22, 49152
    s_nop 0
    buffer_load_dwordx4 v10, s[8:11], s20 offen lds
    s_add_u32 m0, s22, 50176
    s_nop 0
    buffer_load_dwordx4 v11, s[8:11], s20 offen lds
    s_add_u32 m0, s22, 57344
    s_nop 0
    buffer_load_dwordx4 v10, s[12:15], s21 offen lds
    s_add_u32 m0, s22, 58368
    s_nop 0
    buffer_load_dwordx4 v11, s[12:15], s21 offen lds
    s_add_u32 s20, s20, 128
    s_add_u32 s21, s21, 128
    ds_read_b128 v[48:51], v12 offset:0
    ds_read_b128 v[64:67], v16 offset:8192
    ds_read_b128 v[52:55], v13 offset:0
    ds_read_b128 v[68:71], v17 offset:8192
    ds_read_b128 v[56:59], v14 offset:0
    ds_read_b128 v[72:75], v18 offset:8192
    ds_read_b128 v[60:63], v15 offset:0
    ds_read_b128 v[76:79], v19 offset:8192
    s_waitcnt lgkmcnt(6)
    v_mfma_f32_32x32x16_bf16 v[32:47], v[48:51], v[64:67], v[32:47]
    s_waitcnt lgkmcnt(4)
    v_mfma_f32_32x32x16_bf16 v[32:47], v[52:55], v[68:71], v[32:47]
    s_waitcnt lgkmcnt(2)
    v_mfma_f32_32x32x16_bf16 v[32:47], v[56:59], v[72:75], v[32:47]
    s_waitcnt lgkmcnt(0)
    v_mfma_f32_32x32x16_bf16 v[32:47], v[60:63], v[76:79], v[32:47]
    s_waitcnt vmcnt(8)
    s_barrier
    ds_read_b128 v[48:51], v12 offset:16384
    ds_read_b128 v[64:67], v16 offset:24576
    ds_read_b128 v[52:55], v13 offset:16384
    ds_read_b128 v[68:71], v17 offset:24576
    ds_read_b128 v[56:59], v14 offset:16384
    ds_read_b128 v[72:75], v18 offset:24576
    ds_read_b128 v[60:63], v15 offset:16384
    ds_read_b128 v[76:79], v19 offset:24576
    s_waitcnt lgkmcnt(6)
    v_mfma_f32_32x32x16_bf16 v[32:47], v[48:51], v[64:67], v[32:47]
    s_waitcnt lgkmcnt(4)
    v_mfma_f32_32x32x16_bf16 v[32:47], v[52:55], v[68:71], v[32:47]
    s_waitcnt lgkmcnt(2)
    v_mfma_f32_32x32x16_bf16 v[32:47], v[56:59], v[72:75], v[32:47]
    s_waitcnt lgkmcnt(0)
    v_mfma_f32_32x32x16_bf16 v[32:47], v[60:63], v[76:79], v[32:47]
    s_waitcnt vmcnt(4)
    s_barrier
    ds_read_b128 v[48:51], v12 offset:32768
    ds_read_b128 v[64:67], v16 offset:40960
    ds_read_b128 v[52:55], v13 offset:32768
    ds_read_b128 v[68:71], v17 offset:40960
    ds_read_b128 v[56:59], v14 offset:32768
    ds_read_b128 v[72:75], v18 offset:40960
    ds_read_b128 v[60:63], v15 offset:32768
    ds_read_b128 v[76:79], v19 offset:40960
    s_waitcnt lgkmcnt(6)
    v_mfma_f32_32x32x16_bf16 v[32:47], v[48:51], v[64:67], v[32:47]
    s_waitcnt lgkmcnt(4)
    v_mfma_f32_32x32x16_bf16 v[32:47], v[52:55], v[68:71], v[32:47]
    s_waitcnt lgkmcnt(2)
    v_mfma_f32_32x32x16_bf16 v[32:47], v[56:59], v[72:75], v[32:47]
    s_waitcnt lgkmcnt(0)
    v_mfma_f32_32x32x16_bf16 v[32:47], v[60:63], v[76:79], v[32:47]
    s_waitcnt vmcnt(0)
    s_barrier
    ds_read_b128 v[48:51], v12 offset:49152
    ds_read_b128 v[64:67], v16 offset:57344
    ds_read_b128 v[52:55], v13 offset:49152
    ds_read_b128 v[68:71], v17 offset:57344
    ds_read_b128 v[56:59], v14 offset:49152
    ds_read_b128 v[72:75], v18 offset:57344
    ds_read_b128 v[60:63], v15 offset:49152
    ds_read_b128 v[76:79], v19 offset:57344
    s_waitcnt lgkmcnt(6)
    v_mfma_f32_32x32x16_bf16 v[32:47], v[48:51], v[64:67], v[32:47]
    s_waitcnt lgkmcnt(4)
    v_mfma_f32_32x32x16_bf16 v[32:47], v[52:55], v[68:71], v[32:47]
    s_waitcnt lgkmcnt(2)
    v_mfma_f32_32x32x16_bf16 v[32:47], v[56:59], v[72:75], v[32:47]
    s_waitcnt lgkmcnt(0)
    v_mfma_f32_32x32x16_bf16 v[32:47], v[60:63], v[76:79], v[32:47]
    s_load_dwordx2 s[24:25], s[0:1], 72
    s_waitcnt lgkmcnt(0)
    s_mov_b32 s28, s24
    s_mov_b32 s29, s25
    s_mov_b32 s30, 0xc00
    s_mov_b32 s31, 0x00020000
    s_add_u32 s32, s4, 0xba0000
    s_addc_u32 s33, s5, 0
    s_mov_b32 s34, 0x1e0000
    s_mov_b32 s35, 0x00020000
    s_lshl_b32 s26, s17, 6
    v_lshl_add_u32 v80, v6, 5, v3
    v_add_u32 v80, s26, v80
    v_lshlrev_b32 v81, 1, v80
    buffer_load_ushort v82, v81, s[28:31], 0 offen
    s_lshl_b32 s27, s16, 6
    v_lshl_add_u32 v83, v5, 5, s27
    v_lshl_add_u32 v83, v4, 2, v83
    v_mul_u32_u24 v83, 3072, v83
    v_add_u32 v83, v83, v81
    s_waitcnt vmcnt(0)
    v_lshlrev_b32 v82, 16, v82
    v_mov_b32 v84, 0x3f4c422a
    v_mov_b32 v85, 0x3d372713
    v_mov_b32 v86, 0xc038aa3b
    v_cvt_pk_bf16_f32 v32, v32, v32
    v_lshlrev_b32 v32, 16, v32
    v_cvt_pk_bf16_f32 v33, v33, v33
    v_lshlrev_b32 v33, 16, v33
    v_cvt_pk_bf16_f32 v34, v34, v34
    v_lshlrev_b32 v34, 16, v34
    v_cvt_pk_bf16_f32 v35, v35, v35
    v_lshlrev_b32 v35, 16, v35
    v_cvt_pk_bf16_f32 v36, v36, v36
    v_lshlrev_b32 v36, 16, v36
    v_cvt_pk_bf16_f32 v37, v37, v37
    v_lshlrev_b32 v37, 16, v37
    v_cvt_pk_bf16_f32 v38, v38, v38
    v_lshlrev_b32 v38, 16, v38
    v_cvt_pk_bf16_f32 v39, v39, v39
    v_lshlrev_b32 v39, 16, v39
    v_cvt_pk_bf16_f32 v40, v40, v40
    v_lshlrev_b32 v40, 16, v40
    v_cvt_pk_bf16_f32 v41, v41, v41
    v_lshlrev_b32 v41, 16, v41
    v_cvt_pk_bf16_f32 v42, v42, v42
    v_lshlrev_b32 v42, 16, v42
    v_cvt_pk_bf16_f32 v43, v43, v43
    v_lshlrev_b32 v43, 16, v43
    v_cvt_pk_bf16_f32 v44, v44, v44
    v_lshlrev_b32 v44, 16, v44
    v_cvt_pk_bf16_f32 v45, v45, v45
    v_lshlrev_b32 v45, 16, v45
    v_cvt_pk_bf16_f32 v46, v46, v46
    v_lshlrev_b32 v46, 16, v46
    v_cvt_pk_bf16_f32 v47, v47, v47
    v_lshlrev_b32 v47, 16, v47
    v_add_f32 v32, v32, v82
    v_add_f32 v33, v33, v82
    v_add_f32 v34, v34, v82
    v_add_f32 v35, v35, v82
    v_add_f32 v36, v36, v82
    v_add_f32 v37, v37, v82
    v_add_f32 v38, v38, v82
    v_add_f32 v39, v39, v82
    v_add_f32 v40, v40, v82
    v_add_f32 v41, v41, v82
    v_add_f32 v42, v42, v82
    v_add_f32 v43, v43, v82
    v_add_f32 v44, v44, v82
    v_add_f32 v45, v45, v82
    v_add_f32 v46, v46, v82
    v_add_f32 v47, v47, v82
    v_cvt_pk_bf16_f32 v32, v32, v32
    v_lshlrev_b32 v32, 16, v32
    v_cvt_pk_bf16_f32 v33, v33, v33
    v_lshlrev_b32 v33, 16, v33
    v_cvt_pk_bf16_f32 v34, v34, v34
    v_lshlrev_b32 v34, 16, v34
    v_cvt_pk_bf16_f32 v35, v35, v35
    v_lshlrev_b32 v35, 16, v35
    v_cvt_pk_bf16_f32 v36, v36, v36
    v_lshlrev_b32 v36, 16, v36
    v_cvt_pk_bf16_f32 v37, v37, v37
    v_lshlrev_b32 v37, 16, v37
    v_cvt_pk_bf16_f32 v38, v38, v38
    v_lshlrev_b32 v38, 16, v38
    v_cvt_pk_bf16_f32 v39, v39, v39
    v_lshlrev_b32 v39, 16, v39
    v_cvt_pk_bf16_f32 v40, v40, v40
    v_lshlrev_b32 v40, 16, v40
    v_cvt_pk_bf16_f32 v41, v41, v41
    v_lshlrev_b32 v41, 16, v41
    v_cvt_pk_bf16_f32 v42, v42, v42
    v_lshlrev_b32 v42, 16, v42
    v_cvt_pk_bf16_f32 v43, v43, v43
    v_lshlrev_b32 v43, 16, v43
    v_cvt_pk_bf16_f32 v44, v44, v44
    v_lshlrev_b32 v44, 16, v44
    v_cvt_pk_bf16_f32 v45, v45, v45
    v_lshlrev_b32 v45, 16, v45
    v_cvt_pk_bf16_f32 v46, v46, v46
    v_lshlrev_b32 v46, 16, v46
    v_cvt_pk_bf16_f32 v47, v47, v47
    v_lshlrev_b32 v47, 16, v47
    v_mul_f32 v90, v32, v32
    v_mul_f32 v90, v90, v32
    v_fma_f32 v90, v90, v85, v32
    v_mul_f32 v90, v90, v84
    v_mul_f32 v90, v90, v86
    v_mul_f32 v91, v33, v33
    v_mul_f32 v91, v91, v33
    v_fma_f32 v91, v91, v85, v33
    v_mul_f32 v91, v91, v84
    v_mul_f32 v91, v91, v86
    v_mul_f32 v92, v34, v34
    v_mul_f32 v92, v92, v34
    v_fma_f32 v92, v92, v85, v34
    v_mul_f32 v92, v92, v84
    v_mul_f32 v92, v92, v86
    v_mul_f32 v93, v35, v35
    v_mul_f32 v93, v93, v35
    v_fma_f32 v93, v93, v85, v35
    v_mul_f32 v93, v93, v84
    v_mul_f32 v93, v93, v86
    v_mul_f32 v94, v36, v36
    v_mul_f32 v94, v94, v36
    v_fma_f32 v94, v94, v85, v36
    v_mul_f32 v94, v94, v84
    v_mul_f32 v94, v94, v86
    v_mul_f32 v95, v37, v37
    v_mul_f32 v95, v95, v37
    v_fma_f32 v95, v95, v85, v37
    v_mul_f32 v95, v95, v84
    v_mul_f32 v95, v95, v86
    v_mul_f32 v96, v38, v38
    v_mul_f32 v96, v96, v38
    v_fma_f32 v96, v96, v85, v38
    v_mul_f32 v96, v96, v84
    v_mul_f32 v96, v96, v86
    v_mul_f32 v97, v39, v39
    v_mul_f32 v97, v97, v39
    v_fma_f32 v97, v97, v85, v39
    v_mul_f32 v97, v97, v84
    v_mul_f32 v97, v97, v86
    v_mul_f32 v98, v40, v40
    v_mul_f32 v98, v98, v40
    v_fma_f32 v98, v98, v85, v40
    v_mul_f32 v98, v98, v84
    v_mul_f32 v98, v98, v86
    v_mul_f32 v99, v41, v41
    v_mul_f32 v99, v99, v41
    v_fma_f32 v99, v99, v85, v41
    v_mul_f32 v99, v99, v84
    v_mul_f32 v99, v99, v86
    v_mul_f32 v100, v42, v42
    v_mul_f32 v100, v100, v42
    v_fma_f32 v100, v100, v85, v42
    v_mul_f32 v100, v100, v84
    v_mul_f32 v100, v100, v86
    v_mul_f32 v101, v43, v43
    v_mul_f32 v101, v101, v43
    v_fma_f32 v101, v101, v85, v43
    v_mul_f32 v101, v101, v84
    v_mul_f32 v101, v101, v86
    v_mul_f32 v102, v44, v44
    v_mul_f32 v102, v102, v44
    v_fma_f32 v102, v102, v85, v44
    v_mul_f32 v102, v102, v84
    v_mul_f32 v102, v102, v86
    v_mul_f32 v103, v45, v45
    v_mul_f32 v103, v103, v45
    v_fma_f32 v103, v103, v85, v45
    v_mul_f32 v103, v103, v84
    v_mul_f32 v103, v103, v86
    v_mul_f32 v104, v46, v46
    v_mul_f32 v104, v104, v46
    v_fma_f32 v104, v104, v85, v46
    v_mul_f32 v104, v104, v84
    v_mul_f32 v104, v104, v86
    v_mul_f32 v105, v47, v47
    v_mul_f32 v105, v105, v47
    v_fma_f32 v105, v105, v85, v47
    v_mul_f32 v105, v105, v84
    v_mul_f32 v105, v105, v86
    v_exp_f32 v90, v90
    v_exp_f32 v91, v91
    v_exp_f32 v92, v92
    v_exp_f32 v93, v93
    v_exp_f32 v94, v94
    v_exp_f32 v95, v95
    v_exp_f32 v96, v96
    v_exp_f32 v97, v97
    v_exp_f32 v98, v98
    v_exp_f32 v99, v99
    v_exp_f32 v100, v100
    v_exp_f32 v101, v101
    v_exp_f32 v102, v102
    v_exp_f32 v103, v103
    v_exp_f32 v104, v104
    v_exp_f32 v105, v105
    s_nop 0
    v_add_f32 v90, 1.0, v90
    v_add_f32 v91, 1.0, v91
    v_add_f32 v92, 1.0, v92
    v_add_f32 v93, 1.0, v93
    v_add_f32 v94, 1.0, v94
    v_add_f32 v95, 1.0, v95
    v_add_f32 v96, 1.0, v96
    v_add_f32 v97, 1.0, v97
    v_add_f32 v98, 1.0, v98
    v_add_f32 v99, 1.0, v99
    v_add_f32 v100, 1.0, v100
    v_add_f32 v101, 1.0, v101
    v_add_f32 v102, 1.0, v102
    v_add_f32 v103, 1.0, v103
    v_add_f32 v104, 1.0, v104
    v_add_f32 v105, 1.0, v105
    v_rcp_f32 v90, v90
    v_rcp_f32 v91, v91
    v_rcp_f32 v92, v92
    v_rcp_f32 v93, v93
    v_rcp_f32 v94, v94
    v_rcp_f32 v95, v95
    v_rcp_f32 v96, v96
    v_rcp_f32 v97, v97
    v_rcp_f32 v98, v98
    v_rcp_f32 v99, v99
    v_rcp_f32 v100, v100
    v_rcp_f32 v101, v101
    v_rcp_f32 v102, v102
    v_rcp_f32 v103, v103
    v_rcp_f32 v104, v104
    v_rcp_f32 v105, v105
    s_nop 0
    v_mul_f32 v90, v90, v32
    v_mul_f32 v91, v91, v33
    v_mul_f32 v92, v92, v34
    v_mul_f32 v93, v93, v35
    v_mul_f32 v94, v94, v36
    v_mul_f32 v95, v95, v37
    v_mul_f32 v96, v96, v38
    v_mul_f32 v97, v97, v39
    v_mul_f32 v98, v98, v40
    v_mul_f32 v99, v99, v41
    v_mul_f32 v100, v100, v42
    v_mul_f32 v101, v101, v43
    v_mul_f32 v102, v102, v44
    v_mul_f32 v103, v103, v45
    v_mul_f32 v104, v104, v46
    v_mul_f32 v105, v105, v47
    v_cvt_pk_bf16_f32 v90, v90, v90
    buffer_store_short v90, v83, s[32:35], 0 offen offset:0
    v_cvt_pk_bf16_f32 v91, v91, v91
    buffer_store_short v91, v83, s[32:35], 0 offen offset:3072
    v_cvt_pk_bf16_f32 v92, v92, v92
    v_add_u32 v87, 6144, v83
    buffer_store_short v92, v87, s[32:35], 0 offen
    v_cvt_pk_bf16_f32 v93, v93, v93
    v_add_u32 v87, 9216, v83
    buffer_store_short v93, v87, s[32:35], 0 offen
    v_cvt_pk_bf16_f32 v94, v94, v94
    v_add_u32 v87, 24576, v83
    buffer_store_short v94, v87, s[32:35], 0 offen
    v_cvt_pk_bf16_f32 v95, v95, v95
    v_add_u32 v87, 27648, v83
    buffer_store_short v95, v87, s[32:35], 0 offen
    v_cvt_pk_bf16_f32 v96, v96, v96
    v_add_u32 v87, 30720, v83
    buffer_store_short v96, v87, s[32:35], 0 offen
    v_cvt_pk_bf16_f32 v97, v97, v97
    v_add_u32 v87, 33792, v83
    buffer_store_short v97, v87, s[32:35], 0 offen
    v_cvt_pk_bf16_f32 v98, v98, v98
    v_add_u32 v87, 49152, v83
    buffer_store_short v98, v87, s[32:35], 0 offen
    v_cvt_pk_bf16_f32 v99, v99, v99
    v_add_u32 v87, 52224, v83
    buffer_store_short v99, v87, s[32:35], 0 offen
    v_cvt_pk_bf16_f32 v100, v100, v100
    v_add_u32 v87, 55296, v83
    buffer_store_short v100, v87, s[32:35], 0 offen
    v_cvt_pk_bf16_f32 v101, v101, v101
    v_add_u32 v87, 58368, v83
    buffer_store_short v101, v87, s[32:35], 0 offen
    v_cvt_pk_bf16_f32 v102, v102, v102
    v_add_u32 v87, 73728, v83
    buffer_store_short v102, v87, s[32:35], 0 offen
    v_cvt_pk_bf16_f32 v103, v103, v103
    v_add_u32 v87, 76800, v83
    buffer_store_short v103, v87, s[32:35], 0 offen
    v_cvt_pk_bf16_f32 v104, v104, v104
    v_add_u32 v87, 79872, v83
    buffer_store_short v104, v87, s[32:35], 0 offen
    v_cvt_pk_bf16_f32 v105, v105, v105
    v_add_u32 v87, 82944, v83
    buffer_store_short v105, v87, s[32:35], 0 offen
L_end_27:
    s_endpgm
.text
.globl gemm2_kernel
.p2align 8
.type gemm2_kernel,@function
gemm2_kernel:
    s_cmp_ge_u32 s2, 320
    s_cbranch_scc1 L_end_28
    s_load_dwordx2 s[4:5], s[0:1], 112
    s_waitcnt lgkmcnt(0)
    s_add_u32 s8, s4, 0xba0000
    s_addc_u32 s9, s5, 0
    s_mov_b32 s10, 0x1e0000
    s_mov_b32 s11, 0x00020000
    s_add_u32 s12, s4, 0x1380000
    s_addc_u32 s13, s5, 0
    s_mov_b32 s14, 0x600000
    s_mov_b32 s15, 0x00020000
    s_lshr_b32 s16, s2, 5
    s_and_b32 s17, s2, 31
    v_and_b32 v1, 63, v0
    v_lshrrev_b32 v2, 6, v0
    s_nop 0
    v_readfirstlane_b32 s18, v2
    v_lshrrev_b32 v3, 3, v1
    v_lshl_add_u32 v3, v2, 4, v3
    v_and_b32 v4, 7, v1
    v_add_u32 v5, 0, v3
    v_lshrrev_b32 v6, 1, v5
    v_and_b32 v6, 7, v6
    v_xor_b32 v6, v6, v4
    v_mul_u32_u24 v10, 3072, v5
    v_lshl_add_u32 v10, v6, 4, v10
    v_add_u32 v5, 8, v3
    v_lshrrev_b32 v6, 1, v5
    v_and_b32 v6, 7, v6
    v_xor_b32 v6, v6, v4
    v_mul_u32_u24 v11, 3072, v5
    v_lshl_add_u32 v11, v6, 4, v11
    s_mul_i32 s20, s16, 196608
    s_mul_i32 s21, s17, 196608
    v_and_b32 v3, 31, v1
    v_lshrrev_b32 v4, 5, v1
    v_lshrrev_b32 v5, 1, v2
    v_and_b32 v6, 1, v2
    v_lshl_add_u32 v7, v5, 5, v3
    v_lshrrev_b32 v8, 1, v7
    v_and_b32 v8, 7, v8
    v_add_u32 v9, 0, v4
    v_xor_b32 v9, v9, v8
    v_lshl_add_u32 v9, v7, 3, v9
    v_lshlrev_b32 v12, 4, v9
    v_add_u32 v9, 2, v4
    v_xor_b32 v9, v9, v8
    v_lshl_add_u32 v9, v7, 3, v9
    v_lshlrev_b32 v13, 4, v9
    v_add_u32 v9, 4, v4
    v_xor_b32 v9, v9, v8
    v_lshl_add_u32 v9, v7, 3, v9
    v_lshlrev_b32 v14, 4, v9
    v_add_u32 v9, 6, v4
    v_xor_b32 v9, v9, v8
    v_lshl_add_u32 v9, v7, 3, v9
    v_lshlrev_b32 v15, 4, v9
    v_lshl_add_u32 v7, v6, 5, v3
    v_lshrrev_b32 v8, 1, v7
    v_and_b32 v8, 7, v8
    v_add_u32 v9, 0, v4
    v_xor_b32 v9, v9, v8
    v_lshl_add_u32 v9, v7, 3, v9
    v_lshlrev_b32 v16, 4, v9
    v_add_u32 v9, 2, v4
    v_xor_b32 v9, v9, v8
    v_lshl_add_u32 v9, v7, 3, v9
    v_lshlrev_b32 v17, 4, v9
    v_add_u32 v9, 4, v4
    v_xor_b32 v9, v9, v8
    v_lshl_add_u32 v9, v7, 3, v9
    v_lshlrev_b32 v18, 4, v9
    v_add_u32 v9, 6, v4
    v_xor_b32 v9, v9, v8
    v_lshl_add_u32 v9, v7, 3, v9
    v_lshlrev_b32 v19, 4, v9
    v_mov_b32 v32, 0
    v_mov_b32 v33, 0
    v_mov_b32 v34, 0
    v_mov_b32 v35, 0
    v_mov_b32 v36, 0
    v_mov_b32 v37, 0
    v_mov_b32 v38, 0
    v_mov_b32 v39, 0
    v_mov_b32 v40, 0
    v_mov_b32 v41, 0
    v_mov_b32 v42, 0
    v_mov_b32 v43, 0
    v_mov_b32 v44, 0
    v_mov_b32 v45, 0
    v_mov_b32 v46, 0
    v_mov_b32 v47, 0
    s_lshl_b32 s22, s18, 11
    s_add_u32 m0, s22, 0
    s_nop 0
    buffer_load_dwordx4 v10, s[8:11], s20 offen lds
    s_add_u32 m0, s22, 1024
    s_nop 0
    buffer_load_dwordx4 v11, s[8:11], s20 offen lds
    s_add_u32 m0, s22, 8192
    s_nop 0
    buffer_load_dwordx4 v10, s[12:15], s21 offen lds
    s_add_u32 m0, s22, 9216
    s_nop 0
    buffer_load_dwordx4 v11, s[12:15], s21 offen lds
    s_add_u32 s20, s20, 128
    s_add_u32 s21, s21, 128
    s_add_u32 m0, s22, 16384
    s_nop 0
    buffer_load_dwordx4 v10, s[8:11], s20 offen lds
    s_add_u32 m0, s22, 17408
    s_nop 0
    buffer_load_dwordx4 v11, s[8:11], s20 offen lds
    s_add_u32 m0, s22, 24576
    s_nop 0
    buffer_load_dwordx4 v10, s[12:15], s21 offen lds
    s_add_u32 m0, s22, 25600
    s_nop 0
    buffer_load_dwordx4 v11, s[12:15], s21 offen lds
    s_add_u32 s20, s20, 128
    s_add_u32 s21, s21, 128
    s_add_u32 m0, s22, 32768
    s_nop 0
    buffer_load_dwordx4 v10, s[8:11], s20 offen lds
    s_add_u32 m0, s22, 33792
    s_nop 0
    buffer_load_dwordx4 v11, s[8:11], s20 offen lds
    s_add_u32 m0, s22, 40960
    s_nop 0
    buffer_load_dwordx4 v10, s[12:15], s21 offen lds
    s_add_u32 m0, s22, 41984
    s_nop 0
    buffer_load_dwordx4 v11, s[12:15], s21 offen lds
    s_add_u32 s20, s20, 128
    s_add_u32 s21, s21, 128
    s_waitcnt vmcnt(8)
    s_barrier
    s_add_u32 m0, s22, 49152
    s_nop 0
    buffer_load_dwordx4 v10, s[8:11], s20 offen lds
    s_add_u32 m0, s22, 50176
    s_nop 0
    buffer_load_dwordx4 v11, s[8:11], s20 offen lds
    s_add_u32 m0, s22, 57344
    s_nop 0
    buffer_load_dwordx4 v10, s[12:15], s21 offen lds
    s_add_u32 m0, s22, 58368
    s_nop 0
    buffer_load_dwordx4 v11, s[12:15], s21 offen lds
    s_add_u32 s20, s20, 128
    s_add_u32 s21, s21, 128
    ds_read_b128 v[48:51], v12 offset:0
    ds_read_b128 v[64:67], v16 offset:8192
    ds_read_b128 v[52:55], v13 offset:0
    ds_read_b128 v[68:71], v17 offset:8192
    ds_read_b128 v[56:59], v14 offset:0
    ds_read_b128 v[72:75], v18 offset:8192
    ds_read_b128 v[60:63], v15 offset:0
    ds_read_b128 v[76:79], v19 offset:8192
    s_waitcnt lgkmcnt(6)
    v_mfma_f32_32x32x16_bf16 v[32:47], v[48:51], v[64:67], v[32:47]
    s_waitcnt lgkmcnt(4)
    v_mfma_f32_32x32x16_bf16 v[32:47], v[52:55], v[68:71], v[32:47]
    s_waitcnt lgkmcnt(2)
    v_mfma_f32_32x32x16_bf16 v[32:47], v[56:59], v[72:75], v[32:47]
    s_waitcnt lgkmcnt(0)
    v_mfma_f32_32x32x16_bf16 v[32:47], v[60:63], v[76:79], v[32:47]
    s_waitcnt vmcnt(8)
    s_barrier
    s_add_u32 m0, s22, 0
    s_nop 0
    buffer_load_dwordx4 v10, s[8:11], s20 offen lds
    s_add_u32 m0, s22, 1024
    s_nop 0
    buffer_load_dwordx4 v11, s[8:11], s20 offen lds
    s_add_u32 m0, s22, 8192
    s_nop 0
    buffer_load_dwordx4 v10, s[12:15], s21 offen lds
    s_add_u32 m0, s22, 9216
    s_nop 0
    buffer_load_dwordx4 v11, s[12:15], s21 offen lds
    s_add_u32 s20, s20, 128
    s_add_u32 s21, s21, 128
    ds_read_b128 v[48:51], v12 offset:16384
    ds_read_b128 v[64:67], v16 offset:24576
    ds_read_b128 v[52:55], v13 offset:16384
    ds_read_b128 v[68:71], v17 offset:24576
    ds_read_b128 v[56:59], v14 offset:16384
    ds_read_b128 v[72:75], v18 offset:24576
    ds_read_b128 v[60:63], v15 offset:16384
    ds_read_b128 v[76:79], v19 offset:24576
    s_waitcnt lgkmcnt(6)
    v_mfma_f32_32x32x16_bf16 v[32:47], v[48:51], v[64:67], v[32:47]
    s_waitcnt lgkmcnt(4)
    v_mfma_f32_32x32x16_bf16 v[32:47], v[52:55], v[68:71], v[32:47]
    s_waitcnt lgkmcnt(2)
    v_mfma_f32_32x32x16_bf16 v[32:47], v[56:59], v[72:75], v[32:47]
    s_waitcnt lgkmcnt(0)
    v_mfma_f32_32x32x16_bf16 v[32:47], v[60:63], v[76:79], v[32:47]
    s_waitcnt vmcnt(8)
    s_barrier
    s_add_u32 m0, s22, 16384
    s_nop 0
    buffer_load_dwordx4 v10, s[8:11], s20 offen lds
    s_add_u32 m0, s22, 17408
    s_nop 0
    buffer_load_dwordx4 v11, s[8:11], s20 offen lds
    s_add_u32 m0, s22, 24576
    s_nop 0
    buffer_load_dwordx4 v10, s[12:15], s21 offen lds
    s_add_u32 m0, s22, 25600
    s_nop 0
    buffer_load_dwordx4 v11, s[12:15], s21 offen lds
    s_add_u32 s20, s20, 128
    s_add_u32 s21, s21, 128
    ds_read_b128 v[48:51], v12 offset:32768
    ds_read_b128 v[64:67], v16 offset:40960
    ds_read_b128 v[52:55], v13 offset:32768
    ds_read_b128 v[68:71], v17 offset:40960
    ds_read_b128 v[56:59], v14 offset:32768
    ds_read_b128 v[72:75], v18 offset:40960
    ds_read_b128 v[60:63], v15 offset:32768
    ds_read_b128 v[76:79], v19 offset:40960
    s_waitcnt lgkmcnt(6)
    v_mfma_f32_32x32x16_bf16 v[32:47], v[48:51], v[64:67], v[32:47]
    s_waitcnt lgkmcnt(4)
    v_mfma_f32_32x32x16_bf16 v[32:47], v[52:55], v[68:71], v[32:47]
    s_waitcnt lgkmcnt(2)
    v_mfma_f32_32x32x16_bf16 v[32:47], v[56:59], v[72:75], v[32:47]
    s_waitcnt lgkmcnt(0)
    v_mfma_f32_32x32x16_bf16 v[32:47], v[60:63], v[76:79], v[32:47]
    s_waitcnt vmcnt(8)
    s_barrier
    s_add_u32 m0, s22, 32768
    s_nop 0
    buffer_load_dwordx4 v10, s[8:11], s20 offen lds
    s_add_u32 m0, s22, 33792
    s_nop 0
    buffer_load_dwordx4 v11, s[8:11], s20 offen lds
    s_add_u32 m0, s22, 40960
    s_nop 0
    buffer_load_dwordx4 v10, s[12:15], s21 offen lds
    s_add_u32 m0, s22, 41984
    s_nop 0
    buffer_load_dwordx4 v11, s[12:15], s21 offen lds
    s_add_u32 s20, s20, 128
    s_add_u32 s21, s21, 128
    ds_read_b128 v[48:51], v12 offset:49152
    ds_read_b128 v[64:67], v16 offset:57344
    ds_read_b128 v[52:55], v13 offset:49152
    ds_read_b128 v[68:71], v17 offset:57344
    ds_read_b128 v[56:59], v14 offset:49152
    ds_read_b128 v[72:75], v18 offset:57344
    ds_read_b128 v[60:63], v15 offset:49152
    ds_read_b128 v[76:79], v19 offset:57344
    s_waitcnt lgkmcnt(6)
    v_mfma_f32_32x32x16_bf16 v[32:47], v[48:51], v[64:67], v[32:47]
    s_waitcnt lgkmcnt(4)
    v_mfma_f32_32x32x16_bf16 v[32:47], v[52:55], v[68:71], v[32:47]
    s_waitcnt lgkmcnt(2)
    v_mfma_f32_32x32x16_bf16 v[32:47], v[56:59], v[72:75], v[32:47]
    s_waitcnt lgkmcnt(0)
    v_mfma_f32_32x32x16_bf16 v[32:47], v[60:63], v[76:79], v[32:47]
    s_waitcnt vmcnt(8)
    s_barrier
    s_add_u32 m0, s22, 49152
    s_nop 0
    buffer_load_dwordx4 v10, s[8:11], s20 offen lds
    s_add_u32 m0, s22, 50176
    s_nop 0
    buffer_load_dwordx4 v11, s[8:11], s20 offen lds
    s_add_u32 m0, s22, 57344
    s_nop 0
    buffer_load_dwordx4 v10, s[12:15], s21 offen lds
    s_add_u32 m0, s22, 58368
    s_nop 0
    buffer_load_dwordx4 v11, s[12:15], s21 offen lds
    s_add_u32 s20, s20, 128
    s_add_u32 s21, s21, 128
    ds_read_b128 v[48:51], v12 offset:0
    ds_read_b128 v[64:67], v16 offset:8192
    ds_read_b128 v[52:55], v13 offset:0
    ds_read_b128 v[68:71], v17 offset:8192
    ds_read_b128 v[56:59], v14 offset:0
    ds_read_b128 v[72:75], v18 offset:8192
    ds_read_b128 v[60:63], v15 offset:0
    ds_read_b128 v[76:79], v19 offset:8192
    s_waitcnt lgkmcnt(6)
    v_mfma_f32_32x32x16_bf16 v[32:47], v[48:51], v[64:67], v[32:47]
    s_waitcnt lgkmcnt(4)
    v_mfma_f32_32x32x16_bf16 v[32:47], v[52:55], v[68:71], v[32:47]
    s_waitcnt lgkmcnt(2)
    v_mfma_f32_32x32x16_bf16 v[32:47], v[56:59], v[72:75], v[32:47]
    s_waitcnt lgkmcnt(0)
    v_mfma_f32_32x32x16_bf16 v[32:47], v[60:63], v[76:79], v[32:47]
    s_waitcnt vmcnt(8)
    s_barrier
    s_add_u32 m0, s22, 0
    s_nop 0
    buffer_load_dwordx4 v10, s[8:11], s20 offen lds
    s_add_u32 m0, s22, 1024
    s_nop 0
    buffer_load_dwordx4 v11, s[8:11], s20 offen lds
    s_add_u32 m0, s22, 8192
    s_nop 0
    buffer_load_dwordx4 v10, s[12:15], s21 offen lds
    s_add_u32 m0, s22, 9216
    s_nop 0
    buffer_load_dwordx4 v11, s[12:15], s21 offen lds
    s_add_u32 s20, s20, 128
    s_add_u32 s21, s21, 128
    ds_read_b128 v[48:51], v12 offset:16384
    ds_read_b128 v[64:67], v16 offset:24576
    ds_read_b128 v[52:55], v13 offset:16384
    ds_read_b128 v[68:71], v17 offset:24576
    ds_read_b128 v[56:59], v14 offset:16384
    ds_read_b128 v[72:75], v18 offset:24576
    ds_read_b128 v[60:63], v15 offset:16384
    ds_read_b128 v[76:79], v19 offset:24576
    s_waitcnt lgkmcnt(6)
    v_mfma_f32_32x32x16_bf16 v[32:47], v[48:51], v[64:67], v[32:47]
    s_waitcnt lgkmcnt(4)
    v_mfma_f32_32x32x16_bf16 v[32:47], v[52:55], v[68:71], v[32:47]
    s_waitcnt lgkmcnt(2)
    v_mfma_f32_32x32x16_bf16 v[32:47], v[56:59], v[72:75], v[32:47]
    s_waitcnt lgkmcnt(0)
    v_mfma_f32_32x32x16_bf16 v[32:47], v[60:63], v[76:79], v[32:47]
    s_waitcnt vmcnt(8)
    s_barrier
    s_add_u32 m0, s22, 16384
    s_nop 0
    buffer_load_dwordx4 v10, s[8:11], s20 offen lds
    s_add_u32 m0, s22, 17408
    s_nop 0
    buffer_load_dwordx4 v11, s[8:11], s20 offen lds
    s_add_u32 m0, s22, 24576
    s_nop 0
    buffer_load_dwordx4 v10, s[12:15], s21 offen lds
    s_add_u32 m0, s22, 25600
    s_nop 0
    buffer_load_dwordx4 v11, s[12:15], s21 offen lds
    s_add_u32 s20, s20, 128
    s_add_u32 s21, s21, 128
    ds_read_b128 v[48:51], v12 offset:32768
    ds_read_b128 v[64:67], v16 offset:40960
    ds_read_b128 v[52:55], v13 offset:32768
    ds_read_b128 v[68:71], v17 offset:40960
    ds_read_b128 v[56:59], v14 offset:32768
    ds_read_b128 v[72:75], v18 offset:40960
    ds_read_b128 v[60:63], v15 offset:32768
    ds_read_b128 v[76:79], v19 offset:40960
    s_waitcnt lgkmcnt(6)
    v_mfma_f32_32x32x16_bf16 v[32:47], v[48:51], v[64:67], v[32:47]
    s_waitcnt lgkmcnt(4)
    v_mfma_f32_32x32x16_bf16 v[32:47], v[52:55], v[68:71], v[32:47]
    s_waitcnt lgkmcnt(2)
    v_mfma_f32_32x32x16_bf16 v[32:47], v[56:59], v[72:75], v[32:47]
    s_waitcnt lgkmcnt(0)
    v_mfma_f32_32x32x16_bf16 v[32:47], v[60:63], v[76:79], v[32:47]
    s_waitcnt vmcnt(8)
    s_barrier
    s_add_u32 m0, s22, 32768
    s_nop 0
    buffer_load_dwordx4 v10, s[8:11], s20 offen lds
    s_add_u32 m0, s22, 33792
    s_nop 0
    buffer_load_dwordx4 v11, s[8:11], s20 offen lds
    s_add_u32 m0, s22, 40960
    s_nop 0
    buffer_load_dwordx4 v10, s[12:15], s21 offen lds
    s_add_u32 m0, s22, 41984
    s_nop 0
    buffer_load_dwordx4 v11, s[12:15], s21 offen lds
    s_add_u32 s20, s20, 128
    s_add_u32 s21, s21, 128
    ds_read_b128 v[48:51], v12 offset:49152
    ds_read_b128 v[64:67], v16 offset:57344
    ds_read_b128 v[52:55], v13 offset:49152
    ds_read_b128 v[68:71], v17 offset:57344
    ds_read_b128 v[56:59], v14 offset:49152
    ds_read_b128 v[72:75], v18 offset:57344
    ds_read_b128 v[60:63], v15 offset:49152
    ds_read_b128 v[76:79], v19 offset:57344
    s_waitcnt lgkmcnt(6)
    v_mfma_f32_32x32x16_bf16 v[32:47], v[48:51], v[64:67], v[32:47]
    s_waitcnt lgkmcnt(4)
    v_mfma_f32_32x32x16_bf16 v[32:47], v[52:55], v[68:71], v[32:47]
    s_waitcnt lgkmcnt(2)
    v_mfma_f32_32x32x16_bf16 v[32:47], v[56:59], v[72:75], v[32:47]
    s_waitcnt lgkmcnt(0)
    v_mfma_f32_32x32x16_bf16 v[32:47], v[60:63], v[76:79], v[32:47]
    s_waitcnt vmcnt(8)
    s_barrier
    s_add_u32 m0, s22, 49152
    s_nop 0
    buffer_load_dwordx4 v10, s[8:11], s20 offen lds
    s_add_u32 m0, s22, 50176
    s_nop 0
    buffer_load_dwordx4 v11, s[8:11], s20 offen lds
    s_add_u32 m0, s22, 57344
    s_nop 0
    buffer_load_dwordx4 v10, s[12:15], s21 offen lds
    s_add_u32 m0, s22, 58368
    s_nop 0
    buffer_load_dwordx4 v11, s[12:15], s21 offen lds
    s_add_u32 s20, s20, 128
    s_add_u32 s21, s21, 128
    ds_read_b128 v[48:51], v12 offset:0
    ds_read_b128 v[64:67], v16 offset:8192
    ds_read_b128 v[52:55], v13 offset:0
    ds_read_b128 v[68:71], v17 offset:8192
    ds_read_b128 v[56:59], v14 offset:0
    ds_read_b128 v[72:75], v18 offset:8192
    ds_read_b128 v[60:63], v15 offset:0
    ds_read_b128 v[76:79], v19 offset:8192
    s_waitcnt lgkmcnt(6)
    v_mfma_f32_32x32x16_bf16 v[32:47], v[48:51], v[64:67], v[32:47]
    s_waitcnt lgkmcnt(4)
    v_mfma_f32_32x32x16_bf16 v[32:47], v[52:55], v[68:71], v[32:47]
    s_waitcnt lgkmcnt(2)
    v_mfma_f32_32x32x16_bf16 v[32:47], v[56:59], v[72:75], v[32:47]
    s_waitcnt lgkmcnt(0)
    v_mfma_f32_32x32x16_bf16 v[32:47], v[60:63], v[76:79], v[32:47]
    s_waitcnt vmcnt(8)
    s_barrier
    s_add_u32 m0, s22, 0
    s_nop 0
    buffer_load_dwordx4 v10, s[8:11], s20 offen lds
    s_add_u32 m0, s22, 1024
    s_nop 0
    buffer_load_dwordx4 v11, s[8:11], s20 offen lds
    s_add_u32 m0, s22, 8192
    s_nop 0
    buffer_load_dwordx4 v10, s[12:15], s21 offen lds
    s_add_u32 m0, s22, 9216
    s_nop 0
    buffer_load_dwordx4 v11, s[12:15], s21 offen lds
    s_add_u32 s20, s20, 128
    s_add_u32 s21, s21, 128
    ds_read_b128 v[48:51], v12 offset:16384
    ds_read_b128 v[64:67], v16 offset:24576
    ds_read_b128 v[52:55], v13 offset:16384
    ds_read_b128 v[68:71], v17 offset:24576
    ds_read_b128 v[56:59], v14 offset:16384
    ds_read_b128 v[72:75], v18 offset:24576
    ds_read_b128 v[60:63], v15 offset:16384
    ds_read_b128 v[76:79], v19 offset:24576
    s_waitcnt lgkmcnt(6)
    v_mfma_f32_32x32x16_bf16 v[32:47], v[48:51], v[64:67], v[32:47]
    s_waitcnt lgkmcnt(4)
    v_mfma_f32_32x32x16_bf16 v[32:47], v[52:55], v[68:71], v[32:47]
    s_waitcnt lgkmcnt(2)
    v_mfma_f32_32x32x16_bf16 v[32:47], v[56:59], v[72:75], v[32:47]
    s_waitcnt lgkmcnt(0)
    v_mfma_f32_32x32x16_bf16 v[32:47], v[60:63], v[76:79], v[32:47]
    s_waitcnt vmcnt(8)
    s_barrier
    s_add_u32 m0, s22, 16384
    s_nop 0
    buffer_load_dwordx4 v10, s[8:11], s20 offen lds
    s_add_u32 m0, s22, 17408
    s_nop 0
    buffer_load_dwordx4 v11, s[8:11], s20 offen lds
    s_add_u32 m0, s22, 24576
    s_nop 0
    buffer_load_dwordx4 v10, s[12:15], s21 offen lds
    s_add_u32 m0, s22, 25600
    s_nop 0
    buffer_load_dwordx4 v11, s[12:15], s21 offen lds
    s_add_u32 s20, s20, 128
    s_add_u32 s21, s21, 128
    ds_read_b128 v[48:51], v12 offset:32768
    ds_read_b128 v[64:67], v16 offset:40960
    ds_read_b128 v[52:55], v13 offset:32768
    ds_read_b128 v[68:71], v17 offset:40960
    ds_read_b128 v[56:59], v14 offset:32768
    ds_read_b128 v[72:75], v18 offset:40960
    ds_read_b128 v[60:63], v15 offset:32768
    ds_read_b128 v[76:79], v19 offset:40960
    s_waitcnt lgkmcnt(6)
    v_mfma_f32_32x32x16_bf16 v[32:47], v[48:51], v[64:67], v[32:47]
    s_waitcnt lgkmcnt(4)
    v_mfma_f32_32x32x16_bf16 v[32:47], v[52:55], v[68:71], v[32:47]
    s_waitcnt lgkmcnt(2)
    v_mfma_f32_32x32x16_bf16 v[32:47], v[56:59], v[72:75], v[32:47]
    s_waitcnt lgkmcnt(0)
    v_mfma_f32_32x32x16_bf16 v[32:47], v[60:63], v[76:79], v[32:47]
    s_waitcnt vmcnt(8)
    s_barrier
    s_add_u32 m0, s22, 32768
    s_nop 0
    buffer_load_dwordx4 v10, s[8:11], s20 offen lds
    s_add_u32 m0, s22, 33792
    s_nop 0
    buffer_load_dwordx4 v11, s[8:11], s20 offen lds
    s_add_u32 m0, s22, 40960
    s_nop 0
    buffer_load_dwordx4 v10, s[12:15], s21 offen lds
    s_add_u32 m0, s22, 41984
    s_nop 0
    buffer_load_dwordx4 v11, s[12:15], s21 offen lds
    s_add_u32 s20, s20, 128
    s_add_u32 s21, s21, 128
    ds_read_b128 v[48:51], v12 offset:49152
    ds_read_b128 v[64:67], v16 offset:57344
    ds_read_b128 v[52:55], v13 offset:49152
    ds_read_b128 v[68:71], v17 offset:57344
    ds_read_b128 v[56:59], v14 offset:49152
    ds_read_b128 v[72:75], v18 offset:57344
    ds_read_b128 v[60:63], v15 offset:49152
    ds_read_b128 v[76:79], v19 offset:57344
    s_waitcnt lgkmcnt(6)
    v_mfma_f32_32x32x16_bf16 v[32:47], v[48:51], v[64:67], v[32:47]
    s_waitcnt lgkmcnt(4)
    v_mfma_f32_32x32x16_bf16 v[32:47], v[52:55], v[68:71], v[32:47]
    s_waitcnt lgkmcnt(2)
    v_mfma_f32_32x32x16_bf16 v[32:47], v[56:59], v[72:75], v[32:47]
    s_waitcnt lgkmcnt(0)
    v_mfma_f32_32x32x16_bf16 v[32:47], v[60:63], v[76:79], v[32:47]
    s_waitcnt vmcnt(8)
    s_barrier
    s_add_u32 m0, s22, 49152
    s_nop 0
    buffer_load_dwordx4 v10, s[8:11], s20 offen lds
    s_add_u32 m0, s22, 50176
    s_nop 0
    buffer_load_dwordx4 v11, s[8:11], s20 offen lds
    s_add_u32 m0, s22, 57344
    s_nop 0
    buffer_load_dwordx4 v10, s[12:15], s21 offen lds
    s_add_u32 m0, s22, 58368
    s_nop 0
    buffer_load_dwordx4 v11, s[12:15], s21 offen lds
    s_add_u32 s20, s20, 128
    s_add_u32 s21, s21, 128
    ds_read_b128 v[48:51], v12 offset:0
    ds_read_b128 v[64:67], v16 offset:8192
    ds_read_b128 v[52:55], v13 offset:0
    ds_read_b128 v[68:71], v17 offset:8192
    ds_read_b128 v[56:59], v14 offset:0
    ds_read_b128 v[72:75], v18 offset:8192
    ds_read_b128 v[60:63], v15 offset:0
    ds_read_b128 v[76:79], v19 offset:8192
    s_waitcnt lgkmcnt(6)
    v_mfma_f32_32x32x16_bf16 v[32:47], v[48:51], v[64:67], v[32:47]
    s_waitcnt lgkmcnt(4)
    v_mfma_f32_32x32x16_bf16 v[32:47], v[52:55], v[68:71], v[32:47]
    s_waitcnt lgkmcnt(2)
    v_mfma_f32_32x32x16_bf16 v[32:47], v[56:59], v[72:75], v[32:47]
    s_waitcnt lgkmcnt(0)
    v_mfma_f32_32x32x16_bf16 v[32:47], v[60:63], v[76:79], v[32:47]
    s_waitcnt vmcnt(8)
    s_barrier
    s_add_u32 m0, s22, 0
    s_nop 0
    buffer_load_dwordx4 v10, s[8:11], s20 offen lds
    s_add_u32 m0, s22, 1024
    s_nop 0
    buffer_load_dwordx4 v11, s[8:11], s20 offen lds
    s_add_u32 m0, s22, 8192
    s_nop 0
    buffer_load_dwordx4 v10, s[12:15], s21 offen lds
    s_add_u32 m0, s22, 9216
    s_nop 0
    buffer_load_dwordx4 v11, s[12:15], s21 offen lds
    s_add_u32 s20, s20, 128
    s_add_u32 s21, s21, 128
    ds_read_b128 v[48:51], v12 offset:16384
    ds_read_b128 v[64:67], v16 offset:24576
    ds_read_b128 v[52:55], v13 offset:16384
    ds_read_b128 v[68:71], v17 offset:24576
    ds_read_b128 v[56:59], v14 offset:16384
    ds_read_b128 v[72:75], v18 offset:24576
    ds_read_b128 v[60:63], v15 offset:16384
    ds_read_b128 v[76:79], v19 offset:24576
    s_waitcnt lgkmcnt(6)
    v_mfma_f32_32x32x16_bf16 v[32:47], v[48:51], v[64:67], v[32:47]
    s_waitcnt lgkmcnt(4)
    v_mfma_f32_32x32x16_bf16 v[32:47], v[52:55], v[68:71], v[32:47]
    s_waitcnt lgkmcnt(2)
    v_mfma_f32_32x32x16_bf16 v[32:47], v[56:59], v[72:75], v[32:47]
    s_waitcnt lgkmcnt(0)
    v_mfma_f32_32x32x16_bf16 v[32:47], v[60:63], v[76:79], v[32:47]
    s_waitcnt vmcnt(8)
    s_barrier
    s_add_u32 m0, s22, 16384
    s_nop 0
    buffer_load_dwordx4 v10, s[8:11], s20 offen lds
    s_add_u32 m0, s22, 17408
    s_nop 0
    buffer_load_dwordx4 v11, s[8:11], s20 offen lds
    s_add_u32 m0, s22, 24576
    s_nop 0
    buffer_load_dwordx4 v10, s[12:15], s21 offen lds
    s_add_u32 m0, s22, 25600
    s_nop 0
    buffer_load_dwordx4 v11, s[12:15], s21 offen lds
    s_add_u32 s20, s20, 128
    s_add_u32 s21, s21, 128
    ds_read_b128 v[48:51], v12 offset:32768
    ds_read_b128 v[64:67], v16 offset:40960
    ds_read_b128 v[52:55], v13 offset:32768
    ds_read_b128 v[68:71], v17 offset:40960
    ds_read_b128 v[56:59], v14 offset:32768
    ds_read_b128 v[72:75], v18 offset:40960
    ds_read_b128 v[60:63], v15 offset:32768
    ds_read_b128 v[76:79], v19 offset:40960
    s_waitcnt lgkmcnt(6)
    v_mfma_f32_32x32x16_bf16 v[32:47], v[48:51], v[64:67], v[32:47]
    s_waitcnt lgkmcnt(4)
    v_mfma_f32_32x32x16_bf16 v[32:47], v[52:55], v[68:71], v[32:47]
    s_waitcnt lgkmcnt(2)
    v_mfma_f32_32x32x16_bf16 v[32:47], v[56:59], v[72:75], v[32:47]
    s_waitcnt lgkmcnt(0)
    v_mfma_f32_32x32x16_bf16 v[32:47], v[60:63], v[76:79], v[32:47]
    s_waitcnt vmcnt(8)
    s_barrier
    s_add_u32 m0, s22, 32768
    s_nop 0
    buffer_load_dwordx4 v10, s[8:11], s20 offen lds
    s_add_u32 m0, s22, 33792
    s_nop 0
    buffer_load_dwordx4 v11, s[8:11], s20 offen lds
    s_add_u32 m0, s22, 40960
    s_nop 0
    buffer_load_dwordx4 v10, s[12:15], s21 offen lds
    s_add_u32 m0, s22, 41984
    s_nop 0
    buffer_load_dwordx4 v11, s[12:15], s21 offen lds
    s_add_u32 s20, s20, 128
    s_add_u32 s21, s21, 128
    ds_read_b128 v[48:51], v12 offset:49152
    ds_read_b128 v[64:67], v16 offset:57344
    ds_read_b128 v[52:55], v13 offset:49152
    ds_read_b128 v[68:71], v17 offset:57344
    ds_read_b128 v[56:59], v14 offset:49152
    ds_read_b128 v[72:75], v18 offset:57344
    ds_read_b128 v[60:63], v15 offset:49152
    ds_read_b128 v[76:79], v19 offset:57344
    s_waitcnt lgkmcnt(6)
    v_mfma_f32_32x32x16_bf16 v[32:47], v[48:51], v[64:67], v[32:47]
    s_waitcnt lgkmcnt(4)
    v_mfma_f32_32x32x16_bf16 v[32:47], v[52:55], v[68:71], v[32:47]
    s_waitcnt lgkmcnt(2)
    v_mfma_f32_32x32x16_bf16 v[32:47], v[56:59], v[72:75], v[32:47]
    s_waitcnt lgkmcnt(0)
    v_mfma_f32_32x32x16_bf16 v[32:47], v[60:63], v[76:79], v[32:47]
    s_waitcnt vmcnt(8)
    s_barrier
    s_add_u32 m0, s22, 49152
    s_nop 0
    buffer_load_dwordx4 v10, s[8:11], s20 offen lds
    s_add_u32 m0, s22, 50176
    s_nop 0
    buffer_load_dwordx4 v11, s[8:11], s20 offen lds
    s_add_u32 m0, s22, 57344
    s_nop 0
    buffer_load_dwordx4 v10, s[12:15], s21 offen lds
    s_add_u32 m0, s22, 58368
    s_nop 0
    buffer_load_dwordx4 v11, s[12:15], s21 offen lds
    s_add_u32 s20, s20, 128
    s_add_u32 s21, s21, 128
    ds_read_b128 v[48:51], v12 offset:0
    ds_read_b128 v[64:67], v16 offset:8192
    ds_read_b128 v[52:55], v13 offset:0
    ds_read_b128 v[68:71], v17 offset:8192
    ds_read_b128 v[56:59], v14 offset:0
    ds_read_b128 v[72:75], v18 offset:8192
    ds_read_b128 v[60:63], v15 offset:0
    ds_read_b128 v[76:79], v19 offset:8192
    s_waitcnt lgkmcnt(6)
    v_mfma_f32_32x32x16_bf16 v[32:47], v[48:51], v[64:67], v[32:47]
    s_waitcnt lgkmcnt(4)
    v_mfma_f32_32x32x16_bf16 v[32:47], v[52:55], v[68:71], v[32:47]
    s_waitcnt lgkmcnt(2)
    v_mfma_f32_32x32x16_bf16 v[32:47], v[56:59], v[72:75], v[32:47]
    s_waitcnt lgkmcnt(0)
    v_mfma_f32_32x32x16_bf16 v[32:47], v[60:63], v[76:79], v[32:47]
    s_waitcnt vmcnt(8)
    s_barrier
    s_add_u32 m0, s22, 0
    s_nop 0
    buffer_load_dwordx4 v10, s[8:11], s20 offen lds
    s_add_u32 m0, s22, 1024
    s_nop 0
    buffer_load_dwordx4 v11, s[8:11], s20 offen lds
    s_add_u32 m0, s22, 8192
    s_nop 0
    buffer_load_dwordx4 v10, s[12:15], s21 offen lds
    s_add_u32 m0, s22, 9216
    s_nop 0
    buffer_load_dwordx4 v11, s[12:15], s21 offen lds
    s_add_u32 s20, s20, 128
    s_add_u32 s21, s21, 128
    ds_read_b128 v[48:51], v12 offset:16384
    ds_read_b128 v[64:67], v16 offset:24576
    ds_read_b128 v[52:55], v13 offset:16384
    ds_read_b128 v[68:71], v17 offset:24576
    ds_read_b128 v[56:59], v14 offset:16384
    ds_read_b128 v[72:75], v18 offset:24576
    ds_read_b128 v[60:63], v15 offset:16384
    ds_read_b128 v[76:79], v19 offset:24576
    s_waitcnt lgkmcnt(6)
    v_mfma_f32_32x32x16_bf16 v[32:47], v[48:51], v[64:67], v[32:47]
    s_waitcnt lgkmcnt(4)
    v_mfma_f32_32x32x16_bf16 v[32:47], v[52:55], v[68:71], v[32:47]
    s_waitcnt lgkmcnt(2)
    v_mfma_f32_32x32x16_bf16 v[32:47], v[56:59], v[72:75], v[32:47]
    s_waitcnt lgkmcnt(0)
    v_mfma_f32_32x32x16_bf16 v[32:47], v[60:63], v[76:79], v[32:47]
    s_waitcnt vmcnt(8)
    s_barrier
    s_add_u32 m0, s22, 16384
    s_nop 0
    buffer_load_dwordx4 v10, s[8:11], s20 offen lds
    s_add_u32 m0, s22, 17408
    s_nop 0
    buffer_load_dwordx4 v11, s[8:11], s20 offen lds
    s_add_u32 m0, s22, 24576
    s_nop 0
    buffer_load_dwordx4 v10, s[12:15], s21 offen lds
    s_add_u32 m0, s22, 25600
    s_nop 0
    buffer_load_dwordx4 v11, s[12:15], s21 offen lds
    s_add_u32 s20, s20, 128
    s_add_u32 s21, s21, 128
    ds_read_b128 v[48:51], v12 offset:32768
    ds_read_b128 v[64:67], v16 offset:40960
    ds_read_b128 v[52:55], v13 offset:32768
    ds_read_b128 v[68:71], v17 offset:40960
    ds_read_b128 v[56:59], v14 offset:32768
    ds_read_b128 v[72:75], v18 offset:40960
    ds_read_b128 v[60:63], v15 offset:32768
    ds_read_b128 v[76:79], v19 offset:40960
    s_waitcnt lgkmcnt(6)
    v_mfma_f32_32x32x16_bf16 v[32:47], v[48:51], v[64:67], v[32:47]
    s_waitcnt lgkmcnt(4)
    v_mfma_f32_32x32x16_bf16 v[32:47], v[52:55], v[68:71], v[32:47]
    s_waitcnt lgkmcnt(2)
    v_mfma_f32_32x32x16_bf16 v[32:47], v[56:59], v[72:75], v[32:47]
    s_waitcnt lgkmcnt(0)
    v_mfma_f32_32x32x16_bf16 v[32:47], v[60:63], v[76:79], v[32:47]
    s_waitcnt vmcnt(8)
    s_barrier
    s_add_u32 m0, s22, 32768
    s_nop 0
    buffer_load_dwordx4 v10, s[8:11], s20 offen lds
    s_add_u32 m0, s22, 33792
    s_nop 0
    buffer_load_dwordx4 v11, s[8:11], s20 offen lds
    s_add_u32 m0, s22, 40960
    s_nop 0
    buffer_load_dwordx4 v10, s[12:15], s21 offen lds
    s_add_u32 m0, s22, 41984
    s_nop 0
    buffer_load_dwordx4 v11, s[12:15], s21 offen lds
    s_add_u32 s20, s20, 128
    s_add_u32 s21, s21, 128
    ds_read_b128 v[48:51], v12 offset:49152
    ds_read_b128 v[64:67], v16 offset:57344
    ds_read_b128 v[52:55], v13 offset:49152
    ds_read_b128 v[68:71], v17 offset:57344
    ds_read_b128 v[56:59], v14 offset:49152
    ds_read_b128 v[72:75], v18 offset:57344
    ds_read_b128 v[60:63], v15 offset:49152
    ds_read_b128 v[76:79], v19 offset:57344
    s_waitcnt lgkmcnt(6)
    v_mfma_f32_32x32x16_bf16 v[32:47], v[48:51], v[64:67], v[32:47]
    s_waitcnt lgkmcnt(4)
    v_mfma_f32_32x32x16_bf16 v[32:47], v[52:55], v[68:71], v[32:47]
    s_waitcnt lgkmcnt(2)
    v_mfma_f32_32x32x16_bf16 v[32:47], v[56:59], v[72:75], v[32:47]
    s_waitcnt lgkmcnt(0)
    v_mfma_f32_32x32x16_bf16 v[32:47], v[60:63], v[76:79], v[32:47]
    s_waitcnt vmcnt(8)
    s_barrier
    s_add_u32 m0, s22, 49152
    s_nop 0
    buffer_load_dwordx4 v10, s[8:11], s20 offen lds
    s_add_u32 m0, s22, 50176
    s_nop 0
    buffer_load_dwordx4 v11, s[8:11], s20 offen lds
    s_add_u32 m0, s22, 57344
    s_nop 0
    buffer_load_dwordx4 v10, s[12:15], s21 offen lds
    s_add_u32 m0, s22, 58368
    s_nop 0
    buffer_load_dwordx4 v11, s[12:15], s21 offen lds
    s_add_u32 s20, s20, 128
    s_add_u32 s21, s21, 128
    ds_read_b128 v[48:51], v12 offset:0
    ds_read_b128 v[64:67], v16 offset:8192
    ds_read_b128 v[52:55], v13 offset:0
    ds_read_b128 v[68:71], v17 offset:8192
    ds_read_b128 v[56:59], v14 offset:0
    ds_read_b128 v[72:75], v18 offset:8192
    ds_read_b128 v[60:63], v15 offset:0
    ds_read_b128 v[76:79], v19 offset:8192
    s_waitcnt lgkmcnt(6)
    v_mfma_f32_32x32x16_bf16 v[32:47], v[48:51], v[64:67], v[32:47]
    s_waitcnt lgkmcnt(4)
    v_mfma_f32_32x32x16_bf16 v[32:47], v[52:55], v[68:71], v[32:47]
    s_waitcnt lgkmcnt(2)
    v_mfma_f32_32x32x16_bf16 v[32:47], v[56:59], v[72:75], v[32:47]
    s_waitcnt lgkmcnt(0)
    v_mfma_f32_32x32x16_bf16 v[32:47], v[60:63], v[76:79], v[32:47]
    s_waitcnt vmcnt(8)
    s_barrier
    ds_read_b128 v[48:51], v12 offset:16384
    ds_read_b128 v[64:67], v16 offset:24576
    ds_read_b128 v[52:55], v13 offset:16384
    ds_read_b128 v[68:71], v17 offset:24576
    ds_read_b128 v[56:59], v14 offset:16384
    ds_read_b128 v[72:75], v18 offset:24576
    ds_read_b128 v[60:63], v15 offset:16384
    ds_read_b128 v[76:79], v19 offset:24576
    s_waitcnt lgkmcnt(6)
    v_mfma_f32_32x32x16_bf16 v[32:47], v[48:51], v[64:67], v[32:47]
    s_waitcnt lgkmcnt(4)
    v_mfma_f32_32x32x16_bf16 v[32:47], v[52:55], v[68:71], v[32:47]
    s_waitcnt lgkmcnt(2)
    v_mfma_f32_32x32x16_bf16 v[32:47], v[56:59], v[72:75], v[32:47]
    s_waitcnt lgkmcnt(0)
    v_mfma_f32_32x32x16_bf16 v[32:47], v[60:63], v[76:79], v[32:47]
    s_waitcnt vmcnt(4)
    s_barrier
    ds_read_b128 v[48:51], v12 offset:32768
    ds_read_b128 v[64:67], v16 offset:40960
    ds_read_b128 v[52:55], v13 offset:32768
    ds_read_b128 v[68:71], v17 offset:40960
    ds_read_b128 v[56:59], v14 offset:32768
    ds_read_b128 v[72:75], v18 offset:40960
    ds_read_b128 v[60:63], v15 offset:32768
    ds_read_b128 v[76:79], v19 offset:40960
    s_waitcnt lgkmcnt(6)
    v_mfma_f32_32x32x16_bf16 v[32:47], v[48:51], v[64:67], v[32:47]
    s_waitcnt lgkmcnt(4)
    v_mfma_f32_32x32x16_bf16 v[32:47], v[52:55], v[68:71], v[32:47]
    s_waitcnt lgkmcnt(2)
    v_mfma_f32_32x32x16_bf16 v[32:47], v[56:59], v[72:75], v[32:47]
    s_waitcnt lgkmcnt(0)
    v_mfma_f32_32x32x16_bf16 v[32:47], v[60:63], v[76:79], v[32:47]
    s_waitcnt vmcnt(0)
    s_barrier
    ds_read_b128 v[48:51], v12 offset:49152
    ds_read_b128 v[64:67], v16 offset:57344
    ds_read_b128 v[52:55], v13 offset:49152
    ds_read_b128 v[68:71], v17 offset:57344
    ds_read_b128 v[56:59], v14 offset:49152
    ds_read_b128 v[72:75], v18 offset:57344
    ds_read_b128 v[60:63], v15 offset:49152
    ds_read_b128 v[76:79], v19 offset:57344
    s_waitcnt lgkmcnt(6)
    v_mfma_f32_32x32x16_bf16 v[32:47], v[48:51], v[64:67], v[32:47]
    s_waitcnt lgkmcnt(4)
    v_mfma_f32_32x32x16_bf16 v[32:47], v[52:55], v[68:71], v[32:47]
    s_waitcnt lgkmcnt(2)
    v_mfma_f32_32x32x16_bf16 v[32:47], v[56:59], v[72:75], v[32:47]
    s_waitcnt lgkmcnt(0)
    v_mfma_f32_32x32x16_bf16 v[32:47], v[60:63], v[76:79], v[32:47]
    s_load_dwordx2 s[24:25], s[0:1], 88
    s_load_dwordx2 s[26:27], s[0:1], 96
    s_waitcnt lgkmcnt(0)
    s_mov_b32 s28, s24
    s_mov_b32 s29, s25
    s_mov_b32 s30, 0x1000
    s_mov_b32 s31, 0x00020000
    s_add_u32 s32, s4, 0x6a0000
    s_addc_u32 s33, s5, 0
    s_mov_b32 s34, 0x280000
    s_mov_b32 s35, 0x00020000
    s_mov_b32 s36, s26
    s_mov_b32 s37, s27
    s_mov_b32 s38, 0x280000
    s_mov_b32 s39, 0x00020000
    s_nop 7
    s_barrier
    v_lshl_add_u32 v80, v6, 5, v3
    v_mul_u32_u24 v80, 272, v80
    v_lshlrev_b32 v81, 5, v5
    v_lshl_add_u32 v81, v4, 2, v81
    v_lshl_add_u32 v80, v81, 2, v80
    ds_write_b128 v80, v[32:35] offset:0
    ds_write_b128 v80, v[36:39] offset:32
    ds_write_b128 v80, v[40:43] offset:64
    ds_write_b128 v80, v[44:47] offset:96
    s_waitcnt lgkmcnt(0)
    s_barrier
    v_lshrrev_b32 v82, 2, v0
    v_and_b32 v83, 3, v0
    v_mul_u32_u24 v84, 272, v82
    v_lshl_add_u32 v84, v83, 6, v84
    ds_read_b128 v[96:99], v84 offset:0
    ds_read_b128 v[100:103], v84 offset:16
    ds_read_b128 v[104:107], v84 offset:32
    ds_read_b128 v[108:111], v84 offset:48
    s_lshl_b32 s40, s17, 6
    v_add_u32 v85, s40, v82
    v_lshlrev_b32 v86, 1, v85
    buffer_load_ushort v87, v86, s[28:31], 0 offen
    v_mul_u32_u24 v88, 1280, v85
    s_lshl_b32 s41, s16, 7
    v_lshl_add_u32 v88, v83, 5, v88
    v_add_u32 v88, s41, v88
    buffer_load_dwordx4 v[112:115], v88, s[32:35], 0 offen
    buffer_load_dwordx4 v[116:119], v88, s[32:35], 0 offen offset:16
    s_waitcnt vmcnt(0) lgkmcnt(0)
    v_lshlrev_b32 v87, 16, v87
    v_cvt_pk_bf16_f32 v96, v96, v96
    v_lshlrev_b32 v96, 16, v96
    v_cvt_pk_bf16_f32 v97, v97, v97
    v_lshlrev_b32 v97, 16, v97
    v_cvt_pk_bf16_f32 v98, v98, v98
    v_lshlrev_b32 v98, 16, v98
    v_cvt_pk_bf16_f32 v99, v99, v99
    v_lshlrev_b32 v99, 16, v99
    v_cvt_pk_bf16_f32 v100, v100, v100
    v_lshlrev_b32 v100, 16, v100
    v_cvt_pk_bf16_f32 v101, v101, v101
    v_lshlrev_b32 v101, 16, v101
    v_cvt_pk_bf16_f32 v102, v102, v102
    v_lshlrev_b32 v102, 16, v102
    v_cvt_pk_bf16_f32 v103, v103, v103
    v_lshlrev_b32 v103, 16, v103
    v_cvt_pk_bf16_f32 v104, v104, v104
    v_lshlrev_b32 v104, 16, v104
    v_cvt_pk_bf16_f32 v105, v105, v105
    v_lshlrev_b32 v105, 16, v105
    v_cvt_pk_bf16_f32 v106, v106, v106
    v_lshlrev_b32 v106, 16, v106
    v_cvt_pk_bf16_f32 v107, v107, v107
    v_lshlrev_b32 v107, 16, v107
    v_cvt_pk_bf16_f32 v108, v108, v108
    v_lshlrev_b32 v108, 16, v108
    v_cvt_pk_bf16_f32 v109, v109, v109
    v_lshlrev_b32 v109, 16, v109
    v_cvt_pk_bf16_f32 v110, v110, v110
    v_lshlrev_b32 v110, 16, v110
    v_cvt_pk_bf16_f32 v111, v111, v111
    v_lshlrev_b32 v111, 16, v111
    v_add_f32 v96, v96, v87
    v_add_f32 v97, v97, v87
    v_add_f32 v98, v98, v87
    v_add_f32 v99, v99, v87
    v_add_f32 v100, v100, v87
    v_add_f32 v101, v101, v87
    v_add_f32 v102, v102, v87
    v_add_f32 v103, v103, v87
    v_add_f32 v104, v104, v87
    v_add_f32 v105, v105, v87
    v_add_f32 v106, v106, v87
    v_add_f32 v107, v107, v87
    v_add_f32 v108, v108, v87
    v_add_f32 v109, v109, v87
    v_add_f32 v110, v110, v87
    v_add_f32 v111, v111, v87
    v_cvt_pk_bf16_f32 v96, v96, v96
    v_lshlrev_b32 v96, 16, v96
    v_cvt_pk_bf16_f32 v97, v97, v97
    v_lshlrev_b32 v97, 16, v97
    v_cvt_pk_bf16_f32 v98, v98, v98
    v_lshlrev_b32 v98, 16, v98
    v_cvt_pk_bf16_f32 v99, v99, v99
    v_lshlrev_b32 v99, 16, v99
    v_cvt_pk_bf16_f32 v100, v100, v100
    v_lshlrev_b32 v100, 16, v100
    v_cvt_pk_bf16_f32 v101, v101, v101
    v_lshlrev_b32 v101, 16, v101
    v_cvt_pk_bf16_f32 v102, v102, v102
    v_lshlrev_b32 v102, 16, v102
    v_cvt_pk_bf16_f32 v103, v103, v103
    v_lshlrev_b32 v103, 16, v103
    v_cvt_pk_bf16_f32 v104, v104, v104
    v_lshlrev_b32 v104, 16, v104
    v_cvt_pk_bf16_f32 v105, v105, v105
    v_lshlrev_b32 v105, 16, v105
    v_cvt_pk_bf16_f32 v106, v106, v106
    v_lshlrev_b32 v106, 16, v106
    v_cvt_pk_bf16_f32 v107, v107, v107
    v_lshlrev_b32 v107, 16, v107
    v_cvt_pk_bf16_f32 v108, v108, v108
    v_lshlrev_b32 v108, 16, v108
    v_cvt_pk_bf16_f32 v109, v109, v109
    v_lshlrev_b32 v109, 16, v109
    v_cvt_pk_bf16_f32 v110, v110, v110
    v_lshlrev_b32 v110, 16, v110
    v_cvt_pk_bf16_f32 v111, v111, v111
    v_lshlrev_b32 v111, 16, v111
    v_lshlrev_b32 v120, 16, v112
    v_and_b32 v121, 0xffff0000, v112
    v_add_f32 v120, v120, v96
    v_add_f32 v121, v121, v97
    v_cvt_pk_bf16_f32 v112, v120, v121
    v_lshlrev_b32 v120, 16, v113
    v_and_b32 v121, 0xffff0000, v113
    v_add_f32 v120, v120, v98
    v_add_f32 v121, v121, v99
    v_cvt_pk_bf16_f32 v113, v120, v121
    v_lshlrev_b32 v120, 16, v114
    v_and_b32 v121, 0xffff0000, v114
    v_add_f32 v120, v120, v100
    v_add_f32 v121, v121, v101
    v_cvt_pk_bf16_f32 v114, v120, v121
    v_lshlrev_b32 v120, 16, v115
    v_and_b32 v121, 0xffff0000, v115
    v_add_f32 v120, v120, v102
    v_add_f32 v121, v121, v103
    v_cvt_pk_bf16_f32 v115, v120, v121
    v_lshlrev_b32 v120, 16, v116
    v_and_b32 v121, 0xffff0000, v116
    v_add_f32 v120, v120, v104
    v_add_f32 v121, v121, v105
    v_cvt_pk_bf16_f32 v116, v120, v121
    v_lshlrev_b32 v120, 16, v117
    v_and_b32 v121, 0xffff0000, v117
    v_add_f32 v120, v120, v106
    v_add_f32 v121, v121, v107
    v_cvt_pk_bf16_f32 v117, v120, v121
    v_lshlrev_b32 v120, 16, v118
    v_and_b32 v121, 0xffff0000, v118
    v_add_f32 v120, v120, v108
    v_add_f32 v121, v121, v109
    v_cvt_pk_bf16_f32 v118, v120, v121
    v_lshlrev_b32 v120, 16, v119
    v_and_b32 v121, 0xffff0000, v119
    v_add_f32 v120, v120, v110
    v_add_f32 v121, v121, v111
    v_cvt_pk_bf16_f32 v119, v120, v121
    buffer_store_dwordx4 v[112:115], v88, s[36:39], 0 offen
    buffer_store_dwordx4 v[116:119], v88, s[36:39], 0 offen offset:16
L_end_28:
    s_endpgm
.section .rodata,"a"
.p2align 6
.amdhsa_kernel prep_kernel
  .amdhsa_next_free_vgpr 128
  .amdhsa_next_free_sgpr 102
  .amdhsa_accum_offset 128
  .amdhsa_group_segment_fixed_size 0
  .amdhsa_kernarg_size 120
  .amdhsa_user_sgpr_count 2
  .amdhsa_user_sgpr_kernarg_segment_ptr 1
  .amdhsa_system_sgpr_workgroup_id_x 1
.end_amdhsa_kernel
.section .rodata,"a"
.p2align 6
.amdhsa_kernel conv_kernel
  .amdhsa_next_free_vgpr 168
  .amdhsa_next_free_sgpr 102
  .amdhsa_accum_offset 168
  .amdhsa_group_segment_fixed_size 0
  .amdhsa_kernarg_size 120
  .amdhsa_user_sgpr_count 2
  .amdhsa_user_sgpr_kernarg_segment_ptr 1
  .amdhsa_system_sgpr_workgroup_id_x 1
.end_amdhsa_kernel
.section .rodata,"a"
.p2align 6
.amdhsa_kernel ln2_kernel
  .amdhsa_next_free_vgpr 128
  .amdhsa_next_free_sgpr 102
  .amdhsa_accum_offset 128
  .amdhsa_group_segment_fixed_size 0
  .amdhsa_kernarg_size 120
  .amdhsa_user_sgpr_count 2
  .amdhsa_user_sgpr_kernarg_segment_ptr 1
  .amdhsa_system_sgpr_workgroup_id_x 1
.end_amdhsa_kernel
.section .rodata,"a"
.p2align 6
.amdhsa_kernel gemm1_kernel
  .amdhsa_next_free_vgpr 128
  .amdhsa_next_free_sgpr 102
  .amdhsa_accum_offset 128
  .amdhsa_group_segment_fixed_size 0
  .amdhsa_kernarg_size 120
  .amdhsa_user_sgpr_count 2
  .amdhsa_user_sgpr_kernarg_segment_ptr 1
  .amdhsa_system_sgpr_workgroup_id_x 1
.end_amdhsa_kernel
.section .rodata,"a"
.p2align 6
.amdhsa_kernel gemm2_kernel
  .amdhsa_next_free_vgpr 128
  .amdhsa_next_free_sgpr 102
  .amdhsa_accum_offset 128
  .amdhsa_group_segment_fixed_size 0
  .amdhsa_kernarg_size 120
  .amdhsa_user_sgpr_count 2
  .amdhsa_user_sgpr_kernarg_segment_ptr 1
  .amdhsa_system_sgpr_workgroup_id_x 1
.end_amdhsa_kernel
```
